```python
import torch

def _softmax(x, axis=-1):
    return torch.softmax(x, dim=axis)
def _gelu(x):
    return torch.nn.functional.gelu(x, approximate="tanh")
def _silu(x):
    return torch.nn.functional.silu(x)
def _sigmoid(x):
    return torch.sigmoid(x)
def _layernorm(x, axis=-1, eps=1e-5):
    m = x.mean(dim=axis, keepdim=True)
    v = x.var(dim=axis, keepdim=True, unbiased=False)
    return (x - m) / torch.sqrt(v + eps)
def _scatter_add(tgt, idx, src, axis=0):
    return tgt.clone().index_add_(axis, idx, src)
def _segment_sum(src, seg, n):
    out = torch.zeros((n,) + src.shape[1:], dtype=src.dtype)
    return out.index_add_(0, seg, src)
def _pad(x, pw):
    flat = tuple(v for pair in reversed(pw) for v in pair)
    return torch.nn.functional.pad(x, flat)

kernel_name = 'concat_heads__ssm_conv_h3__softmax_full_mha__prompt'

def setup_inputs():

    _w = (lambda a: (lambda t: t.to(torch.bfloat16) if t.is_floating_point() else t)(torch.as_tensor(a)))
    def _A_setup():
        B, S, D = 1, 2048, 1024
        ks = 4
        return {
            "q": _w((lambda *s: torch.randn(*s, dtype=torch.bfloat16) * 0.05)(B, S, D)),
            "k": _w((lambda *s: torch.randn(*s, dtype=torch.bfloat16) * 0.8)(B, S, D)),
            "v": _w((lambda *s: torch.randn(*s, dtype=torch.bfloat16) * 0.8)(B, S, D)),
            "shift_k": _w((lambda *s: torch.randn(*s, dtype=torch.bfloat16) * 0.8)(D, ks) * 0.5),
            "ssm_k": _w((lambda *s: torch.randn(*s, dtype=torch.bfloat16) * 0.8)(D, S) * (1.0 / S ** 0.5)),
            "ssm_D": _w((lambda *s: torch.randn(*s, dtype=torch.bfloat16) * 0.8)(D)),
        }
    _A_in = _A_setup()

    def _B_setup():
        B, S, D = 1, 2048, 1024
        return {
            "x": _w((lambda *s: torch.randn(*s, dtype=torch.bfloat16) * 0.2)(B, S, D)),
            "wqkv": _w((lambda *s: torch.randn(*s, dtype=torch.bfloat16) * 0.2)(D, 3 * D)),
            "wo": _w((lambda *s: torch.randn(*s, dtype=torch.bfloat16) * 0.05)(D, D)),
        }
    _B_in = _B_setup()

    return {
        "A_q": _A_in["q"],
        "A_k": _A_in["k"],
        "A_v": _A_in["v"],
        "A_shift_k": _A_in["shift_k"],
        "A_ssm_k": _A_in["ssm_k"],
        "A_ssm_D": _A_in["ssm_D"],
        "B_x": _B_in["x"],
        "B_wqkv": _B_in["wqkv"],
        "B_wo": _B_in["wo"],
    }

def reference(A_q, A_k, A_v, A_shift_k, A_ssm_k, A_ssm_D, B_x, B_wqkv, B_wo):
    def _A_ref(q, k, v, shift_k, ssm_k, ssm_D):
        B, S, D = q.shape
        ks = shift_k.shape[-1]
        k_pad = _pad(k, ((0, 0), (ks - 1, 0), (0, 0)))
        k_shift = torch.zeros_like(k)
        for t in range(ks):
            k_shift = k_shift + k_pad[:, t:t + S, :] * shift_k[:, ks - 1 - t][None, None, :]
        kv = k_shift * v
        L = 2 * S
        kv_pad = _pad(kv, ((0, 0), (0, S), (0, 0)))
        kf_pad = _pad(ssm_k, ((0, 0), (0, S)))
        kv_f = (lambda x, axes=(-2,-1): torch.fft.rfft2(x.float(), dim=axes))(kv_pad[:, None, :, :], axes=(1, 2))
        kf_f = (lambda x, axes=(-2,-1): torch.fft.rfft2(x.float(), dim=axes))(kf_pad[:, None, :], axes=(1, 2))
        kf_f = (lambda x, *d: x.permute(*d))(kf_f, 1, 2, 0)
        y_f = kv_f * kf_f[None, :, :, :]
        y = (lambda x, s, axes=(-2,-1): torch.fft.irfft2(x, s=s, dim=axes).to(torch.bfloat16))(y_f, (1, L), axes=(1, 2))[:, 0, :S, :]
        y = y + kv * ssm_D[None, None, :]
        return q * y

    def _B_ref(x, wqkv, wo):
        B, S, D = x.shape
        H = 32; Dh = D // H
        qkv = (lambda x, *d: x.permute(*d))((x @ wqkv).reshape(B, S, 3, H, Dh), 2, 0, 3, 1, 4)
        q, k, v = qkv[0], qkv[1], qkv[2]
        scale = Dh ** -0.5
        scores = torch.einsum("bhqd,bhkd->bhqk", q, k) * scale
        p = _softmax(scores, axis=-1)
        o = torch.einsum("bhqk,bhkd->bhqd", p, v)
        return (lambda x, *d: x.permute(*d))(o, 0, 2, 1, 3).reshape(B, S, D) @ wo

    a = _A_ref(A_q, A_k, A_v, A_shift_k, A_ssm_k, A_ssm_D)
    b = _B_ref(B_x, B_wqkv, B_wo)
    return torch.concatenate([a, b], axis=-1)
```

```asm
; @launch grid=(256,1,1) block=(512,1,1) lds=163840
.amdgcn_target "amdgcn-amd-amdhsa--gfx950"
.text
.globl concat_heads__ssm_conv_h3__softmax_full_mha__prompt_kernel
.p2align 8
.type concat_heads__ssm_conv_h3__softmax_full_mha__prompt_kernel,@function
concat_heads__ssm_conv_h3__softmax_full_mha__prompt_kernel:
s_cmp_ge_u32 s2, 256
s_cbranch_scc1 L_concat_heads__ssm_conv_h3__softmax_full_mha__prompt_kernel_end
v_lshrrev_b32 v1, 6, v0
s_nop 0
v_readfirstlane_b32 s12, v1
s_nop 0
s_cmp_ge_u32 s12, 4
s_cbranch_scc1 L_concat_heads__ssm_conv_h3__softmax_full_mha__prompt_kernel_aux
s_load_dwordx4 s[36:39], s[0:1], 48
s_load_dwordx4 s[52:55], s[0:1], 80
v_and_b32 v169, 63, v0
s_and_b32 s40, s2, 1
s_lshl_b32 s40, s40, 3
s_bfe_u32 s44, s2, 0x30003
s_add_u32 s40, s40, s44
s_bfe_u32 s41, s2, 0x20001
s_lshl_b32 s41, s41, 2
s_lshr_b32 s44, s2, 6
s_add_u32 s41, s41, s44
s_and_b32 s46, s12, 1
s_lshr_b32 s47, s12, 1
v_lshrrev_b32 v165, 3, v169
v_lshrrev_b32 v166, 4, v169
v_and_b32 v167, 7, v169
v_xor_b32 v167, v167, v166
s_lshl_b32 s44, s40, 7
s_lshl_b32 s48, s12, 5
s_add_u32 s44, s44, s48
v_add_u32 v165, s44, v165
v_lshlrev_b32 v165, 11, v165
v_mov_b32 v168, v167
v_lshl_add_u32 v155, v168, 4, v165
v_xor_b32 v168, 4, v167
v_lshl_add_u32 v156, v168, 4, v165
v_add_u32 v156, 16384, v156
v_mov_b32 v168, v167
v_lshl_add_u32 v157, v168, 4, v165
v_add_u32 v157, 32768, v157
v_xor_b32 v168, 4, v167
v_lshl_add_u32 v158, v168, 4, v165
v_add_u32 v158, 49152, v158
v_lshrrev_b32 v165, 3, v169
s_lshl_b32 s44, s12, 4
v_add_u32 v165, s44, v165
v_mul_u32_u24 v165, 6144, v165
v_and_b32 v166, 1, v166
v_lshlrev_b32 v166, 2, v166
v_and_b32 v167, 7, v169
v_xor_b32 v167, v167, v166
v_lshl_add_u32 v165, v167, 4, v165
s_lshl_b32 s44, s41, 7
v_add_u32 v165, s44, v165
v_add_u32 v159, 0, v165
v_add_u32 v160, 49152, v165
v_add_u32 v161, 2048, v165
v_add_u32 v162, 51200, v165
v_add_u32 v163, 4096, v165
v_add_u32 v164, 53248, v165
s_lshl_b32 s45, s12, 12
s_lshl_b32 s48, s12, 11
s_and_b32 s42, s40, 3
s_lshl_b32 s42, s42, 9
s_mul_i32 s43, s42, 3072
s_waitcnt lgkmcnt(0)
s_mov_b32 s24, s36
s_and_b32 s25, s37, 0xffff
s_mov_b32 s26, 4194304
s_mov_b32 s27, 0x20000
s_mov_b32 s28, s38
s_and_b32 s29, s39, 0xffff
s_mov_b32 s30, 6291456
s_mov_b32 s31, 0x20000
s_add_u32 m0, s45, 0
s_nop 0
buffer_load_dwordx4 v155, s[24:27], s42 offen lds
s_add_u32 m0, s45, 1024
s_nop 0
buffer_load_dwordx4 v156, s[24:27], s42 offen lds
s_add_u32 m0, s45, 2048
s_nop 0
buffer_load_dwordx4 v157, s[24:27], s42 offen lds
s_add_u32 m0, s45, 3072
s_nop 0
buffer_load_dwordx4 v158, s[24:27], s42 offen lds
s_add_u32 m0, s48, 16384
s_nop 0
buffer_load_dwordx4 v159, s[28:31], s43 offen lds
s_add_u32 m0, s48, 17408
s_nop 0
buffer_load_dwordx4 v160, s[28:31], s43 offen lds
s_add_u32 m0, s48, 24576
s_nop 0
buffer_load_dwordx4 v161, s[28:31], s43 offen lds
s_add_u32 m0, s48, 25600
s_nop 0
buffer_load_dwordx4 v162, s[28:31], s43 offen lds
s_add_u32 m0, s48, 32768
s_nop 0
buffer_load_dwordx4 v163, s[28:31], s43 offen lds
s_add_u32 m0, s48, 33792
s_nop 0
buffer_load_dwordx4 v164, s[28:31], s43 offen lds
s_add_u32 s42, s42, 128
s_and_b32 s42, s42, 2047
s_mul_i32 s43, s42, 3072
s_mov_b32 s32, s54
s_and_b32 s33, s55, 0xffff
s_mov_b32 s34, 16777216
s_mov_b32 s35, 0x20000
v_and_b32 v165, 31, v169
v_lshrrev_b32 v166, 5, v169
v_bfe_u32 v167, v169, 1, 3
v_xor_b32 v167, v167, v166
s_lshl_b32 s44, s46, 6
v_add_u32 v165, s44, v165
v_lshlrev_b32 v165, 7, v165
v_xor_b32 v168, 0, v167
v_lshl_add_u32 v140, v168, 4, v165
v_add_u32 v144, 40960, v140
v_add_u32 v148, 81920, v140
v_xor_b32 v168, 2, v167
v_lshl_add_u32 v141, v168, 4, v165
v_add_u32 v145, 40960, v141
v_add_u32 v149, 81920, v141
v_xor_b32 v168, 4, v167
v_lshl_add_u32 v142, v168, 4, v165
v_add_u32 v146, 40960, v142
v_add_u32 v150, 81920, v142
v_xor_b32 v168, 6, v167
v_lshl_add_u32 v143, v168, 4, v165
v_add_u32 v147, 40960, v143
v_add_u32 v151, 81920, v143
v_lshrrev_b32 v165, 5, v169
v_lshlrev_b32 v165, 3, v165
v_bfe_u32 v166, v169, 2, 2
v_add_u32 v165, v165, v166
v_lshlrev_b32 v165, 7, v165
v_lshrrev_b32 v166, 1, v166
v_xor_b32 v166, s47, v166
v_lshl_add_u32 v165, v166, 6, v165
v_bfe_u32 v166, v169, 4, 1
v_lshl_add_u32 v165, v166, 5, v165
v_and_b32 v166, 3, v169
v_lshl_add_u32 v165, v166, 3, v165
v_add_u32 v152, 16384, v165
v_add_u32 v153, 40960, v152
v_add_u32 v154, 81920, v152
v_mov_b32 v4, 0
v_mov_b32 v5, 0
v_mov_b32 v6, 0
v_mov_b32 v7, 0
v_mov_b32 v8, 0
v_mov_b32 v9, 0
v_mov_b32 v10, 0
v_mov_b32 v11, 0
v_mov_b32 v12, 0
v_mov_b32 v13, 0
v_mov_b32 v14, 0
v_mov_b32 v15, 0
v_mov_b32 v16, 0
v_mov_b32 v17, 0
v_mov_b32 v18, 0
v_mov_b32 v19, 0
v_mov_b32 v20, 0
v_mov_b32 v21, 0
v_mov_b32 v22, 0
v_mov_b32 v23, 0
v_mov_b32 v24, 0
v_mov_b32 v25, 0
v_mov_b32 v26, 0
v_mov_b32 v27, 0
v_mov_b32 v28, 0
v_mov_b32 v29, 0
v_mov_b32 v30, 0
v_mov_b32 v31, 0
v_mov_b32 v32, 0
v_mov_b32 v33, 0
v_mov_b32 v34, 0
v_mov_b32 v35, 0
v_mov_b32 v36, 0
v_mov_b32 v37, 0
v_mov_b32 v38, 0
v_mov_b32 v39, 0
v_mov_b32 v40, 0
v_mov_b32 v41, 0
v_mov_b32 v42, 0
v_mov_b32 v43, 0
v_mov_b32 v44, 0
v_mov_b32 v45, 0
v_mov_b32 v46, 0
v_mov_b32 v47, 0
v_mov_b32 v48, 0
v_mov_b32 v49, 0
v_mov_b32 v50, 0
v_mov_b32 v51, 0
v_mov_b32 v52, 0
v_mov_b32 v53, 0
v_mov_b32 v54, 0
v_mov_b32 v55, 0
v_mov_b32 v56, 0
v_mov_b32 v57, 0
v_mov_b32 v58, 0
v_mov_b32 v59, 0
v_mov_b32 v60, 0
v_mov_b32 v61, 0
v_mov_b32 v62, 0
v_mov_b32 v63, 0
v_mov_b32 v64, 0
v_mov_b32 v65, 0
v_mov_b32 v66, 0
v_mov_b32 v67, 0
v_mov_b32 v68, 0
v_mov_b32 v69, 0
v_mov_b32 v70, 0
v_mov_b32 v71, 0
v_mov_b32 v72, 0
v_mov_b32 v73, 0
v_mov_b32 v74, 0
v_mov_b32 v75, 0
v_mov_b32 v76, 0
v_mov_b32 v77, 0
v_mov_b32 v78, 0
v_mov_b32 v79, 0
v_mov_b32 v80, 0
v_mov_b32 v81, 0
v_mov_b32 v82, 0
v_mov_b32 v83, 0
v_mov_b32 v84, 0
v_mov_b32 v85, 0
v_mov_b32 v86, 0
v_mov_b32 v87, 0
v_mov_b32 v88, 0
v_mov_b32 v89, 0
v_mov_b32 v90, 0
v_mov_b32 v91, 0
v_mov_b32 v92, 0
v_mov_b32 v93, 0
v_mov_b32 v94, 0
v_mov_b32 v95, 0
v_mov_b32 v96, 0
v_mov_b32 v97, 0
v_mov_b32 v98, 0
v_mov_b32 v99, 0
s_add_u32 m0, s45, 40960
s_nop 0
buffer_load_dwordx4 v155, s[24:27], s42 offen lds
s_add_u32 m0, s45, 41984
s_nop 0
buffer_load_dwordx4 v156, s[24:27], s42 offen lds
s_add_u32 m0, s45, 43008
s_nop 0
buffer_load_dwordx4 v157, s[24:27], s42 offen lds
s_add_u32 m0, s45, 44032
s_nop 0
buffer_load_dwordx4 v158, s[24:27], s42 offen lds
s_add_u32 m0, s48, 57344
s_nop 0
buffer_load_dwordx4 v159, s[28:31], s43 offen lds
s_add_u32 m0, s48, 58368
s_nop 0
buffer_load_dwordx4 v160, s[28:31], s43 offen lds
s_add_u32 m0, s48, 65536
s_nop 0
buffer_load_dwordx4 v161, s[28:31], s43 offen lds
s_add_u32 m0, s48, 66560
s_nop 0
buffer_load_dwordx4 v162, s[28:31], s43 offen lds
s_add_u32 m0, s48, 73728
s_nop 0
buffer_load_dwordx4 v163, s[28:31], s43 offen lds
s_add_u32 m0, s48, 74752
s_nop 0
buffer_load_dwordx4 v164, s[28:31], s43 offen lds
s_add_u32 s42, s42, 128
s_and_b32 s42, s42, 2047
s_mul_i32 s43, s42, 3072
s_waitcnt vmcnt(10)
s_barrier
ds_read_b128 v[100:103], v140 offset:0
ds_read_b128 v[104:107], v140 offset:4096
ds_read_b64_tr_b16 v[116:117], v152 offset:0
ds_read_b64_tr_b16 v[118:119], v152 offset:512
ds_read_b64_tr_b16 v[120:121], v152 offset:8192
ds_read_b64_tr_b16 v[122:123], v152 offset:8704
ds_read_b64_tr_b16 v[124:125], v152 offset:16384
ds_read_b64_tr_b16 v[126:127], v152 offset:16896
s_waitcnt lgkmcnt(0)
v_mfma_f32_32x32x16_bf16 v[4:19], v[116:119], v[100:103], v[4:19]
ds_read_b128 v[108:111], v141 offset:0
ds_read_b128 v[112:115], v141 offset:4096
v_mfma_f32_32x32x16_bf16 v[52:67], v[116:119], v[104:107], v[52:67]
ds_read_b64_tr_b16 v[128:129], v152 offset:2048
ds_read_b64_tr_b16 v[130:131], v152 offset:2560
v_mfma_f32_32x32x16_bf16 v[20:35], v[120:123], v[100:103], v[20:35]
ds_read_b64_tr_b16 v[132:133], v152 offset:10240
ds_read_b64_tr_b16 v[134:135], v152 offset:10752
v_mfma_f32_32x32x16_bf16 v[68:83], v[120:123], v[104:107], v[68:83]
ds_read_b64_tr_b16 v[136:137], v152 offset:18432
ds_read_b64_tr_b16 v[138:139], v152 offset:18944
s_add_u32 m0, s45, 81920
s_nop 0
buffer_load_dwordx4 v155, s[24:27], s42 offen lds
v_mfma_f32_32x32x16_bf16 v[36:51], v[100:103], v[124:127], v[36:51]
s_add_u32 m0, s45, 82944
s_nop 0
buffer_load_dwordx4 v156, s[24:27], s42 offen lds
v_mfma_f32_32x32x16_bf16 v[84:99], v[104:107], v[124:127], v[84:99]
s_add_u32 m0, s45, 83968
s_nop 0
buffer_load_dwordx4 v157, s[24:27], s42 offen lds
s_waitcnt lgkmcnt(0)
v_mfma_f32_32x32x16_bf16 v[4:19], v[128:131], v[108:111], v[4:19]
ds_read_b128 v[100:103], v142 offset:0
ds_read_b128 v[104:107], v142 offset:4096
v_mfma_f32_32x32x16_bf16 v[52:67], v[128:131], v[112:115], v[52:67]
ds_read_b64_tr_b16 v[116:117], v152 offset:4096
ds_read_b64_tr_b16 v[118:119], v152 offset:4608
v_mfma_f32_32x32x16_bf16 v[20:35], v[132:135], v[108:111], v[20:35]
ds_read_b64_tr_b16 v[120:121], v152 offset:12288
ds_read_b64_tr_b16 v[122:123], v152 offset:12800
v_mfma_f32_32x32x16_bf16 v[68:83], v[132:135], v[112:115], v[68:83]
ds_read_b64_tr_b16 v[124:125], v152 offset:20480
ds_read_b64_tr_b16 v[126:127], v152 offset:20992
s_add_u32 m0, s45, 84992
s_nop 0
buffer_load_dwordx4 v158, s[24:27], s42 offen lds
v_mfma_f32_32x32x16_bf16 v[36:51], v[108:111], v[136:139], v[36:51]
s_add_u32 m0, s48, 98304
s_nop 0
buffer_load_dwordx4 v159, s[28:31], s43 offen lds
v_mfma_f32_32x32x16_bf16 v[84:99], v[112:115], v[136:139], v[84:99]
s_add_u32 m0, s48, 99328
s_nop 0
buffer_load_dwordx4 v160, s[28:31], s43 offen lds
s_waitcnt lgkmcnt(0)
v_mfma_f32_32x32x16_bf16 v[4:19], v[116:119], v[100:103], v[4:19]
ds_read_b128 v[108:111], v143 offset:0
ds_read_b128 v[112:115], v143 offset:4096
v_mfma_f32_32x32x16_bf16 v[52:67], v[116:119], v[104:107], v[52:67]
ds_read_b64_tr_b16 v[128:129], v152 offset:6144
ds_read_b64_tr_b16 v[130:131], v152 offset:6656
v_mfma_f32_32x32x16_bf16 v[20:35], v[120:123], v[100:103], v[20:35]
ds_read_b64_tr_b16 v[132:133], v152 offset:14336
ds_read_b64_tr_b16 v[134:135], v152 offset:14848
v_mfma_f32_32x32x16_bf16 v[68:83], v[120:123], v[104:107], v[68:83]
ds_read_b64_tr_b16 v[136:137], v152 offset:22528
ds_read_b64_tr_b16 v[138:139], v152 offset:23040
s_add_u32 m0, s48, 106496
s_nop 0
buffer_load_dwordx4 v161, s[28:31], s43 offen lds
v_mfma_f32_32x32x16_bf16 v[36:51], v[100:103], v[124:127], v[36:51]
s_add_u32 m0, s48, 107520
s_nop 0
buffer_load_dwordx4 v162, s[28:31], s43 offen lds
v_mfma_f32_32x32x16_bf16 v[84:99], v[104:107], v[124:127], v[84:99]
s_add_u32 m0, s48, 114688
s_nop 0
buffer_load_dwordx4 v163, s[28:31], s43 offen lds
s_waitcnt lgkmcnt(0)
s_waitcnt vmcnt(9)
s_barrier
v_mfma_f32_32x32x16_bf16 v[4:19], v[128:131], v[108:111], v[4:19]
ds_read_b128 v[100:103], v144 offset:0
ds_read_b128 v[104:107], v144 offset:4096
v_mfma_f32_32x32x16_bf16 v[52:67], v[128:131], v[112:115], v[52:67]
ds_read_b64_tr_b16 v[116:117], v153 offset:0
ds_read_b64_tr_b16 v[118:119], v153 offset:512
v_mfma_f32_32x32x16_bf16 v[20:35], v[132:135], v[108:111], v[20:35]
ds_read_b64_tr_b16 v[120:121], v153 offset:8192
ds_read_b64_tr_b16 v[122:123], v153 offset:8704
v_mfma_f32_32x32x16_bf16 v[68:83], v[132:135], v[112:115], v[68:83]
ds_read_b64_tr_b16 v[124:125], v153 offset:16384
ds_read_b64_tr_b16 v[126:127], v153 offset:16896
s_add_u32 m0, s48, 115712
s_nop 0
buffer_load_dwordx4 v164, s[28:31], s43 offen lds
v_mfma_f32_32x32x16_bf16 v[36:51], v[108:111], v[136:139], v[36:51]
s_add_u32 s42, s42, 128
s_and_b32 s42, s42, 2047
s_mul_i32 s43, s42, 3072
v_mfma_f32_32x32x16_bf16 v[84:99], v[112:115], v[136:139], v[84:99]
s_add_u32 m0, s45, 0
s_nop 0
buffer_load_dwordx4 v155, s[24:27], s42 offen lds
s_add_u32 m0, s45, 1024
s_nop 0
buffer_load_dwordx4 v156, s[24:27], s42 offen lds
s_waitcnt lgkmcnt(0)
v_mfma_f32_32x32x16_bf16 v[4:19], v[116:119], v[100:103], v[4:19]
ds_read_b128 v[108:111], v145 offset:0
ds_read_b128 v[112:115], v145 offset:4096
v_mfma_f32_32x32x16_bf16 v[52:67], v[116:119], v[104:107], v[52:67]
ds_read_b64_tr_b16 v[128:129], v153 offset:2048
ds_read_b64_tr_b16 v[130:131], v153 offset:2560
v_mfma_f32_32x32x16_bf16 v[20:35], v[120:123], v[100:103], v[20:35]
ds_read_b64_tr_b16 v[132:133], v153 offset:10240
ds_read_b64_tr_b16 v[134:135], v153 offset:10752
v_mfma_f32_32x32x16_bf16 v[68:83], v[120:123], v[104:107], v[68:83]
ds_read_b64_tr_b16 v[136:137], v153 offset:18432
ds_read_b64_tr_b16 v[138:139], v153 offset:18944
s_add_u32 m0, s45, 2048
s_nop 0
buffer_load_dwordx4 v157, s[24:27], s42 offen lds
v_mfma_f32_32x32x16_bf16 v[36:51], v[100:103], v[124:127], v[36:51]
s_add_u32 m0, s45, 3072
s_nop 0
buffer_load_dwordx4 v158, s[24:27], s42 offen lds
v_mfma_f32_32x32x16_bf16 v[84:99], v[104:107], v[124:127], v[84:99]
s_add_u32 m0, s48, 16384
s_nop 0
buffer_load_dwordx4 v159, s[28:31], s43 offen lds
s_waitcnt lgkmcnt(0)
v_mfma_f32_32x32x16_bf16 v[4:19], v[128:131], v[108:111], v[4:19]
ds_read_b128 v[100:103], v146 offset:0
ds_read_b128 v[104:107], v146 offset:4096
v_mfma_f32_32x32x16_bf16 v[52:67], v[128:131], v[112:115], v[52:67]
ds_read_b64_tr_b16 v[116:117], v153 offset:4096
ds_read_b64_tr_b16 v[118:119], v153 offset:4608
v_mfma_f32_32x32x16_bf16 v[20:35], v[132:135], v[108:111], v[20:35]
ds_read_b64_tr_b16 v[120:121], v153 offset:12288
ds_read_b64_tr_b16 v[122:123], v153 offset:12800
v_mfma_f32_32x32x16_bf16 v[68:83], v[132:135], v[112:115], v[68:83]
ds_read_b64_tr_b16 v[124:125], v153 offset:20480
ds_read_b64_tr_b16 v[126:127], v153 offset:20992
s_add_u32 m0, s48, 17408
s_nop 0
buffer_load_dwordx4 v160, s[28:31], s43 offen lds
v_mfma_f32_32x32x16_bf16 v[36:51], v[108:111], v[136:139], v[36:51]
s_add_u32 m0, s48, 24576
s_nop 0
buffer_load_dwordx4 v161, s[28:31], s43 offen lds
v_mfma_f32_32x32x16_bf16 v[84:99], v[112:115], v[136:139], v[84:99]
s_add_u32 m0, s48, 25600
s_nop 0
buffer_load_dwordx4 v162, s[28:31], s43 offen lds
s_waitcnt lgkmcnt(0)
v_mfma_f32_32x32x16_bf16 v[4:19], v[116:119], v[100:103], v[4:19]
ds_read_b128 v[108:111], v147 offset:0
ds_read_b128 v[112:115], v147 offset:4096
v_mfma_f32_32x32x16_bf16 v[52:67], v[116:119], v[104:107], v[52:67]
ds_read_b64_tr_b16 v[128:129], v153 offset:6144
ds_read_b64_tr_b16 v[130:131], v153 offset:6656
v_mfma_f32_32x32x16_bf16 v[20:35], v[120:123], v[100:103], v[20:35]
ds_read_b64_tr_b16 v[132:133], v153 offset:14336
ds_read_b64_tr_b16 v[134:135], v153 offset:14848
v_mfma_f32_32x32x16_bf16 v[68:83], v[120:123], v[104:107], v[68:83]
ds_read_b64_tr_b16 v[136:137], v153 offset:22528
ds_read_b64_tr_b16 v[138:139], v153 offset:23040
s_add_u32 m0, s48, 32768
s_nop 0
buffer_load_dwordx4 v163, s[28:31], s43 offen lds
v_mfma_f32_32x32x16_bf16 v[36:51], v[100:103], v[124:127], v[36:51]
s_add_u32 m0, s48, 33792
s_nop 0
buffer_load_dwordx4 v164, s[28:31], s43 offen lds
v_mfma_f32_32x32x16_bf16 v[84:99], v[104:107], v[124:127], v[84:99]
s_add_u32 s42, s42, 128
s_and_b32 s42, s42, 2047
s_mul_i32 s43, s42, 3072
s_waitcnt lgkmcnt(0)
s_waitcnt vmcnt(10)
s_barrier
v_mfma_f32_32x32x16_bf16 v[4:19], v[128:131], v[108:111], v[4:19]
ds_read_b128 v[100:103], v148 offset:0
ds_read_b128 v[104:107], v148 offset:4096
v_mfma_f32_32x32x16_bf16 v[52:67], v[128:131], v[112:115], v[52:67]
ds_read_b64_tr_b16 v[116:117], v154 offset:0
ds_read_b64_tr_b16 v[118:119], v154 offset:512
v_mfma_f32_32x32x16_bf16 v[20:35], v[132:135], v[108:111], v[20:35]
ds_read_b64_tr_b16 v[120:121], v154 offset:8192
ds_read_b64_tr_b16 v[122:123], v154 offset:8704
v_mfma_f32_32x32x16_bf16 v[68:83], v[132:135], v[112:115], v[68:83]
ds_read_b64_tr_b16 v[124:125], v154 offset:16384
ds_read_b64_tr_b16 v[126:127], v154 offset:16896
s_add_u32 m0, s45, 40960
s_nop 0
buffer_load_dwordx4 v155, s[24:27], s42 offen lds
v_mfma_f32_32x32x16_bf16 v[36:51], v[108:111], v[136:139], v[36:51]
s_add_u32 m0, s45, 41984
s_nop 0
buffer_load_dwordx4 v156, s[24:27], s42 offen lds
v_mfma_f32_32x32x16_bf16 v[84:99], v[112:115], v[136:139], v[84:99]
s_add_u32 m0, s45, 43008
s_nop 0
buffer_load_dwordx4 v157, s[24:27], s42 offen lds
s_waitcnt lgkmcnt(0)
v_mfma_f32_32x32x16_bf16 v[4:19], v[116:119], v[100:103], v[4:19]
ds_read_b128 v[108:111], v149 offset:0
ds_read_b128 v[112:115], v149 offset:4096
v_mfma_f32_32x32x16_bf16 v[52:67], v[116:119], v[104:107], v[52:67]
ds_read_b64_tr_b16 v[128:129], v154 offset:2048
ds_read_b64_tr_b16 v[130:131], v154 offset:2560
v_mfma_f32_32x32x16_bf16 v[20:35], v[120:123], v[100:103], v[20:35]
ds_read_b64_tr_b16 v[132:133], v154 offset:10240
ds_read_b64_tr_b16 v[134:135], v154 offset:10752
v_mfma_f32_32x32x16_bf16 v[68:83], v[120:123], v[104:107], v[68:83]
ds_read_b64_tr_b16 v[136:137], v154 offset:18432
ds_read_b64_tr_b16 v[138:139], v154 offset:18944
s_add_u32 m0, s45, 44032
s_nop 0
buffer_load_dwordx4 v158, s[24:27], s42 offen lds
v_mfma_f32_32x32x16_bf16 v[36:51], v[100:103], v[124:127], v[36:51]
s_add_u32 m0, s48, 57344
s_nop 0
buffer_load_dwordx4 v159, s[28:31], s43 offen lds
v_mfma_f32_32x32x16_bf16 v[84:99], v[104:107], v[124:127], v[84:99]
s_add_u32 m0, s48, 58368
s_nop 0
buffer_load_dwordx4 v160, s[28:31], s43 offen lds
s_waitcnt lgkmcnt(0)
v_mfma_f32_32x32x16_bf16 v[4:19], v[128:131], v[108:111], v[4:19]
ds_read_b128 v[100:103], v150 offset:0
ds_read_b128 v[104:107], v150 offset:4096
v_mfma_f32_32x32x16_bf16 v[52:67], v[128:131], v[112:115], v[52:67]
ds_read_b64_tr_b16 v[116:117], v154 offset:4096
ds_read_b64_tr_b16 v[118:119], v154 offset:4608
v_mfma_f32_32x32x16_bf16 v[20:35], v[132:135], v[108:111], v[20:35]
ds_read_b64_tr_b16 v[120:121], v154 offset:12288
ds_read_b64_tr_b16 v[122:123], v154 offset:12800
v_mfma_f32_32x32x16_bf16 v[68:83], v[132:135], v[112:115], v[68:83]
ds_read_b64_tr_b16 v[124:125], v154 offset:20480
ds_read_b64_tr_b16 v[126:127], v154 offset:20992
s_add_u32 m0, s48, 65536
s_nop 0
buffer_load_dwordx4 v161, s[28:31], s43 offen lds
v_mfma_f32_32x32x16_bf16 v[36:51], v[108:111], v[136:139], v[36:51]
s_add_u32 m0, s48, 66560
s_nop 0
buffer_load_dwordx4 v162, s[28:31], s43 offen lds
v_mfma_f32_32x32x16_bf16 v[84:99], v[112:115], v[136:139], v[84:99]
s_add_u32 m0, s48, 73728
s_nop 0
buffer_load_dwordx4 v163, s[28:31], s43 offen lds
s_waitcnt lgkmcnt(0)
v_mfma_f32_32x32x16_bf16 v[4:19], v[116:119], v[100:103], v[4:19]
ds_read_b128 v[108:111], v151 offset:0
ds_read_b128 v[112:115], v151 offset:4096
v_mfma_f32_32x32x16_bf16 v[52:67], v[116:119], v[104:107], v[52:67]
ds_read_b64_tr_b16 v[128:129], v154 offset:6144
ds_read_b64_tr_b16 v[130:131], v154 offset:6656
v_mfma_f32_32x32x16_bf16 v[20:35], v[120:123], v[100:103], v[20:35]
ds_read_b64_tr_b16 v[132:133], v154 offset:14336
ds_read_b64_tr_b16 v[134:135], v154 offset:14848
v_mfma_f32_32x32x16_bf16 v[68:83], v[120:123], v[104:107], v[68:83]
ds_read_b64_tr_b16 v[136:137], v154 offset:22528
ds_read_b64_tr_b16 v[138:139], v154 offset:23040
s_add_u32 m0, s48, 74752
s_nop 0
buffer_load_dwordx4 v164, s[28:31], s43 offen lds
v_mfma_f32_32x32x16_bf16 v[36:51], v[100:103], v[124:127], v[36:51]
s_add_u32 s42, s42, 128
s_and_b32 s42, s42, 2047
s_mul_i32 s43, s42, 3072
v_mfma_f32_32x32x16_bf16 v[84:99], v[104:107], v[124:127], v[84:99]
s_waitcnt lgkmcnt(0)
s_waitcnt vmcnt(10)
s_barrier
v_mfma_f32_32x32x16_bf16 v[4:19], v[128:131], v[108:111], v[4:19]
ds_read_b128 v[100:103], v140 offset:0
ds_read_b128 v[104:107], v140 offset:4096
v_mfma_f32_32x32x16_bf16 v[52:67], v[128:131], v[112:115], v[52:67]
ds_read_b64_tr_b16 v[116:117], v152 offset:0
ds_read_b64_tr_b16 v[118:119], v152 offset:512
v_mfma_f32_32x32x16_bf16 v[20:35], v[132:135], v[108:111], v[20:35]
ds_read_b64_tr_b16 v[120:121], v152 offset:8192
ds_read_b64_tr_b16 v[122:123], v152 offset:8704
v_mfma_f32_32x32x16_bf16 v[68:83], v[132:135], v[112:115], v[68:83]
ds_read_b64_tr_b16 v[124:125], v152 offset:16384
ds_read_b64_tr_b16 v[126:127], v152 offset:16896
s_add_u32 m0, s45, 81920
s_nop 0
buffer_load_dwordx4 v155, s[24:27], s42 offen lds
v_mfma_f32_32x32x16_bf16 v[36:51], v[108:111], v[136:139], v[36:51]
s_add_u32 m0, s45, 82944
s_nop 0
buffer_load_dwordx4 v156, s[24:27], s42 offen lds
v_mfma_f32_32x32x16_bf16 v[84:99], v[112:115], v[136:139], v[84:99]
s_add_u32 m0, s45, 83968
s_nop 0
buffer_load_dwordx4 v157, s[24:27], s42 offen lds
s_waitcnt lgkmcnt(0)
v_mfma_f32_32x32x16_bf16 v[4:19], v[116:119], v[100:103], v[4:19]
ds_read_b128 v[108:111], v141 offset:0
ds_read_b128 v[112:115], v141 offset:4096
v_mfma_f32_32x32x16_bf16 v[52:67], v[116:119], v[104:107], v[52:67]
ds_read_b64_tr_b16 v[128:129], v152 offset:2048
ds_read_b64_tr_b16 v[130:131], v152 offset:2560
v_mfma_f32_32x32x16_bf16 v[20:35], v[120:123], v[100:103], v[20:35]
ds_read_b64_tr_b16 v[132:133], v152 offset:10240
ds_read_b64_tr_b16 v[134:135], v152 offset:10752
v_mfma_f32_32x32x16_bf16 v[68:83], v[120:123], v[104:107], v[68:83]
ds_read_b64_tr_b16 v[136:137], v152 offset:18432
ds_read_b64_tr_b16 v[138:139], v152 offset:18944
s_add_u32 m0, s45, 84992
s_nop 0
buffer_load_dwordx4 v158, s[24:27], s42 offen lds
v_mfma_f32_32x32x16_bf16 v[36:51], v[100:103], v[124:127], v[36:51]
s_add_u32 m0, s48, 98304
s_nop 0
buffer_load_dwordx4 v159, s[28:31], s43 offen lds
v_mfma_f32_32x32x16_bf16 v[84:99], v[104:107], v[124:127], v[84:99]
s_add_u32 m0, s48, 99328
s_nop 0
buffer_load_dwordx4 v160, s[28:31], s43 offen lds
s_waitcnt lgkmcnt(0)
v_mfma_f32_32x32x16_bf16 v[4:19], v[128:131], v[108:111], v[4:19]
ds_read_b128 v[100:103], v142 offset:0
ds_read_b128 v[104:107], v142 offset:4096
v_mfma_f32_32x32x16_bf16 v[52:67], v[128:131], v[112:115], v[52:67]
ds_read_b64_tr_b16 v[116:117], v152 offset:4096
ds_read_b64_tr_b16 v[118:119], v152 offset:4608
v_mfma_f32_32x32x16_bf16 v[20:35], v[132:135], v[108:111], v[20:35]
ds_read_b64_tr_b16 v[120:121], v152 offset:12288
ds_read_b64_tr_b16 v[122:123], v152 offset:12800
v_mfma_f32_32x32x16_bf16 v[68:83], v[132:135], v[112:115], v[68:83]
ds_read_b64_tr_b16 v[124:125], v152 offset:20480
ds_read_b64_tr_b16 v[126:127], v152 offset:20992
s_add_u32 m0, s48, 106496
s_nop 0
buffer_load_dwordx4 v161, s[28:31], s43 offen lds
v_mfma_f32_32x32x16_bf16 v[36:51], v[108:111], v[136:139], v[36:51]
s_add_u32 m0, s48, 107520
s_nop 0
buffer_load_dwordx4 v162, s[28:31], s43 offen lds
v_mfma_f32_32x32x16_bf16 v[84:99], v[112:115], v[136:139], v[84:99]
s_add_u32 m0, s48, 114688
s_nop 0
buffer_load_dwordx4 v163, s[28:31], s43 offen lds
s_waitcnt lgkmcnt(0)
v_mfma_f32_32x32x16_bf16 v[4:19], v[116:119], v[100:103], v[4:19]
ds_read_b128 v[108:111], v143 offset:0
ds_read_b128 v[112:115], v143 offset:4096
v_mfma_f32_32x32x16_bf16 v[52:67], v[116:119], v[104:107], v[52:67]
ds_read_b64_tr_b16 v[128:129], v152 offset:6144
ds_read_b64_tr_b16 v[130:131], v152 offset:6656
v_mfma_f32_32x32x16_bf16 v[20:35], v[120:123], v[100:103], v[20:35]
ds_read_b64_tr_b16 v[132:133], v152 offset:14336
ds_read_b64_tr_b16 v[134:135], v152 offset:14848
v_mfma_f32_32x32x16_bf16 v[68:83], v[120:123], v[104:107], v[68:83]
ds_read_b64_tr_b16 v[136:137], v152 offset:22528
ds_read_b64_tr_b16 v[138:139], v152 offset:23040
s_add_u32 m0, s48, 115712
s_nop 0
buffer_load_dwordx4 v164, s[28:31], s43 offen lds
v_mfma_f32_32x32x16_bf16 v[36:51], v[100:103], v[124:127], v[36:51]
s_add_u32 s42, s42, 128
s_and_b32 s42, s42, 2047
s_mul_i32 s43, s42, 3072
v_mfma_f32_32x32x16_bf16 v[84:99], v[104:107], v[124:127], v[84:99]
s_waitcnt lgkmcnt(0)
s_waitcnt vmcnt(10)
s_barrier
v_mfma_f32_32x32x16_bf16 v[4:19], v[128:131], v[108:111], v[4:19]
ds_read_b128 v[100:103], v144 offset:0
ds_read_b128 v[104:107], v144 offset:4096
v_mfma_f32_32x32x16_bf16 v[52:67], v[128:131], v[112:115], v[52:67]
ds_read_b64_tr_b16 v[116:117], v153 offset:0
ds_read_b64_tr_b16 v[118:119], v153 offset:512
v_mfma_f32_32x32x16_bf16 v[20:35], v[132:135], v[108:111], v[20:35]
ds_read_b64_tr_b16 v[120:121], v153 offset:8192
ds_read_b64_tr_b16 v[122:123], v153 offset:8704
v_mfma_f32_32x32x16_bf16 v[68:83], v[132:135], v[112:115], v[68:83]
ds_read_b64_tr_b16 v[124:125], v153 offset:16384
ds_read_b64_tr_b16 v[126:127], v153 offset:16896
s_add_u32 m0, s45, 0
s_nop 0
buffer_load_dwordx4 v155, s[24:27], s42 offen lds
v_mfma_f32_32x32x16_bf16 v[36:51], v[108:111], v[136:139], v[36:51]
s_add_u32 m0, s45, 1024
s_nop 0
buffer_load_dwordx4 v156, s[24:27], s42 offen lds
v_mfma_f32_32x32x16_bf16 v[84:99], v[112:115], v[136:139], v[84:99]
s_add_u32 m0, s45, 2048
s_nop 0
buffer_load_dwordx4 v157, s[24:27], s42 offen lds
s_waitcnt lgkmcnt(0)
v_mfma_f32_32x32x16_bf16 v[4:19], v[116:119], v[100:103], v[4:19]
ds_read_b128 v[108:111], v145 offset:0
ds_read_b128 v[112:115], v145 offset:4096
v_mfma_f32_32x32x16_bf16 v[52:67], v[116:119], v[104:107], v[52:67]
ds_read_b64_tr_b16 v[128:129], v153 offset:2048
ds_read_b64_tr_b16 v[130:131], v153 offset:2560
v_mfma_f32_32x32x16_bf16 v[20:35], v[120:123], v[100:103], v[20:35]
ds_read_b64_tr_b16 v[132:133], v153 offset:10240
ds_read_b64_tr_b16 v[134:135], v153 offset:10752
v_mfma_f32_32x32x16_bf16 v[68:83], v[120:123], v[104:107], v[68:83]
ds_read_b64_tr_b16 v[136:137], v153 offset:18432
ds_read_b64_tr_b16 v[138:139], v153 offset:18944
s_add_u32 m0, s45, 3072
s_nop 0
buffer_load_dwordx4 v158, s[24:27], s42 offen lds
v_mfma_f32_32x32x16_bf16 v[36:51], v[100:103], v[124:127], v[36:51]
s_add_u32 m0, s48, 16384
s_nop 0
buffer_load_dwordx4 v159, s[28:31], s43 offen lds
v_mfma_f32_32x32x16_bf16 v[84:99], v[104:107], v[124:127], v[84:99]
s_add_u32 m0, s48, 17408
s_nop 0
buffer_load_dwordx4 v160, s[28:31], s43 offen lds
s_waitcnt lgkmcnt(0)
v_mfma_f32_32x32x16_bf16 v[4:19], v[128:131], v[108:111], v[4:19]
ds_read_b128 v[100:103], v146 offset:0
ds_read_b128 v[104:107], v146 offset:4096
v_mfma_f32_32x32x16_bf16 v[52:67], v[128:131], v[112:115], v[52:67]
ds_read_b64_tr_b16 v[116:117], v153 offset:4096
ds_read_b64_tr_b16 v[118:119], v153 offset:4608
v_mfma_f32_32x32x16_bf16 v[20:35], v[132:135], v[108:111], v[20:35]
ds_read_b64_tr_b16 v[120:121], v153 offset:12288
ds_read_b64_tr_b16 v[122:123], v153 offset:12800
v_mfma_f32_32x32x16_bf16 v[68:83], v[132:135], v[112:115], v[68:83]
ds_read_b64_tr_b16 v[124:125], v153 offset:20480
ds_read_b64_tr_b16 v[126:127], v153 offset:20992
s_add_u32 m0, s48, 24576
s_nop 0
buffer_load_dwordx4 v161, s[28:31], s43 offen lds
v_mfma_f32_32x32x16_bf16 v[36:51], v[108:111], v[136:139], v[36:51]
s_add_u32 m0, s48, 25600
s_nop 0
buffer_load_dwordx4 v162, s[28:31], s43 offen lds
v_mfma_f32_32x32x16_bf16 v[84:99], v[112:115], v[136:139], v[84:99]
s_add_u32 m0, s48, 32768
s_nop 0
buffer_load_dwordx4 v163, s[28:31], s43 offen lds
s_waitcnt lgkmcnt(0)
v_mfma_f32_32x32x16_bf16 v[4:19], v[116:119], v[100:103], v[4:19]
ds_read_b128 v[108:111], v147 offset:0
ds_read_b128 v[112:115], v147 offset:4096
v_mfma_f32_32x32x16_bf16 v[52:67], v[116:119], v[104:107], v[52:67]
ds_read_b64_tr_b16 v[128:129], v153 offset:6144
ds_read_b64_tr_b16 v[130:131], v153 offset:6656
v_mfma_f32_32x32x16_bf16 v[20:35], v[120:123], v[100:103], v[20:35]
ds_read_b64_tr_b16 v[132:133], v153 offset:14336
ds_read_b64_tr_b16 v[134:135], v153 offset:14848
v_mfma_f32_32x32x16_bf16 v[68:83], v[120:123], v[104:107], v[68:83]
ds_read_b64_tr_b16 v[136:137], v153 offset:22528
ds_read_b64_tr_b16 v[138:139], v153 offset:23040
s_add_u32 m0, s48, 33792
s_nop 0
buffer_load_dwordx4 v164, s[28:31], s43 offen lds
v_mfma_f32_32x32x16_bf16 v[36:51], v[100:103], v[124:127], v[36:51]
s_add_u32 s42, s42, 128
s_and_b32 s42, s42, 2047
s_mul_i32 s43, s42, 3072
v_mfma_f32_32x32x16_bf16 v[84:99], v[104:107], v[124:127], v[84:99]
s_waitcnt lgkmcnt(0)
s_waitcnt vmcnt(10)
s_barrier
v_mfma_f32_32x32x16_bf16 v[4:19], v[128:131], v[108:111], v[4:19]
ds_read_b128 v[100:103], v148 offset:0
ds_read_b128 v[104:107], v148 offset:4096
v_mfma_f32_32x32x16_bf16 v[52:67], v[128:131], v[112:115], v[52:67]
ds_read_b64_tr_b16 v[116:117], v154 offset:0
ds_read_b64_tr_b16 v[118:119], v154 offset:512
v_mfma_f32_32x32x16_bf16 v[20:35], v[132:135], v[108:111], v[20:35]
ds_read_b64_tr_b16 v[120:121], v154 offset:8192
ds_read_b64_tr_b16 v[122:123], v154 offset:8704
v_mfma_f32_32x32x16_bf16 v[68:83], v[132:135], v[112:115], v[68:83]
ds_read_b64_tr_b16 v[124:125], v154 offset:16384
ds_read_b64_tr_b16 v[126:127], v154 offset:16896
s_add_u32 m0, s45, 40960
s_nop 0
buffer_load_dwordx4 v155, s[24:27], s42 offen lds
v_mfma_f32_32x32x16_bf16 v[36:51], v[108:111], v[136:139], v[36:51]
s_add_u32 m0, s45, 41984
s_nop 0
buffer_load_dwordx4 v156, s[24:27], s42 offen lds
v_mfma_f32_32x32x16_bf16 v[84:99], v[112:115], v[136:139], v[84:99]
s_add_u32 m0, s45, 43008
s_nop 0
buffer_load_dwordx4 v157, s[24:27], s42 offen lds
s_waitcnt lgkmcnt(0)
v_mfma_f32_32x32x16_bf16 v[4:19], v[116:119], v[100:103], v[4:19]
ds_read_b128 v[108:111], v149 offset:0
ds_read_b128 v[112:115], v149 offset:4096
v_mfma_f32_32x32x16_bf16 v[52:67], v[116:119], v[104:107], v[52:67]
ds_read_b64_tr_b16 v[128:129], v154 offset:2048
ds_read_b64_tr_b16 v[130:131], v154 offset:2560
v_mfma_f32_32x32x16_bf16 v[20:35], v[120:123], v[100:103], v[20:35]
ds_read_b64_tr_b16 v[132:133], v154 offset:10240
ds_read_b64_tr_b16 v[134:135], v154 offset:10752
v_mfma_f32_32x32x16_bf16 v[68:83], v[120:123], v[104:107], v[68:83]
ds_read_b64_tr_b16 v[136:137], v154 offset:18432
ds_read_b64_tr_b16 v[138:139], v154 offset:18944
s_add_u32 m0, s45, 44032
s_nop 0
buffer_load_dwordx4 v158, s[24:27], s42 offen lds
v_mfma_f32_32x32x16_bf16 v[36:51], v[100:103], v[124:127], v[36:51]
s_add_u32 m0, s48, 57344
s_nop 0
buffer_load_dwordx4 v159, s[28:31], s43 offen lds
v_mfma_f32_32x32x16_bf16 v[84:99], v[104:107], v[124:127], v[84:99]
s_add_u32 m0, s48, 58368
s_nop 0
buffer_load_dwordx4 v160, s[28:31], s43 offen lds
s_waitcnt lgkmcnt(0)
v_mfma_f32_32x32x16_bf16 v[4:19], v[128:131], v[108:111], v[4:19]
ds_read_b128 v[100:103], v150 offset:0
ds_read_b128 v[104:107], v150 offset:4096
v_mfma_f32_32x32x16_bf16 v[52:67], v[128:131], v[112:115], v[52:67]
ds_read_b64_tr_b16 v[116:117], v154 offset:4096
ds_read_b64_tr_b16 v[118:119], v154 offset:4608
v_mfma_f32_32x32x16_bf16 v[20:35], v[132:135], v[108:111], v[20:35]
ds_read_b64_tr_b16 v[120:121], v154 offset:12288
ds_read_b64_tr_b16 v[122:123], v154 offset:12800
v_mfma_f32_32x32x16_bf16 v[68:83], v[132:135], v[112:115], v[68:83]
ds_read_b64_tr_b16 v[124:125], v154 offset:20480
ds_read_b64_tr_b16 v[126:127], v154 offset:20992
s_add_u32 m0, s48, 65536
s_nop 0
buffer_load_dwordx4 v161, s[28:31], s43 offen lds
v_mfma_f32_32x32x16_bf16 v[36:51], v[108:111], v[136:139], v[36:51]
s_add_u32 m0, s48, 66560
s_nop 0
buffer_load_dwordx4 v162, s[28:31], s43 offen lds
v_mfma_f32_32x32x16_bf16 v[84:99], v[112:115], v[136:139], v[84:99]
s_add_u32 m0, s48, 73728
s_nop 0
buffer_load_dwordx4 v163, s[28:31], s43 offen lds
s_waitcnt lgkmcnt(0)
v_mfma_f32_32x32x16_bf16 v[4:19], v[116:119], v[100:103], v[4:19]
ds_read_b128 v[108:111], v151 offset:0
ds_read_b128 v[112:115], v151 offset:4096
v_mfma_f32_32x32x16_bf16 v[52:67], v[116:119], v[104:107], v[52:67]
ds_read_b64_tr_b16 v[128:129], v154 offset:6144
ds_read_b64_tr_b16 v[130:131], v154 offset:6656
v_mfma_f32_32x32x16_bf16 v[20:35], v[120:123], v[100:103], v[20:35]
ds_read_b64_tr_b16 v[132:133], v154 offset:14336
ds_read_b64_tr_b16 v[134:135], v154 offset:14848
v_mfma_f32_32x32x16_bf16 v[68:83], v[120:123], v[104:107], v[68:83]
ds_read_b64_tr_b16 v[136:137], v154 offset:22528
ds_read_b64_tr_b16 v[138:139], v154 offset:23040
s_add_u32 m0, s48, 74752
s_nop 0
buffer_load_dwordx4 v164, s[28:31], s43 offen lds
v_mfma_f32_32x32x16_bf16 v[36:51], v[100:103], v[124:127], v[36:51]
s_add_u32 s42, s42, 128
s_and_b32 s42, s42, 2047
s_mul_i32 s43, s42, 3072
v_mfma_f32_32x32x16_bf16 v[84:99], v[104:107], v[124:127], v[84:99]
s_waitcnt lgkmcnt(0)
s_waitcnt vmcnt(10)
s_barrier
v_mfma_f32_32x32x16_bf16 v[4:19], v[128:131], v[108:111], v[4:19]
ds_read_b128 v[100:103], v140 offset:0
ds_read_b128 v[104:107], v140 offset:4096
v_mfma_f32_32x32x16_bf16 v[52:67], v[128:131], v[112:115], v[52:67]
ds_read_b64_tr_b16 v[116:117], v152 offset:0
ds_read_b64_tr_b16 v[118:119], v152 offset:512
v_mfma_f32_32x32x16_bf16 v[20:35], v[132:135], v[108:111], v[20:35]
ds_read_b64_tr_b16 v[120:121], v152 offset:8192
ds_read_b64_tr_b16 v[122:123], v152 offset:8704
v_mfma_f32_32x32x16_bf16 v[68:83], v[132:135], v[112:115], v[68:83]
ds_read_b64_tr_b16 v[124:125], v152 offset:16384
ds_read_b64_tr_b16 v[126:127], v152 offset:16896
s_add_u32 m0, s45, 81920
s_nop 0
buffer_load_dwordx4 v155, s[24:27], s42 offen lds
v_mfma_f32_32x32x16_bf16 v[36:51], v[108:111], v[136:139], v[36:51]
s_add_u32 m0, s45, 82944
s_nop 0
buffer_load_dwordx4 v156, s[24:27], s42 offen lds
v_mfma_f32_32x32x16_bf16 v[84:99], v[112:115], v[136:139], v[84:99]
s_add_u32 m0, s45, 83968
s_nop 0
buffer_load_dwordx4 v157, s[24:27], s42 offen lds
s_waitcnt lgkmcnt(0)
v_mfma_f32_32x32x16_bf16 v[4:19], v[116:119], v[100:103], v[4:19]
ds_read_b128 v[108:111], v141 offset:0
ds_read_b128 v[112:115], v141 offset:4096
v_mfma_f32_32x32x16_bf16 v[52:67], v[116:119], v[104:107], v[52:67]
ds_read_b64_tr_b16 v[128:129], v152 offset:2048
ds_read_b64_tr_b16 v[130:131], v152 offset:2560
v_mfma_f32_32x32x16_bf16 v[20:35], v[120:123], v[100:103], v[20:35]
ds_read_b64_tr_b16 v[132:133], v152 offset:10240
ds_read_b64_tr_b16 v[134:135], v152 offset:10752
v_mfma_f32_32x32x16_bf16 v[68:83], v[120:123], v[104:107], v[68:83]
ds_read_b64_tr_b16 v[136:137], v152 offset:18432
ds_read_b64_tr_b16 v[138:139], v152 offset:18944
s_add_u32 m0, s45, 84992
s_nop 0
buffer_load_dwordx4 v158, s[24:27], s42 offen lds
v_mfma_f32_32x32x16_bf16 v[36:51], v[100:103], v[124:127], v[36:51]
s_add_u32 m0, s48, 98304
s_nop 0
buffer_load_dwordx4 v159, s[28:31], s43 offen lds
v_mfma_f32_32x32x16_bf16 v[84:99], v[104:107], v[124:127], v[84:99]
s_add_u32 m0, s48, 99328
s_nop 0
buffer_load_dwordx4 v160, s[28:31], s43 offen lds
s_waitcnt lgkmcnt(0)
v_mfma_f32_32x32x16_bf16 v[4:19], v[128:131], v[108:111], v[4:19]
ds_read_b128 v[100:103], v142 offset:0
ds_read_b128 v[104:107], v142 offset:4096
v_mfma_f32_32x32x16_bf16 v[52:67], v[128:131], v[112:115], v[52:67]
ds_read_b64_tr_b16 v[116:117], v152 offset:4096
ds_read_b64_tr_b16 v[118:119], v152 offset:4608
v_mfma_f32_32x32x16_bf16 v[20:35], v[132:135], v[108:111], v[20:35]
ds_read_b64_tr_b16 v[120:121], v152 offset:12288
ds_read_b64_tr_b16 v[122:123], v152 offset:12800
v_mfma_f32_32x32x16_bf16 v[68:83], v[132:135], v[112:115], v[68:83]
ds_read_b64_tr_b16 v[124:125], v152 offset:20480
ds_read_b64_tr_b16 v[126:127], v152 offset:20992
s_add_u32 m0, s48, 106496
s_nop 0
buffer_load_dwordx4 v161, s[28:31], s43 offen lds
v_mfma_f32_32x32x16_bf16 v[36:51], v[108:111], v[136:139], v[36:51]
s_add_u32 m0, s48, 107520
s_nop 0
buffer_load_dwordx4 v162, s[28:31], s43 offen lds
v_mfma_f32_32x32x16_bf16 v[84:99], v[112:115], v[136:139], v[84:99]
s_add_u32 m0, s48, 114688
s_nop 0
buffer_load_dwordx4 v163, s[28:31], s43 offen lds
s_waitcnt lgkmcnt(0)
v_mfma_f32_32x32x16_bf16 v[4:19], v[116:119], v[100:103], v[4:19]
ds_read_b128 v[108:111], v143 offset:0
ds_read_b128 v[112:115], v143 offset:4096
v_mfma_f32_32x32x16_bf16 v[52:67], v[116:119], v[104:107], v[52:67]
ds_read_b64_tr_b16 v[128:129], v152 offset:6144
ds_read_b64_tr_b16 v[130:131], v152 offset:6656
v_mfma_f32_32x32x16_bf16 v[20:35], v[120:123], v[100:103], v[20:35]
ds_read_b64_tr_b16 v[132:133], v152 offset:14336
ds_read_b64_tr_b16 v[134:135], v152 offset:14848
v_mfma_f32_32x32x16_bf16 v[68:83], v[120:123], v[104:107], v[68:83]
ds_read_b64_tr_b16 v[136:137], v152 offset:22528
ds_read_b64_tr_b16 v[138:139], v152 offset:23040
s_add_u32 m0, s48, 115712
s_nop 0
buffer_load_dwordx4 v164, s[28:31], s43 offen lds
v_mfma_f32_32x32x16_bf16 v[36:51], v[100:103], v[124:127], v[36:51]
s_add_u32 s42, s42, 128
s_and_b32 s42, s42, 2047
s_mul_i32 s43, s42, 3072
v_mfma_f32_32x32x16_bf16 v[84:99], v[104:107], v[124:127], v[84:99]
s_waitcnt lgkmcnt(0)
s_waitcnt vmcnt(10)
s_barrier
v_mfma_f32_32x32x16_bf16 v[4:19], v[128:131], v[108:111], v[4:19]
ds_read_b128 v[100:103], v144 offset:0
ds_read_b128 v[104:107], v144 offset:4096
v_mfma_f32_32x32x16_bf16 v[52:67], v[128:131], v[112:115], v[52:67]
ds_read_b64_tr_b16 v[116:117], v153 offset:0
ds_read_b64_tr_b16 v[118:119], v153 offset:512
v_mfma_f32_32x32x16_bf16 v[20:35], v[132:135], v[108:111], v[20:35]
ds_read_b64_tr_b16 v[120:121], v153 offset:8192
ds_read_b64_tr_b16 v[122:123], v153 offset:8704
v_mfma_f32_32x32x16_bf16 v[68:83], v[132:135], v[112:115], v[68:83]
ds_read_b64_tr_b16 v[124:125], v153 offset:16384
ds_read_b64_tr_b16 v[126:127], v153 offset:16896
s_add_u32 m0, s45, 0
s_nop 0
buffer_load_dwordx4 v155, s[24:27], s42 offen lds
v_mfma_f32_32x32x16_bf16 v[36:51], v[108:111], v[136:139], v[36:51]
s_add_u32 m0, s45, 1024
s_nop 0
buffer_load_dwordx4 v156, s[24:27], s42 offen lds
v_mfma_f32_32x32x16_bf16 v[84:99], v[112:115], v[136:139], v[84:99]
s_add_u32 m0, s45, 2048
s_nop 0
buffer_load_dwordx4 v157, s[24:27], s42 offen lds
s_waitcnt lgkmcnt(0)
v_mfma_f32_32x32x16_bf16 v[4:19], v[116:119], v[100:103], v[4:19]
ds_read_b128 v[108:111], v145 offset:0
ds_read_b128 v[112:115], v145 offset:4096
v_mfma_f32_32x32x16_bf16 v[52:67], v[116:119], v[104:107], v[52:67]
ds_read_b64_tr_b16 v[128:129], v153 offset:2048
ds_read_b64_tr_b16 v[130:131], v153 offset:2560
v_mfma_f32_32x32x16_bf16 v[20:35], v[120:123], v[100:103], v[20:35]
ds_read_b64_tr_b16 v[132:133], v153 offset:10240
ds_read_b64_tr_b16 v[134:135], v153 offset:10752
v_mfma_f32_32x32x16_bf16 v[68:83], v[120:123], v[104:107], v[68:83]
ds_read_b64_tr_b16 v[136:137], v153 offset:18432
ds_read_b64_tr_b16 v[138:139], v153 offset:18944
s_add_u32 m0, s45, 3072
s_nop 0
buffer_load_dwordx4 v158, s[24:27], s42 offen lds
v_mfma_f32_32x32x16_bf16 v[36:51], v[100:103], v[124:127], v[36:51]
s_add_u32 m0, s48, 16384
s_nop 0
buffer_load_dwordx4 v159, s[28:31], s43 offen lds
v_mfma_f32_32x32x16_bf16 v[84:99], v[104:107], v[124:127], v[84:99]
s_add_u32 m0, s48, 17408
s_nop 0
buffer_load_dwordx4 v160, s[28:31], s43 offen lds
s_waitcnt lgkmcnt(0)
v_mfma_f32_32x32x16_bf16 v[4:19], v[128:131], v[108:111], v[4:19]
ds_read_b128 v[100:103], v146 offset:0
ds_read_b128 v[104:107], v146 offset:4096
v_mfma_f32_32x32x16_bf16 v[52:67], v[128:131], v[112:115], v[52:67]
ds_read_b64_tr_b16 v[116:117], v153 offset:4096
ds_read_b64_tr_b16 v[118:119], v153 offset:4608
v_mfma_f32_32x32x16_bf16 v[20:35], v[132:135], v[108:111], v[20:35]
ds_read_b64_tr_b16 v[120:121], v153 offset:12288
ds_read_b64_tr_b16 v[122:123], v153 offset:12800
v_mfma_f32_32x32x16_bf16 v[68:83], v[132:135], v[112:115], v[68:83]
ds_read_b64_tr_b16 v[124:125], v153 offset:20480
ds_read_b64_tr_b16 v[126:127], v153 offset:20992
s_add_u32 m0, s48, 24576
s_nop 0
buffer_load_dwordx4 v161, s[28:31], s43 offen lds
v_mfma_f32_32x32x16_bf16 v[36:51], v[108:111], v[136:139], v[36:51]
s_add_u32 m0, s48, 25600
s_nop 0
buffer_load_dwordx4 v162, s[28:31], s43 offen lds
v_mfma_f32_32x32x16_bf16 v[84:99], v[112:115], v[136:139], v[84:99]
s_add_u32 m0, s48, 32768
s_nop 0
buffer_load_dwordx4 v163, s[28:31], s43 offen lds
s_waitcnt lgkmcnt(0)
v_mfma_f32_32x32x16_bf16 v[4:19], v[116:119], v[100:103], v[4:19]
ds_read_b128 v[108:111], v147 offset:0
ds_read_b128 v[112:115], v147 offset:4096
v_mfma_f32_32x32x16_bf16 v[52:67], v[116:119], v[104:107], v[52:67]
ds_read_b64_tr_b16 v[128:129], v153 offset:6144
ds_read_b64_tr_b16 v[130:131], v153 offset:6656
v_mfma_f32_32x32x16_bf16 v[20:35], v[120:123], v[100:103], v[20:35]
ds_read_b64_tr_b16 v[132:133], v153 offset:14336
ds_read_b64_tr_b16 v[134:135], v153 offset:14848
v_mfma_f32_32x32x16_bf16 v[68:83], v[120:123], v[104:107], v[68:83]
ds_read_b64_tr_b16 v[136:137], v153 offset:22528
ds_read_b64_tr_b16 v[138:139], v153 offset:23040
s_add_u32 m0, s48, 33792
s_nop 0
buffer_load_dwordx4 v164, s[28:31], s43 offen lds
v_mfma_f32_32x32x16_bf16 v[36:51], v[100:103], v[124:127], v[36:51]
s_add_u32 s42, s42, 128
s_and_b32 s42, s42, 2047
s_mul_i32 s43, s42, 3072
v_mfma_f32_32x32x16_bf16 v[84:99], v[104:107], v[124:127], v[84:99]
s_waitcnt lgkmcnt(0)
s_waitcnt vmcnt(10)
s_barrier
v_mfma_f32_32x32x16_bf16 v[4:19], v[128:131], v[108:111], v[4:19]
ds_read_b128 v[100:103], v148 offset:0
ds_read_b128 v[104:107], v148 offset:4096
v_mfma_f32_32x32x16_bf16 v[52:67], v[128:131], v[112:115], v[52:67]
ds_read_b64_tr_b16 v[116:117], v154 offset:0
ds_read_b64_tr_b16 v[118:119], v154 offset:512
v_mfma_f32_32x32x16_bf16 v[20:35], v[132:135], v[108:111], v[20:35]
ds_read_b64_tr_b16 v[120:121], v154 offset:8192
ds_read_b64_tr_b16 v[122:123], v154 offset:8704
v_mfma_f32_32x32x16_bf16 v[68:83], v[132:135], v[112:115], v[68:83]
ds_read_b64_tr_b16 v[124:125], v154 offset:16384
ds_read_b64_tr_b16 v[126:127], v154 offset:16896
s_add_u32 m0, s45, 40960
s_nop 0
buffer_load_dwordx4 v155, s[24:27], s42 offen lds
v_mfma_f32_32x32x16_bf16 v[36:51], v[108:111], v[136:139], v[36:51]
s_add_u32 m0, s45, 41984
s_nop 0
buffer_load_dwordx4 v156, s[24:27], s42 offen lds
v_mfma_f32_32x32x16_bf16 v[84:99], v[112:115], v[136:139], v[84:99]
s_add_u32 m0, s45, 43008
s_nop 0
buffer_load_dwordx4 v157, s[24:27], s42 offen lds
s_waitcnt lgkmcnt(0)
v_mfma_f32_32x32x16_bf16 v[4:19], v[116:119], v[100:103], v[4:19]
ds_read_b128 v[108:111], v149 offset:0
ds_read_b128 v[112:115], v149 offset:4096
v_mfma_f32_32x32x16_bf16 v[52:67], v[116:119], v[104:107], v[52:67]
ds_read_b64_tr_b16 v[128:129], v154 offset:2048
ds_read_b64_tr_b16 v[130:131], v154 offset:2560
v_mfma_f32_32x32x16_bf16 v[20:35], v[120:123], v[100:103], v[20:35]
ds_read_b64_tr_b16 v[132:133], v154 offset:10240
ds_read_b64_tr_b16 v[134:135], v154 offset:10752
v_mfma_f32_32x32x16_bf16 v[68:83], v[120:123], v[104:107], v[68:83]
ds_read_b64_tr_b16 v[136:137], v154 offset:18432
ds_read_b64_tr_b16 v[138:139], v154 offset:18944
s_add_u32 m0, s45, 44032
s_nop 0
buffer_load_dwordx4 v158, s[24:27], s42 offen lds
v_mfma_f32_32x32x16_bf16 v[36:51], v[100:103], v[124:127], v[36:51]
s_add_u32 m0, s48, 57344
s_nop 0
buffer_load_dwordx4 v159, s[28:31], s43 offen lds
v_mfma_f32_32x32x16_bf16 v[84:99], v[104:107], v[124:127], v[84:99]
s_add_u32 m0, s48, 58368
s_nop 0
buffer_load_dwordx4 v160, s[28:31], s43 offen lds
s_waitcnt lgkmcnt(0)
v_mfma_f32_32x32x16_bf16 v[4:19], v[128:131], v[108:111], v[4:19]
ds_read_b128 v[100:103], v150 offset:0
ds_read_b128 v[104:107], v150 offset:4096
v_mfma_f32_32x32x16_bf16 v[52:67], v[128:131], v[112:115], v[52:67]
ds_read_b64_tr_b16 v[116:117], v154 offset:4096
ds_read_b64_tr_b16 v[118:119], v154 offset:4608
v_mfma_f32_32x32x16_bf16 v[20:35], v[132:135], v[108:111], v[20:35]
ds_read_b64_tr_b16 v[120:121], v154 offset:12288
ds_read_b64_tr_b16 v[122:123], v154 offset:12800
v_mfma_f32_32x32x16_bf16 v[68:83], v[132:135], v[112:115], v[68:83]
ds_read_b64_tr_b16 v[124:125], v154 offset:20480
ds_read_b64_tr_b16 v[126:127], v154 offset:20992
s_add_u32 m0, s48, 65536
s_nop 0
buffer_load_dwordx4 v161, s[28:31], s43 offen lds
v_mfma_f32_32x32x16_bf16 v[36:51], v[108:111], v[136:139], v[36:51]
s_add_u32 m0, s48, 66560
s_nop 0
buffer_load_dwordx4 v162, s[28:31], s43 offen lds
v_mfma_f32_32x32x16_bf16 v[84:99], v[112:115], v[136:139], v[84:99]
s_add_u32 m0, s48, 73728
s_nop 0
buffer_load_dwordx4 v163, s[28:31], s43 offen lds
s_waitcnt lgkmcnt(0)
v_mfma_f32_32x32x16_bf16 v[4:19], v[116:119], v[100:103], v[4:19]
ds_read_b128 v[108:111], v151 offset:0
ds_read_b128 v[112:115], v151 offset:4096
v_mfma_f32_32x32x16_bf16 v[52:67], v[116:119], v[104:107], v[52:67]
ds_read_b64_tr_b16 v[128:129], v154 offset:6144
ds_read_b64_tr_b16 v[130:131], v154 offset:6656
v_mfma_f32_32x32x16_bf16 v[20:35], v[120:123], v[100:103], v[20:35]
ds_read_b64_tr_b16 v[132:133], v154 offset:14336
ds_read_b64_tr_b16 v[134:135], v154 offset:14848
v_mfma_f32_32x32x16_bf16 v[68:83], v[120:123], v[104:107], v[68:83]
ds_read_b64_tr_b16 v[136:137], v154 offset:22528
ds_read_b64_tr_b16 v[138:139], v154 offset:23040
s_add_u32 m0, s48, 74752
s_nop 0
buffer_load_dwordx4 v164, s[28:31], s43 offen lds
v_mfma_f32_32x32x16_bf16 v[36:51], v[100:103], v[124:127], v[36:51]
s_add_u32 s42, s42, 128
s_and_b32 s42, s42, 2047
s_mul_i32 s43, s42, 3072
v_mfma_f32_32x32x16_bf16 v[84:99], v[104:107], v[124:127], v[84:99]
s_waitcnt lgkmcnt(0)
s_waitcnt vmcnt(10)
s_barrier
v_mfma_f32_32x32x16_bf16 v[4:19], v[128:131], v[108:111], v[4:19]
ds_read_b128 v[100:103], v140 offset:0
ds_read_b128 v[104:107], v140 offset:4096
v_mfma_f32_32x32x16_bf16 v[52:67], v[128:131], v[112:115], v[52:67]
ds_read_b64_tr_b16 v[116:117], v152 offset:0
ds_read_b64_tr_b16 v[118:119], v152 offset:512
v_mfma_f32_32x32x16_bf16 v[20:35], v[132:135], v[108:111], v[20:35]
ds_read_b64_tr_b16 v[120:121], v152 offset:8192
ds_read_b64_tr_b16 v[122:123], v152 offset:8704
v_mfma_f32_32x32x16_bf16 v[68:83], v[132:135], v[112:115], v[68:83]
ds_read_b64_tr_b16 v[124:125], v152 offset:16384
ds_read_b64_tr_b16 v[126:127], v152 offset:16896
s_add_u32 m0, s45, 81920
s_nop 0
buffer_load_dwordx4 v155, s[24:27], s42 offen lds
v_mfma_f32_32x32x16_bf16 v[36:51], v[108:111], v[136:139], v[36:51]
s_add_u32 m0, s45, 82944
s_nop 0
buffer_load_dwordx4 v156, s[24:27], s42 offen lds
v_mfma_f32_32x32x16_bf16 v[84:99], v[112:115], v[136:139], v[84:99]
s_add_u32 m0, s45, 83968
s_nop 0
buffer_load_dwordx4 v157, s[24:27], s42 offen lds
s_waitcnt lgkmcnt(0)
v_mfma_f32_32x32x16_bf16 v[4:19], v[116:119], v[100:103], v[4:19]
ds_read_b128 v[108:111], v141 offset:0
ds_read_b128 v[112:115], v141 offset:4096
v_mfma_f32_32x32x16_bf16 v[52:67], v[116:119], v[104:107], v[52:67]
ds_read_b64_tr_b16 v[128:129], v152 offset:2048
ds_read_b64_tr_b16 v[130:131], v152 offset:2560
v_mfma_f32_32x32x16_bf16 v[20:35], v[120:123], v[100:103], v[20:35]
ds_read_b64_tr_b16 v[132:133], v152 offset:10240
ds_read_b64_tr_b16 v[134:135], v152 offset:10752
v_mfma_f32_32x32x16_bf16 v[68:83], v[120:123], v[104:107], v[68:83]
ds_read_b64_tr_b16 v[136:137], v152 offset:18432
ds_read_b64_tr_b16 v[138:139], v152 offset:18944
s_add_u32 m0, s45, 84992
s_nop 0
buffer_load_dwordx4 v158, s[24:27], s42 offen lds
v_mfma_f32_32x32x16_bf16 v[36:51], v[100:103], v[124:127], v[36:51]
s_add_u32 m0, s48, 98304
s_nop 0
buffer_load_dwordx4 v159, s[28:31], s43 offen lds
v_mfma_f32_32x32x16_bf16 v[84:99], v[104:107], v[124:127], v[84:99]
s_add_u32 m0, s48, 99328
s_nop 0
buffer_load_dwordx4 v160, s[28:31], s43 offen lds
s_waitcnt lgkmcnt(0)
v_mfma_f32_32x32x16_bf16 v[4:19], v[128:131], v[108:111], v[4:19]
ds_read_b128 v[100:103], v142 offset:0
ds_read_b128 v[104:107], v142 offset:4096
v_mfma_f32_32x32x16_bf16 v[52:67], v[128:131], v[112:115], v[52:67]
ds_read_b64_tr_b16 v[116:117], v152 offset:4096
ds_read_b64_tr_b16 v[118:119], v152 offset:4608
v_mfma_f32_32x32x16_bf16 v[20:35], v[132:135], v[108:111], v[20:35]
ds_read_b64_tr_b16 v[120:121], v152 offset:12288
ds_read_b64_tr_b16 v[122:123], v152 offset:12800
v_mfma_f32_32x32x16_bf16 v[68:83], v[132:135], v[112:115], v[68:83]
ds_read_b64_tr_b16 v[124:125], v152 offset:20480
ds_read_b64_tr_b16 v[126:127], v152 offset:20992
s_add_u32 m0, s48, 106496
s_nop 0
buffer_load_dwordx4 v161, s[28:31], s43 offen lds
v_mfma_f32_32x32x16_bf16 v[36:51], v[108:111], v[136:139], v[36:51]
s_add_u32 m0, s48, 107520
s_nop 0
buffer_load_dwordx4 v162, s[28:31], s43 offen lds
v_mfma_f32_32x32x16_bf16 v[84:99], v[112:115], v[136:139], v[84:99]
s_add_u32 m0, s48, 114688
s_nop 0
buffer_load_dwordx4 v163, s[28:31], s43 offen lds
s_waitcnt lgkmcnt(0)
v_mfma_f32_32x32x16_bf16 v[4:19], v[116:119], v[100:103], v[4:19]
ds_read_b128 v[108:111], v143 offset:0
ds_read_b128 v[112:115], v143 offset:4096
v_mfma_f32_32x32x16_bf16 v[52:67], v[116:119], v[104:107], v[52:67]
ds_read_b64_tr_b16 v[128:129], v152 offset:6144
ds_read_b64_tr_b16 v[130:131], v152 offset:6656
v_mfma_f32_32x32x16_bf16 v[20:35], v[120:123], v[100:103], v[20:35]
ds_read_b64_tr_b16 v[132:133], v152 offset:14336
ds_read_b64_tr_b16 v[134:135], v152 offset:14848
v_mfma_f32_32x32x16_bf16 v[68:83], v[120:123], v[104:107], v[68:83]
ds_read_b64_tr_b16 v[136:137], v152 offset:22528
ds_read_b64_tr_b16 v[138:139], v152 offset:23040
s_add_u32 m0, s48, 115712
s_nop 0
buffer_load_dwordx4 v164, s[28:31], s43 offen lds
v_mfma_f32_32x32x16_bf16 v[36:51], v[100:103], v[124:127], v[36:51]
s_add_u32 s42, s42, 128
s_and_b32 s42, s42, 2047
s_mul_i32 s43, s42, 3072
v_mfma_f32_32x32x16_bf16 v[84:99], v[104:107], v[124:127], v[84:99]
s_waitcnt lgkmcnt(0)
s_waitcnt vmcnt(10)
s_barrier
v_mfma_f32_32x32x16_bf16 v[4:19], v[128:131], v[108:111], v[4:19]
ds_read_b128 v[100:103], v144 offset:0
ds_read_b128 v[104:107], v144 offset:4096
v_mfma_f32_32x32x16_bf16 v[52:67], v[128:131], v[112:115], v[52:67]
ds_read_b64_tr_b16 v[116:117], v153 offset:0
ds_read_b64_tr_b16 v[118:119], v153 offset:512
v_mfma_f32_32x32x16_bf16 v[20:35], v[132:135], v[108:111], v[20:35]
ds_read_b64_tr_b16 v[120:121], v153 offset:8192
ds_read_b64_tr_b16 v[122:123], v153 offset:8704
v_mfma_f32_32x32x16_bf16 v[68:83], v[132:135], v[112:115], v[68:83]
ds_read_b64_tr_b16 v[124:125], v153 offset:16384
ds_read_b64_tr_b16 v[126:127], v153 offset:16896
s_add_u32 m0, s45, 0
s_nop 0
buffer_load_dwordx4 v155, s[24:27], s42 offen lds
v_mfma_f32_32x32x16_bf16 v[36:51], v[108:111], v[136:139], v[36:51]
s_add_u32 m0, s45, 1024
s_nop 0
buffer_load_dwordx4 v156, s[24:27], s42 offen lds
v_mfma_f32_32x32x16_bf16 v[84:99], v[112:115], v[136:139], v[84:99]
s_add_u32 m0, s45, 2048
s_nop 0
buffer_load_dwordx4 v157, s[24:27], s42 offen lds
s_waitcnt lgkmcnt(0)
v_mfma_f32_32x32x16_bf16 v[4:19], v[116:119], v[100:103], v[4:19]
ds_read_b128 v[108:111], v145 offset:0
ds_read_b128 v[112:115], v145 offset:4096
v_mfma_f32_32x32x16_bf16 v[52:67], v[116:119], v[104:107], v[52:67]
ds_read_b64_tr_b16 v[128:129], v153 offset:2048
ds_read_b64_tr_b16 v[130:131], v153 offset:2560
v_mfma_f32_32x32x16_bf16 v[20:35], v[120:123], v[100:103], v[20:35]
ds_read_b64_tr_b16 v[132:133], v153 offset:10240
ds_read_b64_tr_b16 v[134:135], v153 offset:10752
v_mfma_f32_32x32x16_bf16 v[68:83], v[120:123], v[104:107], v[68:83]
ds_read_b64_tr_b16 v[136:137], v153 offset:18432
ds_read_b64_tr_b16 v[138:139], v153 offset:18944
s_add_u32 m0, s45, 3072
s_nop 0
buffer_load_dwordx4 v158, s[24:27], s42 offen lds
v_mfma_f32_32x32x16_bf16 v[36:51], v[100:103], v[124:127], v[36:51]
s_add_u32 m0, s48, 16384
s_nop 0
buffer_load_dwordx4 v159, s[28:31], s43 offen lds
v_mfma_f32_32x32x16_bf16 v[84:99], v[104:107], v[124:127], v[84:99]
s_add_u32 m0, s48, 17408
s_nop 0
buffer_load_dwordx4 v160, s[28:31], s43 offen lds
s_waitcnt lgkmcnt(0)
v_mfma_f32_32x32x16_bf16 v[4:19], v[128:131], v[108:111], v[4:19]
ds_read_b128 v[100:103], v146 offset:0
ds_read_b128 v[104:107], v146 offset:4096
v_mfma_f32_32x32x16_bf16 v[52:67], v[128:131], v[112:115], v[52:67]
ds_read_b64_tr_b16 v[116:117], v153 offset:4096
ds_read_b64_tr_b16 v[118:119], v153 offset:4608
v_mfma_f32_32x32x16_bf16 v[20:35], v[132:135], v[108:111], v[20:35]
ds_read_b64_tr_b16 v[120:121], v153 offset:12288
ds_read_b64_tr_b16 v[122:123], v153 offset:12800
v_mfma_f32_32x32x16_bf16 v[68:83], v[132:135], v[112:115], v[68:83]
ds_read_b64_tr_b16 v[124:125], v153 offset:20480
ds_read_b64_tr_b16 v[126:127], v153 offset:20992
s_add_u32 m0, s48, 24576
s_nop 0
buffer_load_dwordx4 v161, s[28:31], s43 offen lds
v_mfma_f32_32x32x16_bf16 v[36:51], v[108:111], v[136:139], v[36:51]
s_add_u32 m0, s48, 25600
s_nop 0
buffer_load_dwordx4 v162, s[28:31], s43 offen lds
v_mfma_f32_32x32x16_bf16 v[84:99], v[112:115], v[136:139], v[84:99]
s_add_u32 m0, s48, 32768
s_nop 0
buffer_load_dwordx4 v163, s[28:31], s43 offen lds
s_waitcnt lgkmcnt(0)
v_mfma_f32_32x32x16_bf16 v[4:19], v[116:119], v[100:103], v[4:19]
ds_read_b128 v[108:111], v147 offset:0
ds_read_b128 v[112:115], v147 offset:4096
v_mfma_f32_32x32x16_bf16 v[52:67], v[116:119], v[104:107], v[52:67]
ds_read_b64_tr_b16 v[128:129], v153 offset:6144
ds_read_b64_tr_b16 v[130:131], v153 offset:6656
v_mfma_f32_32x32x16_bf16 v[20:35], v[120:123], v[100:103], v[20:35]
ds_read_b64_tr_b16 v[132:133], v153 offset:14336
ds_read_b64_tr_b16 v[134:135], v153 offset:14848
v_mfma_f32_32x32x16_bf16 v[68:83], v[120:123], v[104:107], v[68:83]
ds_read_b64_tr_b16 v[136:137], v153 offset:22528
ds_read_b64_tr_b16 v[138:139], v153 offset:23040
s_add_u32 m0, s48, 33792
s_nop 0
buffer_load_dwordx4 v164, s[28:31], s43 offen lds
v_mfma_f32_32x32x16_bf16 v[36:51], v[100:103], v[124:127], v[36:51]
s_add_u32 s42, s42, 128
s_and_b32 s42, s42, 2047
s_mul_i32 s43, s42, 3072
v_mfma_f32_32x32x16_bf16 v[84:99], v[104:107], v[124:127], v[84:99]
s_waitcnt lgkmcnt(0)
s_waitcnt vmcnt(10)
s_barrier
v_mfma_f32_32x32x16_bf16 v[4:19], v[128:131], v[108:111], v[4:19]
ds_read_b128 v[100:103], v148 offset:0
ds_read_b128 v[104:107], v148 offset:4096
v_mfma_f32_32x32x16_bf16 v[52:67], v[128:131], v[112:115], v[52:67]
ds_read_b64_tr_b16 v[116:117], v154 offset:0
ds_read_b64_tr_b16 v[118:119], v154 offset:512
v_mfma_f32_32x32x16_bf16 v[20:35], v[132:135], v[108:111], v[20:35]
ds_read_b64_tr_b16 v[120:121], v154 offset:8192
ds_read_b64_tr_b16 v[122:123], v154 offset:8704
v_mfma_f32_32x32x16_bf16 v[68:83], v[132:135], v[112:115], v[68:83]
ds_read_b64_tr_b16 v[124:125], v154 offset:16384
ds_read_b64_tr_b16 v[126:127], v154 offset:16896
s_add_u32 m0, s45, 40960
s_nop 0
buffer_load_dwordx4 v155, s[24:27], s42 offen lds
v_mfma_f32_32x32x16_bf16 v[36:51], v[108:111], v[136:139], v[36:51]
s_add_u32 m0, s45, 41984
s_nop 0
buffer_load_dwordx4 v156, s[24:27], s42 offen lds
v_mfma_f32_32x32x16_bf16 v[84:99], v[112:115], v[136:139], v[84:99]
s_add_u32 m0, s45, 43008
s_nop 0
buffer_load_dwordx4 v157, s[24:27], s42 offen lds
s_waitcnt lgkmcnt(0)
v_mfma_f32_32x32x16_bf16 v[4:19], v[116:119], v[100:103], v[4:19]
ds_read_b128 v[108:111], v149 offset:0
ds_read_b128 v[112:115], v149 offset:4096
v_mfma_f32_32x32x16_bf16 v[52:67], v[116:119], v[104:107], v[52:67]
ds_read_b64_tr_b16 v[128:129], v154 offset:2048
ds_read_b64_tr_b16 v[130:131], v154 offset:2560
v_mfma_f32_32x32x16_bf16 v[20:35], v[120:123], v[100:103], v[20:35]
ds_read_b64_tr_b16 v[132:133], v154 offset:10240
ds_read_b64_tr_b16 v[134:135], v154 offset:10752
v_mfma_f32_32x32x16_bf16 v[68:83], v[120:123], v[104:107], v[68:83]
ds_read_b64_tr_b16 v[136:137], v154 offset:18432
ds_read_b64_tr_b16 v[138:139], v154 offset:18944
s_add_u32 m0, s45, 44032
s_nop 0
buffer_load_dwordx4 v158, s[24:27], s42 offen lds
v_mfma_f32_32x32x16_bf16 v[36:51], v[100:103], v[124:127], v[36:51]
s_add_u32 m0, s48, 57344
s_nop 0
buffer_load_dwordx4 v159, s[28:31], s43 offen lds
v_mfma_f32_32x32x16_bf16 v[84:99], v[104:107], v[124:127], v[84:99]
s_add_u32 m0, s48, 58368
s_nop 0
buffer_load_dwordx4 v160, s[28:31], s43 offen lds
s_waitcnt lgkmcnt(0)
v_mfma_f32_32x32x16_bf16 v[4:19], v[128:131], v[108:111], v[4:19]
ds_read_b128 v[100:103], v150 offset:0
ds_read_b128 v[104:107], v150 offset:4096
v_mfma_f32_32x32x16_bf16 v[52:67], v[128:131], v[112:115], v[52:67]
ds_read_b64_tr_b16 v[116:117], v154 offset:4096
ds_read_b64_tr_b16 v[118:119], v154 offset:4608
v_mfma_f32_32x32x16_bf16 v[20:35], v[132:135], v[108:111], v[20:35]
ds_read_b64_tr_b16 v[120:121], v154 offset:12288
ds_read_b64_tr_b16 v[122:123], v154 offset:12800
v_mfma_f32_32x32x16_bf16 v[68:83], v[132:135], v[112:115], v[68:83]
ds_read_b64_tr_b16 v[124:125], v154 offset:20480
ds_read_b64_tr_b16 v[126:127], v154 offset:20992
s_add_u32 m0, s48, 65536
s_nop 0
buffer_load_dwordx4 v161, s[28:31], s43 offen lds
v_mfma_f32_32x32x16_bf16 v[36:51], v[108:111], v[136:139], v[36:51]
s_add_u32 m0, s48, 66560
s_nop 0
buffer_load_dwordx4 v162, s[28:31], s43 offen lds
v_mfma_f32_32x32x16_bf16 v[84:99], v[112:115], v[136:139], v[84:99]
s_add_u32 m0, s48, 73728
s_nop 0
buffer_load_dwordx4 v163, s[28:31], s43 offen lds
s_waitcnt lgkmcnt(0)
v_mfma_f32_32x32x16_bf16 v[4:19], v[116:119], v[100:103], v[4:19]
ds_read_b128 v[108:111], v151 offset:0
ds_read_b128 v[112:115], v151 offset:4096
v_mfma_f32_32x32x16_bf16 v[52:67], v[116:119], v[104:107], v[52:67]
ds_read_b64_tr_b16 v[128:129], v154 offset:6144
ds_read_b64_tr_b16 v[130:131], v154 offset:6656
v_mfma_f32_32x32x16_bf16 v[20:35], v[120:123], v[100:103], v[20:35]
ds_read_b64_tr_b16 v[132:133], v154 offset:14336
ds_read_b64_tr_b16 v[134:135], v154 offset:14848
v_mfma_f32_32x32x16_bf16 v[68:83], v[120:123], v[104:107], v[68:83]
ds_read_b64_tr_b16 v[136:137], v154 offset:22528
ds_read_b64_tr_b16 v[138:139], v154 offset:23040
s_add_u32 m0, s48, 74752
s_nop 0
buffer_load_dwordx4 v164, s[28:31], s43 offen lds
v_mfma_f32_32x32x16_bf16 v[36:51], v[100:103], v[124:127], v[36:51]
s_add_u32 s42, s42, 128
s_and_b32 s42, s42, 2047
s_mul_i32 s43, s42, 3072
v_mfma_f32_32x32x16_bf16 v[84:99], v[104:107], v[124:127], v[84:99]
s_waitcnt lgkmcnt(0)
s_waitcnt vmcnt(10)
s_barrier
v_mfma_f32_32x32x16_bf16 v[4:19], v[128:131], v[108:111], v[4:19]
ds_read_b128 v[100:103], v140 offset:0
ds_read_b128 v[104:107], v140 offset:4096
v_mfma_f32_32x32x16_bf16 v[52:67], v[128:131], v[112:115], v[52:67]
ds_read_b64_tr_b16 v[116:117], v152 offset:0
ds_read_b64_tr_b16 v[118:119], v152 offset:512
v_mfma_f32_32x32x16_bf16 v[20:35], v[132:135], v[108:111], v[20:35]
ds_read_b64_tr_b16 v[120:121], v152 offset:8192
ds_read_b64_tr_b16 v[122:123], v152 offset:8704
v_mfma_f32_32x32x16_bf16 v[68:83], v[132:135], v[112:115], v[68:83]
ds_read_b64_tr_b16 v[124:125], v152 offset:16384
ds_read_b64_tr_b16 v[126:127], v152 offset:16896
s_add_u32 m0, s45, 81920
s_nop 0
buffer_load_dwordx4 v155, s[24:27], s42 offen lds
v_mfma_f32_32x32x16_bf16 v[36:51], v[108:111], v[136:139], v[36:51]
s_add_u32 m0, s45, 82944
s_nop 0
buffer_load_dwordx4 v156, s[24:27], s42 offen lds
v_mfma_f32_32x32x16_bf16 v[84:99], v[112:115], v[136:139], v[84:99]
s_add_u32 m0, s45, 83968
s_nop 0
buffer_load_dwordx4 v157, s[24:27], s42 offen lds
s_waitcnt lgkmcnt(0)
v_mfma_f32_32x32x16_bf16 v[4:19], v[116:119], v[100:103], v[4:19]
ds_read_b128 v[108:111], v141 offset:0
ds_read_b128 v[112:115], v141 offset:4096
v_mfma_f32_32x32x16_bf16 v[52:67], v[116:119], v[104:107], v[52:67]
ds_read_b64_tr_b16 v[128:129], v152 offset:2048
ds_read_b64_tr_b16 v[130:131], v152 offset:2560
v_mfma_f32_32x32x16_bf16 v[20:35], v[120:123], v[100:103], v[20:35]
ds_read_b64_tr_b16 v[132:133], v152 offset:10240
ds_read_b64_tr_b16 v[134:135], v152 offset:10752
v_mfma_f32_32x32x16_bf16 v[68:83], v[120:123], v[104:107], v[68:83]
ds_read_b64_tr_b16 v[136:137], v152 offset:18432
ds_read_b64_tr_b16 v[138:139], v152 offset:18944
s_add_u32 m0, s45, 84992
s_nop 0
buffer_load_dwordx4 v158, s[24:27], s42 offen lds
v_mfma_f32_32x32x16_bf16 v[36:51], v[100:103], v[124:127], v[36:51]
s_add_u32 m0, s48, 98304
s_nop 0
buffer_load_dwordx4 v159, s[28:31], s43 offen lds
v_mfma_f32_32x32x16_bf16 v[84:99], v[104:107], v[124:127], v[84:99]
s_add_u32 m0, s48, 99328
s_nop 0
buffer_load_dwordx4 v160, s[28:31], s43 offen lds
s_waitcnt lgkmcnt(0)
v_mfma_f32_32x32x16_bf16 v[4:19], v[128:131], v[108:111], v[4:19]
ds_read_b128 v[100:103], v142 offset:0
ds_read_b128 v[104:107], v142 offset:4096
v_mfma_f32_32x32x16_bf16 v[52:67], v[128:131], v[112:115], v[52:67]
ds_read_b64_tr_b16 v[116:117], v152 offset:4096
ds_read_b64_tr_b16 v[118:119], v152 offset:4608
v_mfma_f32_32x32x16_bf16 v[20:35], v[132:135], v[108:111], v[20:35]
ds_read_b64_tr_b16 v[120:121], v152 offset:12288
ds_read_b64_tr_b16 v[122:123], v152 offset:12800
v_mfma_f32_32x32x16_bf16 v[68:83], v[132:135], v[112:115], v[68:83]
ds_read_b64_tr_b16 v[124:125], v152 offset:20480
ds_read_b64_tr_b16 v[126:127], v152 offset:20992
s_add_u32 m0, s48, 106496
s_nop 0
buffer_load_dwordx4 v161, s[28:31], s43 offen lds
v_mfma_f32_32x32x16_bf16 v[36:51], v[108:111], v[136:139], v[36:51]
s_add_u32 m0, s48, 107520
s_nop 0
buffer_load_dwordx4 v162, s[28:31], s43 offen lds
v_mfma_f32_32x32x16_bf16 v[84:99], v[112:115], v[136:139], v[84:99]
s_add_u32 m0, s48, 114688
s_nop 0
buffer_load_dwordx4 v163, s[28:31], s43 offen lds
s_waitcnt lgkmcnt(0)
v_mfma_f32_32x32x16_bf16 v[4:19], v[116:119], v[100:103], v[4:19]
ds_read_b128 v[108:111], v143 offset:0
ds_read_b128 v[112:115], v143 offset:4096
v_mfma_f32_32x32x16_bf16 v[52:67], v[116:119], v[104:107], v[52:67]
ds_read_b64_tr_b16 v[128:129], v152 offset:6144
ds_read_b64_tr_b16 v[130:131], v152 offset:6656
v_mfma_f32_32x32x16_bf16 v[20:35], v[120:123], v[100:103], v[20:35]
ds_read_b64_tr_b16 v[132:133], v152 offset:14336
ds_read_b64_tr_b16 v[134:135], v152 offset:14848
v_mfma_f32_32x32x16_bf16 v[68:83], v[120:123], v[104:107], v[68:83]
ds_read_b64_tr_b16 v[136:137], v152 offset:22528
ds_read_b64_tr_b16 v[138:139], v152 offset:23040
s_add_u32 m0, s48, 115712
s_nop 0
buffer_load_dwordx4 v164, s[28:31], s43 offen lds
v_mfma_f32_32x32x16_bf16 v[36:51], v[100:103], v[124:127], v[36:51]
s_add_u32 s42, s42, 128
s_and_b32 s42, s42, 2047
s_mul_i32 s43, s42, 3072
v_mfma_f32_32x32x16_bf16 v[84:99], v[104:107], v[124:127], v[84:99]
s_waitcnt lgkmcnt(0)
s_waitcnt vmcnt(10)
s_barrier
v_mfma_f32_32x32x16_bf16 v[4:19], v[128:131], v[108:111], v[4:19]
ds_read_b128 v[100:103], v144 offset:0
ds_read_b128 v[104:107], v144 offset:4096
v_mfma_f32_32x32x16_bf16 v[52:67], v[128:131], v[112:115], v[52:67]
ds_read_b64_tr_b16 v[116:117], v153 offset:0
ds_read_b64_tr_b16 v[118:119], v153 offset:512
v_mfma_f32_32x32x16_bf16 v[20:35], v[132:135], v[108:111], v[20:35]
ds_read_b64_tr_b16 v[120:121], v153 offset:8192
ds_read_b64_tr_b16 v[122:123], v153 offset:8704
v_mfma_f32_32x32x16_bf16 v[68:83], v[132:135], v[112:115], v[68:83]
ds_read_b64_tr_b16 v[124:125], v153 offset:16384
ds_read_b64_tr_b16 v[126:127], v153 offset:16896
s_add_u32 m0, s45, 0
s_nop 0
buffer_load_dwordx4 v155, s[24:27], s42 offen lds
v_mfma_f32_32x32x16_bf16 v[36:51], v[108:111], v[136:139], v[36:51]
s_add_u32 m0, s45, 1024
s_nop 0
buffer_load_dwordx4 v156, s[24:27], s42 offen lds
v_mfma_f32_32x32x16_bf16 v[84:99], v[112:115], v[136:139], v[84:99]
s_add_u32 m0, s45, 2048
s_nop 0
buffer_load_dwordx4 v157, s[24:27], s42 offen lds
s_waitcnt lgkmcnt(0)
v_mfma_f32_32x32x16_bf16 v[4:19], v[116:119], v[100:103], v[4:19]
ds_read_b128 v[108:111], v145 offset:0
ds_read_b128 v[112:115], v145 offset:4096
v_mfma_f32_32x32x16_bf16 v[52:67], v[116:119], v[104:107], v[52:67]
ds_read_b64_tr_b16 v[128:129], v153 offset:2048
ds_read_b64_tr_b16 v[130:131], v153 offset:2560
v_mfma_f32_32x32x16_bf16 v[20:35], v[120:123], v[100:103], v[20:35]
ds_read_b64_tr_b16 v[132:133], v153 offset:10240
ds_read_b64_tr_b16 v[134:135], v153 offset:10752
v_mfma_f32_32x32x16_bf16 v[68:83], v[120:123], v[104:107], v[68:83]
ds_read_b64_tr_b16 v[136:137], v153 offset:18432
ds_read_b64_tr_b16 v[138:139], v153 offset:18944
s_add_u32 m0, s45, 3072
s_nop 0
buffer_load_dwordx4 v158, s[24:27], s42 offen lds
v_mfma_f32_32x32x16_bf16 v[36:51], v[100:103], v[124:127], v[36:51]
s_add_u32 m0, s48, 16384
s_nop 0
buffer_load_dwordx4 v159, s[28:31], s43 offen lds
v_mfma_f32_32x32x16_bf16 v[84:99], v[104:107], v[124:127], v[84:99]
s_add_u32 m0, s48, 17408
s_nop 0
buffer_load_dwordx4 v160, s[28:31], s43 offen lds
s_waitcnt lgkmcnt(0)
v_mfma_f32_32x32x16_bf16 v[4:19], v[128:131], v[108:111], v[4:19]
ds_read_b128 v[100:103], v146 offset:0
ds_read_b128 v[104:107], v146 offset:4096
v_mfma_f32_32x32x16_bf16 v[52:67], v[128:131], v[112:115], v[52:67]
ds_read_b64_tr_b16 v[116:117], v153 offset:4096
ds_read_b64_tr_b16 v[118:119], v153 offset:4608
v_mfma_f32_32x32x16_bf16 v[20:35], v[132:135], v[108:111], v[20:35]
ds_read_b64_tr_b16 v[120:121], v153 offset:12288
ds_read_b64_tr_b16 v[122:123], v153 offset:12800
v_mfma_f32_32x32x16_bf16 v[68:83], v[132:135], v[112:115], v[68:83]
ds_read_b64_tr_b16 v[124:125], v153 offset:20480
ds_read_b64_tr_b16 v[126:127], v153 offset:20992
s_add_u32 m0, s48, 24576
s_nop 0
buffer_load_dwordx4 v161, s[28:31], s43 offen lds
v_mfma_f32_32x32x16_bf16 v[36:51], v[108:111], v[136:139], v[36:51]
s_add_u32 m0, s48, 25600
s_nop 0
buffer_load_dwordx4 v162, s[28:31], s43 offen lds
v_mfma_f32_32x32x16_bf16 v[84:99], v[112:115], v[136:139], v[84:99]
s_add_u32 m0, s48, 32768
s_nop 0
buffer_load_dwordx4 v163, s[28:31], s43 offen lds
s_waitcnt lgkmcnt(0)
v_mfma_f32_32x32x16_bf16 v[4:19], v[116:119], v[100:103], v[4:19]
ds_read_b128 v[108:111], v147 offset:0
ds_read_b128 v[112:115], v147 offset:4096
v_mfma_f32_32x32x16_bf16 v[52:67], v[116:119], v[104:107], v[52:67]
ds_read_b64_tr_b16 v[128:129], v153 offset:6144
ds_read_b64_tr_b16 v[130:131], v153 offset:6656
v_mfma_f32_32x32x16_bf16 v[20:35], v[120:123], v[100:103], v[20:35]
ds_read_b64_tr_b16 v[132:133], v153 offset:14336
ds_read_b64_tr_b16 v[134:135], v153 offset:14848
v_mfma_f32_32x32x16_bf16 v[68:83], v[120:123], v[104:107], v[68:83]
ds_read_b64_tr_b16 v[136:137], v153 offset:22528
ds_read_b64_tr_b16 v[138:139], v153 offset:23040
s_add_u32 m0, s48, 33792
s_nop 0
buffer_load_dwordx4 v164, s[28:31], s43 offen lds
v_mfma_f32_32x32x16_bf16 v[36:51], v[100:103], v[124:127], v[36:51]
s_add_u32 s42, s42, 128
s_and_b32 s42, s42, 2047
s_mul_i32 s43, s42, 3072
v_mfma_f32_32x32x16_bf16 v[84:99], v[104:107], v[124:127], v[84:99]
s_waitcnt lgkmcnt(0)
s_waitcnt vmcnt(10)
s_barrier
v_mfma_f32_32x32x16_bf16 v[4:19], v[128:131], v[108:111], v[4:19]
ds_read_b128 v[100:103], v148 offset:0
ds_read_b128 v[104:107], v148 offset:4096
v_mfma_f32_32x32x16_bf16 v[52:67], v[128:131], v[112:115], v[52:67]
ds_read_b64_tr_b16 v[116:117], v154 offset:0
ds_read_b64_tr_b16 v[118:119], v154 offset:512
v_mfma_f32_32x32x16_bf16 v[20:35], v[132:135], v[108:111], v[20:35]
ds_read_b64_tr_b16 v[120:121], v154 offset:8192
ds_read_b64_tr_b16 v[122:123], v154 offset:8704
v_mfma_f32_32x32x16_bf16 v[68:83], v[132:135], v[112:115], v[68:83]
ds_read_b64_tr_b16 v[124:125], v154 offset:16384
ds_read_b64_tr_b16 v[126:127], v154 offset:16896
v_mfma_f32_32x32x16_bf16 v[36:51], v[108:111], v[136:139], v[36:51]
v_mfma_f32_32x32x16_bf16 v[84:99], v[112:115], v[136:139], v[84:99]
s_waitcnt lgkmcnt(0)
v_mfma_f32_32x32x16_bf16 v[4:19], v[116:119], v[100:103], v[4:19]
ds_read_b128 v[108:111], v149 offset:0
ds_read_b128 v[112:115], v149 offset:4096
v_mfma_f32_32x32x16_bf16 v[52:67], v[116:119], v[104:107], v[52:67]
ds_read_b64_tr_b16 v[128:129], v154 offset:2048
ds_read_b64_tr_b16 v[130:131], v154 offset:2560
v_mfma_f32_32x32x16_bf16 v[20:35], v[120:123], v[100:103], v[20:35]
ds_read_b64_tr_b16 v[132:133], v154 offset:10240
ds_read_b64_tr_b16 v[134:135], v154 offset:10752
v_mfma_f32_32x32x16_bf16 v[68:83], v[120:123], v[104:107], v[68:83]
ds_read_b64_tr_b16 v[136:137], v154 offset:18432
ds_read_b64_tr_b16 v[138:139], v154 offset:18944
v_mfma_f32_32x32x16_bf16 v[36:51], v[100:103], v[124:127], v[36:51]
v_mfma_f32_32x32x16_bf16 v[84:99], v[104:107], v[124:127], v[84:99]
s_waitcnt lgkmcnt(0)
v_mfma_f32_32x32x16_bf16 v[4:19], v[128:131], v[108:111], v[4:19]
ds_read_b128 v[100:103], v150 offset:0
ds_read_b128 v[104:107], v150 offset:4096
v_mfma_f32_32x32x16_bf16 v[52:67], v[128:131], v[112:115], v[52:67]
ds_read_b64_tr_b16 v[116:117], v154 offset:4096
ds_read_b64_tr_b16 v[118:119], v154 offset:4608
v_mfma_f32_32x32x16_bf16 v[20:35], v[132:135], v[108:111], v[20:35]
ds_read_b64_tr_b16 v[120:121], v154 offset:12288
ds_read_b64_tr_b16 v[122:123], v154 offset:12800
v_mfma_f32_32x32x16_bf16 v[68:83], v[132:135], v[112:115], v[68:83]
ds_read_b64_tr_b16 v[124:125], v154 offset:20480
ds_read_b64_tr_b16 v[126:127], v154 offset:20992
v_mfma_f32_32x32x16_bf16 v[36:51], v[108:111], v[136:139], v[36:51]
v_mfma_f32_32x32x16_bf16 v[84:99], v[112:115], v[136:139], v[84:99]
s_waitcnt lgkmcnt(0)
v_mfma_f32_32x32x16_bf16 v[4:19], v[116:119], v[100:103], v[4:19]
ds_read_b128 v[108:111], v151 offset:0
ds_read_b128 v[112:115], v151 offset:4096
v_mfma_f32_32x32x16_bf16 v[52:67], v[116:119], v[104:107], v[52:67]
ds_read_b64_tr_b16 v[128:129], v154 offset:6144
ds_read_b64_tr_b16 v[130:131], v154 offset:6656
v_mfma_f32_32x32x16_bf16 v[20:35], v[120:123], v[100:103], v[20:35]
ds_read_b64_tr_b16 v[132:133], v154 offset:14336
ds_read_b64_tr_b16 v[134:135], v154 offset:14848
v_mfma_f32_32x32x16_bf16 v[68:83], v[120:123], v[104:107], v[68:83]
ds_read_b64_tr_b16 v[136:137], v154 offset:22528
ds_read_b64_tr_b16 v[138:139], v154 offset:23040
v_mfma_f32_32x32x16_bf16 v[36:51], v[100:103], v[124:127], v[36:51]
v_mfma_f32_32x32x16_bf16 v[84:99], v[104:107], v[124:127], v[84:99]
s_waitcnt lgkmcnt(0)
s_waitcnt vmcnt(0)
s_barrier
v_mfma_f32_32x32x16_bf16 v[4:19], v[128:131], v[108:111], v[4:19]
ds_read_b128 v[100:103], v140 offset:0
ds_read_b128 v[104:107], v140 offset:4096
v_mfma_f32_32x32x16_bf16 v[52:67], v[128:131], v[112:115], v[52:67]
ds_read_b64_tr_b16 v[116:117], v152 offset:0
ds_read_b64_tr_b16 v[118:119], v152 offset:512
v_mfma_f32_32x32x16_bf16 v[20:35], v[132:135], v[108:111], v[20:35]
ds_read_b64_tr_b16 v[120:121], v152 offset:8192
ds_read_b64_tr_b16 v[122:123], v152 offset:8704
v_mfma_f32_32x32x16_bf16 v[68:83], v[132:135], v[112:115], v[68:83]
ds_read_b64_tr_b16 v[124:125], v152 offset:16384
ds_read_b64_tr_b16 v[126:127], v152 offset:16896
v_mfma_f32_32x32x16_bf16 v[36:51], v[108:111], v[136:139], v[36:51]
v_mfma_f32_32x32x16_bf16 v[84:99], v[112:115], v[136:139], v[84:99]
s_waitcnt lgkmcnt(0)
v_mfma_f32_32x32x16_bf16 v[4:19], v[116:119], v[100:103], v[4:19]
ds_read_b128 v[108:111], v141 offset:0
ds_read_b128 v[112:115], v141 offset:4096
v_mfma_f32_32x32x16_bf16 v[52:67], v[116:119], v[104:107], v[52:67]
ds_read_b64_tr_b16 v[128:129], v152 offset:2048
ds_read_b64_tr_b16 v[130:131], v152 offset:2560
v_mfma_f32_32x32x16_bf16 v[20:35], v[120:123], v[100:103], v[20:35]
ds_read_b64_tr_b16 v[132:133], v152 offset:10240
ds_read_b64_tr_b16 v[134:135], v152 offset:10752
v_mfma_f32_32x32x16_bf16 v[68:83], v[120:123], v[104:107], v[68:83]
ds_read_b64_tr_b16 v[136:137], v152 offset:18432
ds_read_b64_tr_b16 v[138:139], v152 offset:18944
v_mfma_f32_32x32x16_bf16 v[36:51], v[100:103], v[124:127], v[36:51]
v_mfma_f32_32x32x16_bf16 v[84:99], v[104:107], v[124:127], v[84:99]
s_waitcnt lgkmcnt(0)
v_mfma_f32_32x32x16_bf16 v[4:19], v[128:131], v[108:111], v[4:19]
ds_read_b128 v[100:103], v142 offset:0
ds_read_b128 v[104:107], v142 offset:4096
v_mfma_f32_32x32x16_bf16 v[52:67], v[128:131], v[112:115], v[52:67]
ds_read_b64_tr_b16 v[116:117], v152 offset:4096
ds_read_b64_tr_b16 v[118:119], v152 offset:4608
v_mfma_f32_32x32x16_bf16 v[20:35], v[132:135], v[108:111], v[20:35]
ds_read_b64_tr_b16 v[120:121], v152 offset:12288
ds_read_b64_tr_b16 v[122:123], v152 offset:12800
v_mfma_f32_32x32x16_bf16 v[68:83], v[132:135], v[112:115], v[68:83]
ds_read_b64_tr_b16 v[124:125], v152 offset:20480
ds_read_b64_tr_b16 v[126:127], v152 offset:20992
v_mfma_f32_32x32x16_bf16 v[36:51], v[108:111], v[136:139], v[36:51]
v_mfma_f32_32x32x16_bf16 v[84:99], v[112:115], v[136:139], v[84:99]
s_waitcnt lgkmcnt(0)
v_mfma_f32_32x32x16_bf16 v[4:19], v[116:119], v[100:103], v[4:19]
ds_read_b128 v[108:111], v143 offset:0
ds_read_b128 v[112:115], v143 offset:4096
v_mfma_f32_32x32x16_bf16 v[52:67], v[116:119], v[104:107], v[52:67]
ds_read_b64_tr_b16 v[128:129], v152 offset:6144
ds_read_b64_tr_b16 v[130:131], v152 offset:6656
v_mfma_f32_32x32x16_bf16 v[20:35], v[120:123], v[100:103], v[20:35]
ds_read_b64_tr_b16 v[132:133], v152 offset:14336
ds_read_b64_tr_b16 v[134:135], v152 offset:14848
v_mfma_f32_32x32x16_bf16 v[68:83], v[120:123], v[104:107], v[68:83]
ds_read_b64_tr_b16 v[136:137], v152 offset:22528
ds_read_b64_tr_b16 v[138:139], v152 offset:23040
v_mfma_f32_32x32x16_bf16 v[36:51], v[100:103], v[124:127], v[36:51]
v_mfma_f32_32x32x16_bf16 v[84:99], v[104:107], v[124:127], v[84:99]
s_waitcnt lgkmcnt(0)
s_barrier
v_mfma_f32_32x32x16_bf16 v[4:19], v[128:131], v[108:111], v[4:19]
v_mfma_f32_32x32x16_bf16 v[52:67], v[128:131], v[112:115], v[52:67]
v_mfma_f32_32x32x16_bf16 v[20:35], v[132:135], v[108:111], v[20:35]
v_mfma_f32_32x32x16_bf16 v[68:83], v[132:135], v[112:115], v[68:83]
v_mfma_f32_32x32x16_bf16 v[36:51], v[108:111], v[136:139], v[36:51]
v_mfma_f32_32x32x16_bf16 v[84:99], v[112:115], v[136:139], v[84:99]
s_lshl_b32 s44, s41, 1
s_add_u32 s44, s44, s47
s_mul_i32 s44, s44, 131072
s_lshl_b32 s48, s40, 1
s_add_u32 s48, s48, s46
s_lshl_b32 s48, s48, 12
s_add_u32 s44, s44, s48
s_lshl_b32 s42, s12, 13
s_add_u32 s42, s42, 65536
v_and_b32 v165, 31, v169
v_lshrrev_b32 v166, 5, v169
v_bfe_u32 v167, v169, 1, 2
v_xor_b32 v167, v167, v166
v_lshlrev_b32 v155, 6, v165
v_lshl_add_u32 v155, v167, 4, v155
v_add_u32 v155, s42, v155
v_xor_b32 v156, 32, v155
v_bfe_u32 v167, v169, 3, 2
v_lshlrev_b32 v167, 4, v167
v_lshlrev_b32 v158, 4, v169
v_xor_b32 v157, v158, v167
v_add_u32 v157, s42, v157
v_add_u32 v158, s44, v158
s_mov_b32 s48, 1048744942
v_cvt_pk_bf16_f32 v20, v20, v21
v_cvt_pk_bf16_f32 v21, v22, v23
v_cvt_pk_bf16_f32 v22, v24, v25
v_cvt_pk_bf16_f32 v23, v26, v27
v_cvt_pk_bf16_f32 v24, v28, v29
v_cvt_pk_bf16_f32 v25, v30, v31
v_cvt_pk_bf16_f32 v26, v32, v33
v_cvt_pk_bf16_f32 v27, v34, v35
v_permlane32_swap_b32 v20, v22
v_permlane32_swap_b32 v21, v23
v_permlane32_swap_b32 v24, v26
v_permlane32_swap_b32 v25, v27
ds_write_b128 v155, v[20:23] offset:4096
ds_write_b128 v156, v[24:27] offset:4096
v_cvt_pk_bf16_f32 v68, v68, v69
v_cvt_pk_bf16_f32 v69, v70, v71
v_cvt_pk_bf16_f32 v70, v72, v73
v_cvt_pk_bf16_f32 v71, v74, v75
v_cvt_pk_bf16_f32 v72, v76, v77
v_cvt_pk_bf16_f32 v73, v78, v79
v_cvt_pk_bf16_f32 v74, v80, v81
v_cvt_pk_bf16_f32 v75, v82, v83
v_permlane32_swap_b32 v68, v70
v_permlane32_swap_b32 v69, v71
v_permlane32_swap_b32 v72, v74
v_permlane32_swap_b32 v73, v75
ds_write_b128 v155, v[68:71] offset:6144
ds_write_b128 v156, v[72:75] offset:6144
s_waitcnt lgkmcnt(0)
ds_read_b128 v[28:31], v157 offset:4096
ds_read_b128 v[32:35], v157 offset:5120
ds_read_b128 v[76:79], v157 offset:6144
ds_read_b128 v[80:83], v157 offset:7168
s_mov_b32 s43, 4194304
s_waitcnt lgkmcnt(3)
buffer_store_dwordx4 v[28:31], v158, s[32:35], s43 offen offset:0 sc1
s_waitcnt lgkmcnt(2)
buffer_store_dwordx4 v[32:35], v158, s[32:35], s43 offen offset:1024 sc1
s_waitcnt lgkmcnt(1)
buffer_store_dwordx4 v[76:79], v158, s[32:35], s43 offen offset:2048 sc1
s_waitcnt lgkmcnt(0)
buffer_store_dwordx4 v[80:83], v158, s[32:35], s43 offen offset:3072 sc1
v_cvt_pk_bf16_f32 v36, v36, v37
v_cvt_pk_bf16_f32 v37, v38, v39
v_cvt_pk_bf16_f32 v38, v40, v41
v_cvt_pk_bf16_f32 v39, v42, v43
v_cvt_pk_bf16_f32 v40, v44, v45
v_cvt_pk_bf16_f32 v41, v46, v47
v_cvt_pk_bf16_f32 v42, v48, v49
v_cvt_pk_bf16_f32 v43, v50, v51
v_permlane32_swap_b32 v36, v38
v_permlane32_swap_b32 v37, v39
v_permlane32_swap_b32 v40, v42
v_permlane32_swap_b32 v41, v43
ds_write_b128 v155, v[36:39] offset:0
ds_write_b128 v156, v[40:43] offset:0
v_cvt_pk_bf16_f32 v84, v84, v85
v_cvt_pk_bf16_f32 v85, v86, v87
v_cvt_pk_bf16_f32 v86, v88, v89
v_cvt_pk_bf16_f32 v87, v90, v91
v_cvt_pk_bf16_f32 v88, v92, v93
v_cvt_pk_bf16_f32 v89, v94, v95
v_cvt_pk_bf16_f32 v90, v96, v97
v_cvt_pk_bf16_f32 v91, v98, v99
v_permlane32_swap_b32 v84, v86
v_permlane32_swap_b32 v85, v87
v_permlane32_swap_b32 v88, v90
v_permlane32_swap_b32 v89, v91
ds_write_b128 v155, v[84:87] offset:2048
ds_write_b128 v156, v[88:91] offset:2048
s_waitcnt lgkmcnt(0)
ds_read_b128 v[44:47], v157 offset:0
ds_read_b128 v[48:51], v157 offset:1024
ds_read_b128 v[92:95], v157 offset:2048
ds_read_b128 v[96:99], v157 offset:3072
s_mov_b32 s43, 8388608
s_waitcnt lgkmcnt(3)
buffer_store_dwordx4 v[44:47], v158, s[32:35], s43 offen offset:0 sc1
s_waitcnt lgkmcnt(2)
buffer_store_dwordx4 v[48:51], v158, s[32:35], s43 offen offset:1024 sc1
s_waitcnt lgkmcnt(1)
buffer_store_dwordx4 v[92:95], v158, s[32:35], s43 offen offset:2048 sc1
s_waitcnt lgkmcnt(0)
buffer_store_dwordx4 v[96:99], v158, s[32:35], s43 offen offset:3072 sc1
v_mul_f32 v4, s48, v4
v_mul_f32 v5, s48, v5
v_mul_f32 v6, s48, v6
v_mul_f32 v7, s48, v7
v_mul_f32 v8, s48, v8
v_mul_f32 v9, s48, v9
v_mul_f32 v10, s48, v10
v_mul_f32 v11, s48, v11
v_mul_f32 v12, s48, v12
v_mul_f32 v13, s48, v13
v_mul_f32 v14, s48, v14
v_mul_f32 v15, s48, v15
v_mul_f32 v16, s48, v16
v_mul_f32 v17, s48, v17
v_mul_f32 v18, s48, v18
v_mul_f32 v19, s48, v19
v_cvt_pk_bf16_f32 v4, v4, v5
v_cvt_pk_bf16_f32 v5, v6, v7
v_cvt_pk_bf16_f32 v6, v8, v9
v_cvt_pk_bf16_f32 v7, v10, v11
v_cvt_pk_bf16_f32 v8, v12, v13
v_cvt_pk_bf16_f32 v9, v14, v15
v_cvt_pk_bf16_f32 v10, v16, v17
v_cvt_pk_bf16_f32 v11, v18, v19
v_permlane32_swap_b32 v4, v6
v_permlane32_swap_b32 v5, v7
v_permlane32_swap_b32 v8, v10
v_permlane32_swap_b32 v9, v11
ds_write_b128 v155, v[4:7] offset:0
ds_write_b128 v156, v[8:11] offset:0
v_mul_f32 v52, s48, v52
v_mul_f32 v53, s48, v53
v_mul_f32 v54, s48, v54
v_mul_f32 v55, s48, v55
v_mul_f32 v56, s48, v56
v_mul_f32 v57, s48, v57
v_mul_f32 v58, s48, v58
v_mul_f32 v59, s48, v59
v_mul_f32 v60, s48, v60
v_mul_f32 v61, s48, v61
v_mul_f32 v62, s48, v62
v_mul_f32 v63, s48, v63
v_mul_f32 v64, s48, v64
v_mul_f32 v65, s48, v65
v_mul_f32 v66, s48, v66
v_mul_f32 v67, s48, v67
v_cvt_pk_bf16_f32 v52, v52, v53
v_cvt_pk_bf16_f32 v53, v54, v55
v_cvt_pk_bf16_f32 v54, v56, v57
v_cvt_pk_bf16_f32 v55, v58, v59
v_cvt_pk_bf16_f32 v56, v60, v61
v_cvt_pk_bf16_f32 v57, v62, v63
v_cvt_pk_bf16_f32 v58, v64, v65
v_cvt_pk_bf16_f32 v59, v66, v67
v_permlane32_swap_b32 v52, v54
v_permlane32_swap_b32 v53, v55
v_permlane32_swap_b32 v56, v58
v_permlane32_swap_b32 v57, v59
ds_write_b128 v155, v[52:55] offset:2048
ds_write_b128 v156, v[56:59] offset:2048
s_waitcnt lgkmcnt(0)
ds_read_b128 v[12:15], v157 offset:0
ds_read_b128 v[16:19], v157 offset:1024
ds_read_b128 v[60:63], v157 offset:2048
ds_read_b128 v[64:67], v157 offset:3072
s_mov_b32 s43, 0
s_waitcnt lgkmcnt(3)
buffer_store_dwordx4 v[12:15], v158, s[32:35], s43 offen offset:0 sc1
s_waitcnt lgkmcnt(2)
buffer_store_dwordx4 v[16:19], v158, s[32:35], s43 offen offset:1024 sc1
s_waitcnt lgkmcnt(1)
buffer_store_dwordx4 v[60:63], v158, s[32:35], s43 offen offset:2048 sc1
s_waitcnt lgkmcnt(0)
buffer_store_dwordx4 v[64:67], v158, s[32:35], s43 offen offset:3072 sc1
v_mov_b32 v165, 0
s_mov_b32 s101, 0
L_tokm:
global_load_dword v166, v165, s[52:53] sc1
s_waitcnt vmcnt(0)
v_readfirstlane_b32 s100, v166
s_add_u32 s101, s101, 1
s_cmp_ge_u32 s101, 0x400000
s_cbranch_scc1 L_tokxm
s_cmp_eq_u32 s100, 0
s_cbranch_scc1 L_tokm
L_tokxm:
s_add_u32 s56, s54, 41955328
s_addc_u32 s57, s55, 0
s_lshl_b32 s44, s41, 1
s_add_u32 s44, s44, s47
s_lshl_b32 s44, s44, 5
s_lshl_b32 s48, s40, 1
s_add_u32 s44, s44, s48
s_add_u32 s44, s44, s46
s_lshl_b32 s44, s44, 2
v_mov_b32 v165, s44
v_mov_b32 v166, s100
s_mov_b64 exec, 1
global_store_dword v165, v166, s[56:57] sc1
s_mov_b64 exec, -1
s_mov_b64 s[4:5], s[54:55]
v_and_b32 v191, 63, v0
s_and_b32 s13, s2, 7
s_lshl_b32 s13, s13, 2
s_lshr_b32 s15, s2, 6
s_add_u32 s13, s13, s15
s_bfe_u32 s14, s2, 0x30003
s_mul_i32 s21, s13, 131072
s_mov_b32 s20, 1233125376
v_and_b32 v192, 31, v191
v_lshrrev_b32 v193, 5, v191
v_and_b32 v194, 19, v191
v_and_b32 v195, 4, v191
v_lshl_or_b32 v194, v195, 1, v194
v_and_b32 v195, 8, v191
v_lshrrev_b32 v195, 1, v195
v_or_b32 v194, v194, v195
v_lshlrev_b32 v189, 6, v194
v_bfe_u32 v195, v194, 2, 2
v_xor_b32 v195, v195, v193
v_lshl_add_u32 v184, v195, 4, v189
v_xor_b32 v185, 32, v184
v_lshl_add_u32 v189, v193, 4, v189
v_add_u32 v189, 4194304, v189
v_lshlrev_b32 v190, 6, v192
v_bfe_u32 v195, v191, 2, 2
v_xor_b32 v195, v195, v193
v_lshl_add_u32 v186, v195, 4, v190
v_add_u32 v186, 8192, v186
v_xor_b32 v187, 32, v186
v_lshl_add_u32 v190, v193, 4, v190
v_add_u32 v190, 8388608, v190
s_lshl_b32 s15, s14, 2
s_add_u32 s15, s15, s12
s_lshl_b32 s15, s15, 6
v_add_u32 v194, s15, v192
v_lshlrev_b32 v194, 6, v194
v_lshl_add_u32 v194, v193, 4, v194
v_lshrrev_b32 v196, 4, v191
v_and_b32 v195, 3, v191
v_xor_b32 v195, v195, v196
v_lshrrev_b32 v188, 2, v191
v_lshlrev_b32 v188, 6, v188
v_lshl_add_u32 v188, v195, 4, v188
s_lshl_b32 s18, s12, 11
v_add_u32 v188, s18, v188
v_add_u32 v188, 2048, v188
s_add_u32 s17, s21, 4194304
s_add_u32 s23, s21, 8388608
s_mov_b32 s8, s4
s_and_b32 s9, s5, 0xffff
s_mov_b32 s10, 50331648
s_mov_b32 s11, 0x20000
v_mov_b32 v36, 0
v_mov_b32 v37, 0
v_mov_b32 v38, 0
v_mov_b32 v39, 0
v_mov_b32 v40, 0
v_mov_b32 v41, 0
v_mov_b32 v42, 0
v_mov_b32 v43, 0
v_mov_b32 v44, 0
v_mov_b32 v45, 0
v_mov_b32 v46, 0
v_mov_b32 v47, 0
v_mov_b32 v48, 0
v_mov_b32 v49, 0
v_mov_b32 v50, 0
v_mov_b32 v51, 0
v_mov_b32 v164, 0
v_mov_b32 v52, 0
v_mov_b32 v53, 0
v_mov_b32 v54, 0
v_mov_b32 v55, 0
v_mov_b32 v56, 0
v_mov_b32 v57, 0
v_mov_b32 v58, 0
v_mov_b32 v59, 0
v_mov_b32 v60, 0
v_mov_b32 v61, 0
v_mov_b32 v62, 0
v_mov_b32 v63, 0
v_mov_b32 v64, 0
v_mov_b32 v65, 0
v_mov_b32 v66, 0
v_mov_b32 v67, 0
v_mov_b32 v168, 0
v_mov_b32 v108, 0
v_mov_b32 v109, 0
v_mov_b32 v110, 0
v_mov_b32 v111, 0
v_mov_b32 v112, 0
v_mov_b32 v113, 0
v_mov_b32 v114, 0
v_mov_b32 v115, 0
v_mov_b32 v156, 0
v_mov_b32 v157, 0
v_mov_b32 v158, 0
v_mov_b32 v159, 0
v_mov_b32 v160, 0
v_mov_b32 v161, 0
v_mov_b32 v162, 0
v_mov_b32 v163, 0
v_lshrrev_b32 v196, 4, v191
v_lshlrev_b32 v196, 2, v196
v_and_b32 v197, 15, v191
v_cmp_eq_u32 vcc, v196, v197
v_mov_b32 v196, 0x3f803f80
s_nop 0
v_cndmask_b32 v172, 0, v196, vcc
v_cndmask_b32 v173, 0, v196, vcc
v_cndmask_b32 v174, 0, v196, vcc
v_cndmask_b32 v175, 0, v196, vcc
v_mov_b32 v165, 0
v_mov_b32 v169, 0
v_mov_b32 v166, 0
v_mov_b32 v170, 0
v_mov_b32 v167, 0
v_mov_b32 v171, 0
s_lshl_b32 s15, s13, 7
v_lshl_add_u32 v196, v192, 2, s15
s_lshl_b32 s15, s14, 2
s_add_u32 s15, s15, s12
s_lshl_b32 s15, 1, s15
s_or_b32 s15, s15, 31
s_mov_b32 s16, 0
L_pollq:
global_load_dword v197, v196, s[56:57] sc1
s_waitcnt vmcnt(0)
v_cmp_eq_u32 vcc, s100, v197
s_nop 0
s_and_b32 s22, vcc_lo, s15
s_cmp_eq_u32 s22, s15
s_cbranch_scc1 L_readyq
s_sleep 4
s_add_u32 s16, s16, 1
s_cmp_lt_u32 s16, 0x200000
s_cbranch_scc1 L_pollq
L_readyq:
buffer_load_dwordx4 v[116:119], v194, s[8:11], s21 offen offset:0
buffer_load_dwordx4 v[120:123], v194, s[8:11], s21 offen offset:32
buffer_load_dwordx4 v[124:127], v194, s[8:11], s21 offen offset:2048
buffer_load_dwordx4 v[128:131], v194, s[8:11], s21 offen offset:2080
buffer_load_dwordx4 v[132:135], v189, s[8:11], s21 offen offset:0
buffer_load_dwordx4 v[136:139], v189, s[8:11], s21 offen offset:32
buffer_load_dwordx4 v[148:151], v190, s[8:11], s21 offen offset:0
buffer_load_dwordx4 v[152:155], v190, s[8:11], s21 offen offset:32
s_add_u32 m0, s18, 0
s_nop 0
buffer_load_dwordx4 v188, s[8:11], s17 offen lds
buffer_load_dwordx4 v188, s[8:11], s17 offen offset:1024 lds
s_add_u32 m0, s18, 8192
s_nop 0
buffer_load_dwordx4 v188, s[8:11], s23 offen lds
buffer_load_dwordx4 v188, s[8:11], s23 offen offset:1024 lds
s_add_u32 s17, s17, 8192
s_add_u32 s23, s23, 8192
s_add_u32 m0, s18, 16384
s_nop 0
buffer_load_dwordx4 v188, s[8:11], s17 offen lds
buffer_load_dwordx4 v188, s[8:11], s17 offen offset:1024 lds
s_add_u32 m0, s18, 24576
s_nop 0
buffer_load_dwordx4 v188, s[8:11], s23 offen lds
buffer_load_dwordx4 v188, s[8:11], s23 offen offset:1024 lds
s_add_u32 s17, s17, 8192
s_add_u32 s23, s23, 8192
s_waitcnt vmcnt(10)
v_mfma_f32_32x32x16_bf16 v[4:19], v[132:135], v[116:119], 0
v_mfma_f32_32x32x16_bf16 v[4:19], v[136:139], v[120:123], v[4:19]
v_mfma_f32_32x32x16_bf16 v[20:35], v[132:135], v[124:127], 0
v_mfma_f32_32x32x16_bf16 v[20:35], v[136:139], v[128:131], v[20:35]
s_nop 9
v_max3_f32 v195, v4, v5, v6
v_max3_f32 v195, v195, v7, v8
v_max3_f32 v195, v195, v9, v10
v_max3_f32 v195, v195, v11, v12
v_max3_f32 v195, v195, v13, v14
v_max3_f32 v195, v195, v15, v16
v_max3_f32 v195, v195, v17, v18
v_max_f32 v195, v195, v19
v_mov_b32 v194, v195
s_nop 1
v_permlane32_swap_b32 v195, v194
v_max_f32 v195, v195, v194
v_sub_f32 v68, 0, v195
v_sub_f32 v69, 0, v195
v_sub_f32 v70, 0, v195
v_sub_f32 v71, 0, v195
v_sub_f32 v72, 0, v195
v_sub_f32 v73, 0, v195
v_sub_f32 v74, 0, v195
v_sub_f32 v75, 0, v195
v_sub_f32 v76, 0, v195
v_sub_f32 v77, 0, v195
v_sub_f32 v78, 0, v195
v_sub_f32 v79, 0, v195
v_sub_f32 v80, 0, v195
v_sub_f32 v81, 0, v195
v_sub_f32 v82, 0, v195
v_sub_f32 v83, 0, v195
v_sub_f32 v4, v4, v195
v_sub_f32 v5, v5, v195
v_sub_f32 v6, v6, v195
v_sub_f32 v7, v7, v195
v_sub_f32 v8, v8, v195
v_sub_f32 v9, v9, v195
v_sub_f32 v10, v10, v195
v_sub_f32 v11, v11, v195
v_sub_f32 v12, v12, v195
v_sub_f32 v13, v13, v195
v_sub_f32 v14, v14, v195
v_sub_f32 v15, v15, v195
v_sub_f32 v16, v16, v195
v_sub_f32 v17, v17, v195
v_sub_f32 v18, v18, v195
v_sub_f32 v19, v19, v195
v_max3_f32 v195, v20, v21, v22
v_max3_f32 v195, v195, v23, v24
v_max3_f32 v195, v195, v25, v26
v_max3_f32 v195, v195, v27, v28
v_max3_f32 v195, v195, v29, v30
v_max3_f32 v195, v195, v31, v32
v_max3_f32 v195, v195, v33, v34
v_max_f32 v195, v195, v35
v_mov_b32 v194, v195
s_nop 1
v_permlane32_swap_b32 v195, v194
v_max_f32 v195, v195, v194
v_sub_f32 v84, 0, v195
v_sub_f32 v85, 0, v195
v_sub_f32 v86, 0, v195
v_sub_f32 v87, 0, v195
v_sub_f32 v88, 0, v195
v_sub_f32 v89, 0, v195
v_sub_f32 v90, 0, v195
v_sub_f32 v91, 0, v195
v_sub_f32 v92, 0, v195
v_sub_f32 v93, 0, v195
v_sub_f32 v94, 0, v195
v_sub_f32 v95, 0, v195
v_sub_f32 v96, 0, v195
v_sub_f32 v97, 0, v195
v_sub_f32 v98, 0, v195
v_sub_f32 v99, 0, v195
s_mov_b32 s19, 0
L_concat_heads__ssm_conv_h3__softmax_full_mha__prompt_kernel_loop:
s_waitcnt vmcnt(0) lgkmcnt(0)
s_barrier
v_max_f32 v194, v164, v168
v_cmp_lt_f32 vcc, s20, v194
s_nop 0
s_cbranch_vccnz L_concat_heads__ssm_conv_h3__softmax_full_mha__prompt_kernel_stub0
L_concat_heads__ssm_conv_h3__softmax_full_mha__prompt_kernel_back0:
v_exp_f32 v176, v4
v_mfma_f32_16x16x32_bf16 v[168:171], v[172:175], v[112:115], v[168:171]
v_exp_f32 v177, v5
v_exp_f32 v178, v6
v_exp_f32 v179, v7
v_mfma_f32_32x32x16_bf16 v[20:35], v[132:135], v[124:127], v[84:99]
ds_read_b128 v[140:143], v184 offset:0
v_cvt_pk_bf16_f32 v100, v176, v177
v_exp_f32 v180, v8
v_cvt_pk_bf16_f32 v101, v178, v179
v_exp_f32 v181, v9
v_exp_f32 v182, v10
v_mfma_f32_32x32x16_bf16 v[20:35], v[136:139], v[128:131], v[20:35]
ds_read_b128 v[144:147], v185 offset:0
v_exp_f32 v183, v11
v_cvt_pk_bf16_f32 v102, v180, v181
v_exp_f32 v176, v12
v_cvt_pk_bf16_f32 v103, v182, v183
v_exp_f32 v177, v13
v_mfma_f32_32x32x16_bf16 v[52:67], v[156:159], v[108:111], v[52:67]
v_exp_f32 v178, v14
v_exp_f32 v179, v15
v_cvt_pk_bf16_f32 v104, v176, v177
v_exp_f32 v180, v16
v_mfma_f32_16x16x32_bf16 v[164:167], v[172:175], v[100:103], v[164:167]
v_cvt_pk_bf16_f32 v105, v178, v179
v_exp_f32 v181, v17
v_mfma_f32_32x32x16_bf16 v[52:67], v[160:163], v[112:115], v[52:67]
v_exp_f32 v182, v18
v_exp_f32 v183, v19
v_cvt_pk_bf16_f32 v106, v180, v181
v_cvt_pk_bf16_f32 v107, v182, v183
s_waitcnt lgkmcnt(0)
v_exp_f32 v176, v20
v_mfma_f32_16x16x32_bf16 v[164:167], v[172:175], v[104:107], v[164:167]
v_exp_f32 v177, v21
v_exp_f32 v178, v22
v_exp_f32 v179, v23
v_mfma_f32_32x32x16_bf16 v[4:19], v[140:143], v[116:119], v[68:83]
ds_read_b128 v[156:159], v186 offset:0
v_cvt_pk_bf16_f32 v108, v176, v177
v_exp_f32 v180, v24
v_cvt_pk_bf16_f32 v109, v178, v179
v_exp_f32 v181, v25
v_exp_f32 v182, v26
v_mfma_f32_32x32x16_bf16 v[4:19], v[144:147], v[120:123], v[4:19]
ds_read_b128 v[160:163], v187 offset:0
v_exp_f32 v183, v27
v_cvt_pk_bf16_f32 v110, v180, v181
v_exp_f32 v176, v28
v_cvt_pk_bf16_f32 v111, v182, v183
v_exp_f32 v177, v29
v_mfma_f32_32x32x16_bf16 v[36:51], v[148:151], v[100:103], v[36:51]
v_exp_f32 v178, v30
v_exp_f32 v179, v31
v_cvt_pk_bf16_f32 v112, v176, v177
v_exp_f32 v180, v32
v_mfma_f32_16x16x32_bf16 v[168:171], v[172:175], v[108:111], v[168:171]
v_cvt_pk_bf16_f32 v113, v178, v179
v_exp_f32 v181, v33
v_mfma_f32_32x32x16_bf16 v[36:51], v[152:155], v[104:107], v[36:51]
v_exp_f32 v182, v34
v_exp_f32 v183, v35
v_cvt_pk_bf16_f32 v114, v180, v181
v_cvt_pk_bf16_f32 v115, v182, v183
s_waitcnt lgkmcnt(0)
v_exp_f32 v176, v4
v_mfma_f32_16x16x32_bf16 v[168:171], v[172:175], v[112:115], v[168:171]
v_exp_f32 v177, v5
v_exp_f32 v178, v6
v_exp_f32 v179, v7
v_mfma_f32_32x32x16_bf16 v[20:35], v[140:143], v[124:127], v[84:99]
ds_read_b128 v[132:135], v184 offset:2048
v_cvt_pk_bf16_f32 v100, v176, v177
v_exp_f32 v180, v8
v_cvt_pk_bf16_f32 v101, v178, v179
v_exp_f32 v181, v9
v_exp_f32 v182, v10
v_mfma_f32_32x32x16_bf16 v[20:35], v[144:147], v[128:131], v[20:35]
ds_read_b128 v[136:139], v185 offset:2048
v_exp_f32 v183, v11
v_cvt_pk_bf16_f32 v102, v180, v181
v_exp_f32 v176, v12
v_cvt_pk_bf16_f32 v103, v182, v183
v_exp_f32 v177, v13
v_mfma_f32_32x32x16_bf16 v[52:67], v[148:151], v[108:111], v[52:67]
v_exp_f32 v178, v14
v_exp_f32 v179, v15
v_cvt_pk_bf16_f32 v104, v176, v177
v_exp_f32 v180, v16
v_mfma_f32_16x16x32_bf16 v[164:167], v[172:175], v[100:103], v[164:167]
v_cvt_pk_bf16_f32 v105, v178, v179
v_exp_f32 v181, v17
v_mfma_f32_32x32x16_bf16 v[52:67], v[152:155], v[112:115], v[52:67]
v_exp_f32 v182, v18
v_exp_f32 v183, v19
v_cvt_pk_bf16_f32 v106, v180, v181
v_cvt_pk_bf16_f32 v107, v182, v183
s_waitcnt lgkmcnt(0)
v_exp_f32 v176, v20
v_mfma_f32_16x16x32_bf16 v[164:167], v[172:175], v[104:107], v[164:167]
v_exp_f32 v177, v21
v_exp_f32 v178, v22
v_exp_f32 v179, v23
v_mfma_f32_32x32x16_bf16 v[4:19], v[132:135], v[116:119], v[68:83]
ds_read_b128 v[148:151], v186 offset:2048
v_cvt_pk_bf16_f32 v108, v176, v177
v_exp_f32 v180, v24
v_cvt_pk_bf16_f32 v109, v178, v179
v_exp_f32 v181, v25
v_exp_f32 v182, v26
v_mfma_f32_32x32x16_bf16 v[4:19], v[136:139], v[120:123], v[4:19]
ds_read_b128 v[152:155], v187 offset:2048
v_exp_f32 v183, v27
v_cvt_pk_bf16_f32 v110, v180, v181
v_exp_f32 v176, v28
v_cvt_pk_bf16_f32 v111, v182, v183
v_exp_f32 v177, v29
v_mfma_f32_32x32x16_bf16 v[36:51], v[156:159], v[100:103], v[36:51]
v_exp_f32 v178, v30
v_exp_f32 v179, v31
v_cvt_pk_bf16_f32 v112, v176, v177
v_exp_f32 v180, v32
v_mfma_f32_16x16x32_bf16 v[168:171], v[172:175], v[108:111], v[168:171]
v_cvt_pk_bf16_f32 v113, v178, v179
v_exp_f32 v181, v33
v_mfma_f32_32x32x16_bf16 v[36:51], v[160:163], v[104:107], v[36:51]
v_exp_f32 v182, v34
v_exp_f32 v183, v35
v_cvt_pk_bf16_f32 v114, v180, v181
v_cvt_pk_bf16_f32 v115, v182, v183
s_waitcnt lgkmcnt(0)
v_exp_f32 v176, v4
v_mfma_f32_16x16x32_bf16 v[168:171], v[172:175], v[112:115], v[168:171]
v_exp_f32 v177, v5
v_exp_f32 v178, v6
v_exp_f32 v179, v7
v_mfma_f32_32x32x16_bf16 v[20:35], v[132:135], v[124:127], v[84:99]
ds_read_b128 v[140:143], v184 offset:4096
v_cvt_pk_bf16_f32 v100, v176, v177
v_exp_f32 v180, v8
v_cvt_pk_bf16_f32 v101, v178, v179
v_exp_f32 v181, v9
v_exp_f32 v182, v10
v_mfma_f32_32x32x16_bf16 v[20:35], v[136:139], v[128:131], v[20:35]
ds_read_b128 v[144:147], v185 offset:4096
v_exp_f32 v183, v11
v_cvt_pk_bf16_f32 v102, v180, v181
v_exp_f32 v176, v12
v_cvt_pk_bf16_f32 v103, v182, v183
v_exp_f32 v177, v13
v_mfma_f32_32x32x16_bf16 v[52:67], v[156:159], v[108:111], v[52:67]
v_exp_f32 v178, v14
v_exp_f32 v179, v15
v_cvt_pk_bf16_f32 v104, v176, v177
v_exp_f32 v180, v16
v_mfma_f32_16x16x32_bf16 v[164:167], v[172:175], v[100:103], v[164:167]
v_cvt_pk_bf16_f32 v105, v178, v179
v_exp_f32 v181, v17
v_mfma_f32_32x32x16_bf16 v[52:67], v[160:163], v[112:115], v[52:67]
v_exp_f32 v182, v18
v_exp_f32 v183, v19
v_cvt_pk_bf16_f32 v106, v180, v181
v_cvt_pk_bf16_f32 v107, v182, v183
s_waitcnt lgkmcnt(0)
v_exp_f32 v176, v20
v_mfma_f32_16x16x32_bf16 v[164:167], v[172:175], v[104:107], v[164:167]
v_exp_f32 v177, v21
v_exp_f32 v178, v22
v_exp_f32 v179, v23
v_mfma_f32_32x32x16_bf16 v[4:19], v[140:143], v[116:119], v[68:83]
ds_read_b128 v[156:159], v186 offset:4096
v_cvt_pk_bf16_f32 v108, v176, v177
v_exp_f32 v180, v24
v_cvt_pk_bf16_f32 v109, v178, v179
v_exp_f32 v181, v25
v_exp_f32 v182, v26
v_mfma_f32_32x32x16_bf16 v[4:19], v[144:147], v[120:123], v[4:19]
ds_read_b128 v[160:163], v187 offset:4096
v_exp_f32 v183, v27
v_cvt_pk_bf16_f32 v110, v180, v181
v_exp_f32 v176, v28
v_cvt_pk_bf16_f32 v111, v182, v183
v_exp_f32 v177, v29
v_mfma_f32_32x32x16_bf16 v[36:51], v[148:151], v[100:103], v[36:51]
v_exp_f32 v178, v30
v_exp_f32 v179, v31
v_cvt_pk_bf16_f32 v112, v176, v177
v_exp_f32 v180, v32
v_mfma_f32_16x16x32_bf16 v[168:171], v[172:175], v[108:111], v[168:171]
v_cvt_pk_bf16_f32 v113, v178, v179
v_exp_f32 v181, v33
v_mfma_f32_32x32x16_bf16 v[36:51], v[152:155], v[104:107], v[36:51]
v_exp_f32 v182, v34
v_exp_f32 v183, v35
v_cvt_pk_bf16_f32 v114, v180, v181
v_cvt_pk_bf16_f32 v115, v182, v183
s_waitcnt lgkmcnt(0)
v_exp_f32 v176, v4
v_mfma_f32_16x16x32_bf16 v[168:171], v[172:175], v[112:115], v[168:171]
v_exp_f32 v177, v5
v_exp_f32 v178, v6
v_exp_f32 v179, v7
v_mfma_f32_32x32x16_bf16 v[20:35], v[140:143], v[124:127], v[84:99]
ds_read_b128 v[132:135], v184 offset:6144
v_cvt_pk_bf16_f32 v100, v176, v177
v_exp_f32 v180, v8
v_cvt_pk_bf16_f32 v101, v178, v179
v_exp_f32 v181, v9
v_exp_f32 v182, v10
v_mfma_f32_32x32x16_bf16 v[20:35], v[144:147], v[128:131], v[20:35]
ds_read_b128 v[136:139], v185 offset:6144
v_exp_f32 v183, v11
v_cvt_pk_bf16_f32 v102, v180, v181
v_exp_f32 v176, v12
v_cvt_pk_bf16_f32 v103, v182, v183
v_exp_f32 v177, v13
v_mfma_f32_32x32x16_bf16 v[52:67], v[148:151], v[108:111], v[52:67]
v_exp_f32 v178, v14
v_exp_f32 v179, v15
v_cvt_pk_bf16_f32 v104, v176, v177
v_exp_f32 v180, v16
v_mfma_f32_16x16x32_bf16 v[164:167], v[172:175], v[100:103], v[164:167]
v_cvt_pk_bf16_f32 v105, v178, v179
v_exp_f32 v181, v17
v_mfma_f32_32x32x16_bf16 v[52:67], v[152:155], v[112:115], v[52:67]
v_exp_f32 v182, v18
v_exp_f32 v183, v19
v_cvt_pk_bf16_f32 v106, v180, v181
v_cvt_pk_bf16_f32 v107, v182, v183
s_waitcnt lgkmcnt(0)
v_exp_f32 v176, v20
v_mfma_f32_16x16x32_bf16 v[164:167], v[172:175], v[104:107], v[164:167]
v_exp_f32 v177, v21
v_exp_f32 v178, v22
v_exp_f32 v179, v23
v_mfma_f32_32x32x16_bf16 v[4:19], v[132:135], v[116:119], v[68:83]
ds_read_b128 v[148:151], v186 offset:6144
v_cvt_pk_bf16_f32 v108, v176, v177
v_exp_f32 v180, v24
v_cvt_pk_bf16_f32 v109, v178, v179
v_exp_f32 v181, v25
v_exp_f32 v182, v26
v_mfma_f32_32x32x16_bf16 v[4:19], v[136:139], v[120:123], v[4:19]
ds_read_b128 v[152:155], v187 offset:6144
v_exp_f32 v183, v27
v_cvt_pk_bf16_f32 v110, v180, v181
v_exp_f32 v176, v28
v_cvt_pk_bf16_f32 v111, v182, v183
v_exp_f32 v177, v29
v_mfma_f32_32x32x16_bf16 v[36:51], v[156:159], v[100:103], v[36:51]
v_exp_f32 v178, v30
v_exp_f32 v179, v31
v_cvt_pk_bf16_f32 v112, v176, v177
v_exp_f32 v180, v32
v_mfma_f32_16x16x32_bf16 v[168:171], v[172:175], v[108:111], v[168:171]
v_cvt_pk_bf16_f32 v113, v178, v179
v_exp_f32 v181, v33
v_mfma_f32_32x32x16_bf16 v[36:51], v[160:163], v[104:107], v[36:51]
v_exp_f32 v182, v34
v_exp_f32 v183, v35
v_cvt_pk_bf16_f32 v114, v180, v181
v_cvt_pk_bf16_f32 v115, v182, v183
s_waitcnt vmcnt(0) lgkmcnt(0)
s_barrier
v_max_f32 v194, v164, v168
v_cmp_lt_f32 vcc, s20, v194
s_nop 0
s_cbranch_vccnz L_concat_heads__ssm_conv_h3__softmax_full_mha__prompt_kernel_stub1
L_concat_heads__ssm_conv_h3__softmax_full_mha__prompt_kernel_back1:
v_exp_f32 v176, v4
v_mfma_f32_16x16x32_bf16 v[168:171], v[172:175], v[112:115], v[168:171]
v_exp_f32 v177, v5
v_exp_f32 v178, v6
v_exp_f32 v179, v7
v_mfma_f32_32x32x16_bf16 v[20:35], v[132:135], v[124:127], v[84:99]
ds_read_b128 v[140:143], v184 offset:16384
v_cvt_pk_bf16_f32 v100, v176, v177
v_exp_f32 v180, v8
v_cvt_pk_bf16_f32 v101, v178, v179
v_exp_f32 v181, v9
v_exp_f32 v182, v10
v_mfma_f32_32x32x16_bf16 v[20:35], v[136:139], v[128:131], v[20:35]
ds_read_b128 v[144:147], v185 offset:16384
v_exp_f32 v183, v11
v_cvt_pk_bf16_f32 v102, v180, v181
v_exp_f32 v176, v12
v_cvt_pk_bf16_f32 v103, v182, v183
v_exp_f32 v177, v13
v_mfma_f32_32x32x16_bf16 v[52:67], v[156:159], v[108:111], v[52:67]
v_exp_f32 v178, v14
v_exp_f32 v179, v15
v_cvt_pk_bf16_f32 v104, v176, v177
v_exp_f32 v180, v16
v_mfma_f32_16x16x32_bf16 v[164:167], v[172:175], v[100:103], v[164:167]
v_cvt_pk_bf16_f32 v105, v178, v179
v_exp_f32 v181, v17
v_mfma_f32_32x32x16_bf16 v[52:67], v[160:163], v[112:115], v[52:67]
v_exp_f32 v182, v18
v_exp_f32 v183, v19
v_cvt_pk_bf16_f32 v106, v180, v181
v_cvt_pk_bf16_f32 v107, v182, v183
s_waitcnt lgkmcnt(0)
v_exp_f32 v176, v20
v_mfma_f32_16x16x32_bf16 v[164:167], v[172:175], v[104:107], v[164:167]
v_exp_f32 v177, v21
v_exp_f32 v178, v22
v_exp_f32 v179, v23
v_mfma_f32_32x32x16_bf16 v[4:19], v[140:143], v[116:119], v[68:83]
ds_read_b128 v[156:159], v186 offset:16384
v_cvt_pk_bf16_f32 v108, v176, v177
v_exp_f32 v180, v24
v_cvt_pk_bf16_f32 v109, v178, v179
v_exp_f32 v181, v25
v_exp_f32 v182, v26
v_mfma_f32_32x32x16_bf16 v[4:19], v[144:147], v[120:123], v[4:19]
ds_read_b128 v[160:163], v187 offset:16384
v_exp_f32 v183, v27
v_cvt_pk_bf16_f32 v110, v180, v181
v_exp_f32 v176, v28
v_cvt_pk_bf16_f32 v111, v182, v183
v_exp_f32 v177, v29
v_mfma_f32_32x32x16_bf16 v[36:51], v[148:151], v[100:103], v[36:51]
v_exp_f32 v178, v30
v_exp_f32 v179, v31
v_cvt_pk_bf16_f32 v112, v176, v177
v_exp_f32 v180, v32
v_mfma_f32_16x16x32_bf16 v[168:171], v[172:175], v[108:111], v[168:171]
v_cvt_pk_bf16_f32 v113, v178, v179
v_exp_f32 v181, v33
v_mfma_f32_32x32x16_bf16 v[36:51], v[152:155], v[104:107], v[36:51]
v_exp_f32 v182, v34
v_exp_f32 v183, v35
v_cvt_pk_bf16_f32 v114, v180, v181
v_cvt_pk_bf16_f32 v115, v182, v183
s_waitcnt lgkmcnt(0)
v_exp_f32 v176, v4
v_mfma_f32_16x16x32_bf16 v[168:171], v[172:175], v[112:115], v[168:171]
v_exp_f32 v177, v5
v_exp_f32 v178, v6
v_exp_f32 v179, v7
v_mfma_f32_32x32x16_bf16 v[20:35], v[140:143], v[124:127], v[84:99]
ds_read_b128 v[132:135], v184 offset:18432
v_cvt_pk_bf16_f32 v100, v176, v177
v_exp_f32 v180, v8
v_cvt_pk_bf16_f32 v101, v178, v179
v_exp_f32 v181, v9
v_exp_f32 v182, v10
v_mfma_f32_32x32x16_bf16 v[20:35], v[144:147], v[128:131], v[20:35]
ds_read_b128 v[136:139], v185 offset:18432
v_exp_f32 v183, v11
v_cvt_pk_bf16_f32 v102, v180, v181
v_exp_f32 v176, v12
v_cvt_pk_bf16_f32 v103, v182, v183
v_exp_f32 v177, v13
v_mfma_f32_32x32x16_bf16 v[52:67], v[148:151], v[108:111], v[52:67]
v_exp_f32 v178, v14
v_exp_f32 v179, v15
v_cvt_pk_bf16_f32 v104, v176, v177
v_exp_f32 v180, v16
v_mfma_f32_16x16x32_bf16 v[164:167], v[172:175], v[100:103], v[164:167]
v_cvt_pk_bf16_f32 v105, v178, v179
v_exp_f32 v181, v17
v_mfma_f32_32x32x16_bf16 v[52:67], v[152:155], v[112:115], v[52:67]
v_exp_f32 v182, v18
v_exp_f32 v183, v19
v_cvt_pk_bf16_f32 v106, v180, v181
v_cvt_pk_bf16_f32 v107, v182, v183
s_waitcnt lgkmcnt(0)
v_exp_f32 v176, v20
v_mfma_f32_16x16x32_bf16 v[164:167], v[172:175], v[104:107], v[164:167]
v_exp_f32 v177, v21
v_exp_f32 v178, v22
v_exp_f32 v179, v23
v_mfma_f32_32x32x16_bf16 v[4:19], v[132:135], v[116:119], v[68:83]
ds_read_b128 v[148:151], v186 offset:18432
v_cvt_pk_bf16_f32 v108, v176, v177
v_exp_f32 v180, v24
v_cvt_pk_bf16_f32 v109, v178, v179
v_exp_f32 v181, v25
v_exp_f32 v182, v26
v_mfma_f32_32x32x16_bf16 v[4:19], v[136:139], v[120:123], v[4:19]
ds_read_b128 v[152:155], v187 offset:18432
v_exp_f32 v183, v27
v_cvt_pk_bf16_f32 v110, v180, v181
v_exp_f32 v176, v28
v_cvt_pk_bf16_f32 v111, v182, v183
v_exp_f32 v177, v29
v_mfma_f32_32x32x16_bf16 v[36:51], v[156:159], v[100:103], v[36:51]
v_exp_f32 v178, v30
v_exp_f32 v179, v31
v_cvt_pk_bf16_f32 v112, v176, v177
v_exp_f32 v180, v32
v_mfma_f32_16x16x32_bf16 v[168:171], v[172:175], v[108:111], v[168:171]
v_cvt_pk_bf16_f32 v113, v178, v179
v_exp_f32 v181, v33
v_mfma_f32_32x32x16_bf16 v[36:51], v[160:163], v[104:107], v[36:51]
v_exp_f32 v182, v34
v_exp_f32 v183, v35
v_cvt_pk_bf16_f32 v114, v180, v181
v_cvt_pk_bf16_f32 v115, v182, v183
s_waitcnt lgkmcnt(0)
v_exp_f32 v176, v4
v_mfma_f32_16x16x32_bf16 v[168:171], v[172:175], v[112:115], v[168:171]
v_exp_f32 v177, v5
v_exp_f32 v178, v6
v_exp_f32 v179, v7
v_mfma_f32_32x32x16_bf16 v[20:35], v[132:135], v[124:127], v[84:99]
ds_read_b128 v[140:143], v184 offset:20480
v_cvt_pk_bf16_f32 v100, v176, v177
v_exp_f32 v180, v8
v_cvt_pk_bf16_f32 v101, v178, v179
v_exp_f32 v181, v9
v_exp_f32 v182, v10
v_mfma_f32_32x32x16_bf16 v[20:35], v[136:139], v[128:131], v[20:35]
ds_read_b128 v[144:147], v185 offset:20480
v_exp_f32 v183, v11
v_cvt_pk_bf16_f32 v102, v180, v181
v_exp_f32 v176, v12
v_cvt_pk_bf16_f32 v103, v182, v183
v_exp_f32 v177, v13
v_mfma_f32_32x32x16_bf16 v[52:67], v[156:159], v[108:111], v[52:67]
v_exp_f32 v178, v14
v_exp_f32 v179, v15
v_cvt_pk_bf16_f32 v104, v176, v177
v_exp_f32 v180, v16
v_mfma_f32_16x16x32_bf16 v[164:167], v[172:175], v[100:103], v[164:167]
v_cvt_pk_bf16_f32 v105, v178, v179
v_exp_f32 v181, v17
v_mfma_f32_32x32x16_bf16 v[52:67], v[160:163], v[112:115], v[52:67]
v_exp_f32 v182, v18
v_exp_f32 v183, v19
v_cvt_pk_bf16_f32 v106, v180, v181
v_cvt_pk_bf16_f32 v107, v182, v183
s_waitcnt lgkmcnt(0)
v_exp_f32 v176, v20
v_mfma_f32_16x16x32_bf16 v[164:167], v[172:175], v[104:107], v[164:167]
v_exp_f32 v177, v21
v_exp_f32 v178, v22
v_exp_f32 v179, v23
v_mfma_f32_32x32x16_bf16 v[4:19], v[140:143], v[116:119], v[68:83]
ds_read_b128 v[156:159], v186 offset:20480
v_cvt_pk_bf16_f32 v108, v176, v177
v_exp_f32 v180, v24
v_cvt_pk_bf16_f32 v109, v178, v179
v_exp_f32 v181, v25
v_exp_f32 v182, v26
v_mfma_f32_32x32x16_bf16 v[4:19], v[144:147], v[120:123], v[4:19]
ds_read_b128 v[160:163], v187 offset:20480
v_exp_f32 v183, v27
v_cvt_pk_bf16_f32 v110, v180, v181
v_exp_f32 v176, v28
v_cvt_pk_bf16_f32 v111, v182, v183
v_exp_f32 v177, v29
v_mfma_f32_32x32x16_bf16 v[36:51], v[148:151], v[100:103], v[36:51]
v_exp_f32 v178, v30
v_exp_f32 v179, v31
v_cvt_pk_bf16_f32 v112, v176, v177
v_exp_f32 v180, v32
v_mfma_f32_16x16x32_bf16 v[168:171], v[172:175], v[108:111], v[168:171]
v_cvt_pk_bf16_f32 v113, v178, v179
v_exp_f32 v181, v33
v_mfma_f32_32x32x16_bf16 v[36:51], v[152:155], v[104:107], v[36:51]
v_exp_f32 v182, v34
v_exp_f32 v183, v35
v_cvt_pk_bf16_f32 v114, v180, v181
v_cvt_pk_bf16_f32 v115, v182, v183
s_waitcnt lgkmcnt(0)
v_exp_f32 v176, v4
v_mfma_f32_16x16x32_bf16 v[168:171], v[172:175], v[112:115], v[168:171]
v_exp_f32 v177, v5
v_exp_f32 v178, v6
v_exp_f32 v179, v7
v_mfma_f32_32x32x16_bf16 v[20:35], v[140:143], v[124:127], v[84:99]
ds_read_b128 v[132:135], v184 offset:22528
v_cvt_pk_bf16_f32 v100, v176, v177
v_exp_f32 v180, v8
v_cvt_pk_bf16_f32 v101, v178, v179
v_exp_f32 v181, v9
v_exp_f32 v182, v10
v_mfma_f32_32x32x16_bf16 v[20:35], v[144:147], v[128:131], v[20:35]
ds_read_b128 v[136:139], v185 offset:22528
v_exp_f32 v183, v11
v_cvt_pk_bf16_f32 v102, v180, v181
v_exp_f32 v176, v12
v_cvt_pk_bf16_f32 v103, v182, v183
v_exp_f32 v177, v13
v_mfma_f32_32x32x16_bf16 v[52:67], v[148:151], v[108:111], v[52:67]
v_exp_f32 v178, v14
v_exp_f32 v179, v15
v_cvt_pk_bf16_f32 v104, v176, v177
v_exp_f32 v180, v16
v_mfma_f32_16x16x32_bf16 v[164:167], v[172:175], v[100:103], v[164:167]
v_cvt_pk_bf16_f32 v105, v178, v179
v_exp_f32 v181, v17
v_mfma_f32_32x32x16_bf16 v[52:67], v[152:155], v[112:115], v[52:67]
v_exp_f32 v182, v18
v_exp_f32 v183, v19
v_cvt_pk_bf16_f32 v106, v180, v181
v_cvt_pk_bf16_f32 v107, v182, v183
s_waitcnt lgkmcnt(0)
v_exp_f32 v176, v20
v_mfma_f32_16x16x32_bf16 v[164:167], v[172:175], v[104:107], v[164:167]
v_exp_f32 v177, v21
v_exp_f32 v178, v22
v_exp_f32 v179, v23
v_mfma_f32_32x32x16_bf16 v[4:19], v[132:135], v[116:119], v[68:83]
ds_read_b128 v[148:151], v186 offset:22528
v_cvt_pk_bf16_f32 v108, v176, v177
v_exp_f32 v180, v24
v_cvt_pk_bf16_f32 v109, v178, v179
v_exp_f32 v181, v25
v_exp_f32 v182, v26
v_mfma_f32_32x32x16_bf16 v[4:19], v[136:139], v[120:123], v[4:19]
ds_read_b128 v[152:155], v187 offset:22528
v_exp_f32 v183, v27
v_cvt_pk_bf16_f32 v110, v180, v181
v_exp_f32 v176, v28
v_cvt_pk_bf16_f32 v111, v182, v183
v_exp_f32 v177, v29
v_mfma_f32_32x32x16_bf16 v[36:51], v[156:159], v[100:103], v[36:51]
v_exp_f32 v178, v30
v_exp_f32 v179, v31
v_cvt_pk_bf16_f32 v112, v176, v177
v_exp_f32 v180, v32
v_mfma_f32_16x16x32_bf16 v[168:171], v[172:175], v[108:111], v[168:171]
v_cvt_pk_bf16_f32 v113, v178, v179
v_exp_f32 v181, v33
v_mfma_f32_32x32x16_bf16 v[36:51], v[160:163], v[104:107], v[36:51]
v_exp_f32 v182, v34
v_exp_f32 v183, v35
v_cvt_pk_bf16_f32 v114, v180, v181
v_cvt_pk_bf16_f32 v115, v182, v183
s_waitcnt vmcnt(0) lgkmcnt(0)
s_barrier
v_max_f32 v194, v164, v168
v_cmp_lt_f32 vcc, s20, v194
s_nop 0
s_cbranch_vccnz L_concat_heads__ssm_conv_h3__softmax_full_mha__prompt_kernel_stub2
L_concat_heads__ssm_conv_h3__softmax_full_mha__prompt_kernel_back2:
v_exp_f32 v176, v4
v_mfma_f32_16x16x32_bf16 v[168:171], v[172:175], v[112:115], v[168:171]
v_exp_f32 v177, v5
v_exp_f32 v178, v6
v_exp_f32 v179, v7
v_mfma_f32_32x32x16_bf16 v[20:35], v[132:135], v[124:127], v[84:99]
ds_read_b128 v[140:143], v184 offset:32768
v_cvt_pk_bf16_f32 v100, v176, v177
v_exp_f32 v180, v8
v_cvt_pk_bf16_f32 v101, v178, v179
v_exp_f32 v181, v9
v_exp_f32 v182, v10
v_mfma_f32_32x32x16_bf16 v[20:35], v[136:139], v[128:131], v[20:35]
ds_read_b128 v[144:147], v185 offset:32768
v_exp_f32 v183, v11
v_cvt_pk_bf16_f32 v102, v180, v181
v_exp_f32 v176, v12
v_cvt_pk_bf16_f32 v103, v182, v183
v_exp_f32 v177, v13
v_mfma_f32_32x32x16_bf16 v[52:67], v[156:159], v[108:111], v[52:67]
v_exp_f32 v178, v14
v_exp_f32 v179, v15
v_cvt_pk_bf16_f32 v104, v176, v177
v_exp_f32 v180, v16
v_mfma_f32_16x16x32_bf16 v[164:167], v[172:175], v[100:103], v[164:167]
v_cvt_pk_bf16_f32 v105, v178, v179
v_exp_f32 v181, v17
v_mfma_f32_32x32x16_bf16 v[52:67], v[160:163], v[112:115], v[52:67]
v_exp_f32 v182, v18
v_exp_f32 v183, v19
v_cvt_pk_bf16_f32 v106, v180, v181
v_cvt_pk_bf16_f32 v107, v182, v183
s_waitcnt lgkmcnt(0)
v_exp_f32 v176, v20
v_mfma_f32_16x16x32_bf16 v[164:167], v[172:175], v[104:107], v[164:167]
v_exp_f32 v177, v21
v_exp_f32 v178, v22
v_exp_f32 v179, v23
v_mfma_f32_32x32x16_bf16 v[4:19], v[140:143], v[116:119], v[68:83]
ds_read_b128 v[156:159], v186 offset:32768
v_cvt_pk_bf16_f32 v108, v176, v177
v_exp_f32 v180, v24
v_cvt_pk_bf16_f32 v109, v178, v179
v_exp_f32 v181, v25
v_exp_f32 v182, v26
v_mfma_f32_32x32x16_bf16 v[4:19], v[144:147], v[120:123], v[4:19]
ds_read_b128 v[160:163], v187 offset:32768
v_exp_f32 v183, v27
v_cvt_pk_bf16_f32 v110, v180, v181
v_exp_f32 v176, v28
v_cvt_pk_bf16_f32 v111, v182, v183
v_exp_f32 v177, v29
v_mfma_f32_32x32x16_bf16 v[36:51], v[148:151], v[100:103], v[36:51]
v_exp_f32 v178, v30
v_exp_f32 v179, v31
v_cvt_pk_bf16_f32 v112, v176, v177
v_exp_f32 v180, v32
v_mfma_f32_16x16x32_bf16 v[168:171], v[172:175], v[108:111], v[168:171]
v_cvt_pk_bf16_f32 v113, v178, v179
v_exp_f32 v181, v33
v_mfma_f32_32x32x16_bf16 v[36:51], v[152:155], v[104:107], v[36:51]
v_exp_f32 v182, v34
v_exp_f32 v183, v35
v_cvt_pk_bf16_f32 v114, v180, v181
v_cvt_pk_bf16_f32 v115, v182, v183
s_waitcnt lgkmcnt(0)
v_exp_f32 v176, v4
v_mfma_f32_16x16x32_bf16 v[168:171], v[172:175], v[112:115], v[168:171]
v_exp_f32 v177, v5
v_exp_f32 v178, v6
v_exp_f32 v179, v7
v_mfma_f32_32x32x16_bf16 v[20:35], v[140:143], v[124:127], v[84:99]
ds_read_b128 v[132:135], v184 offset:34816
v_cvt_pk_bf16_f32 v100, v176, v177
v_exp_f32 v180, v8
v_cvt_pk_bf16_f32 v101, v178, v179
v_exp_f32 v181, v9
v_exp_f32 v182, v10
v_mfma_f32_32x32x16_bf16 v[20:35], v[144:147], v[128:131], v[20:35]
ds_read_b128 v[136:139], v185 offset:34816
v_exp_f32 v183, v11
v_cvt_pk_bf16_f32 v102, v180, v181
v_exp_f32 v176, v12
v_cvt_pk_bf16_f32 v103, v182, v183
v_exp_f32 v177, v13
v_mfma_f32_32x32x16_bf16 v[52:67], v[148:151], v[108:111], v[52:67]
v_exp_f32 v178, v14
v_exp_f32 v179, v15
v_cvt_pk_bf16_f32 v104, v176, v177
v_exp_f32 v180, v16
v_mfma_f32_16x16x32_bf16 v[164:167], v[172:175], v[100:103], v[164:167]
v_cvt_pk_bf16_f32 v105, v178, v179
v_exp_f32 v181, v17
v_mfma_f32_32x32x16_bf16 v[52:67], v[152:155], v[112:115], v[52:67]
v_exp_f32 v182, v18
v_exp_f32 v183, v19
v_cvt_pk_bf16_f32 v106, v180, v181
v_cvt_pk_bf16_f32 v107, v182, v183
s_waitcnt lgkmcnt(0)
v_exp_f32 v176, v20
v_mfma_f32_16x16x32_bf16 v[164:167], v[172:175], v[104:107], v[164:167]
v_exp_f32 v177, v21
v_exp_f32 v178, v22
v_exp_f32 v179, v23
v_mfma_f32_32x32x16_bf16 v[4:19], v[132:135], v[116:119], v[68:83]
ds_read_b128 v[148:151], v186 offset:34816
v_cvt_pk_bf16_f32 v108, v176, v177
v_exp_f32 v180, v24
v_cvt_pk_bf16_f32 v109, v178, v179
v_exp_f32 v181, v25
v_exp_f32 v182, v26
v_mfma_f32_32x32x16_bf16 v[4:19], v[136:139], v[120:123], v[4:19]
ds_read_b128 v[152:155], v187 offset:34816
v_exp_f32 v183, v27
v_cvt_pk_bf16_f32 v110, v180, v181
v_exp_f32 v176, v28
v_cvt_pk_bf16_f32 v111, v182, v183
v_exp_f32 v177, v29
v_mfma_f32_32x32x16_bf16 v[36:51], v[156:159], v[100:103], v[36:51]
v_exp_f32 v178, v30
v_exp_f32 v179, v31
v_cvt_pk_bf16_f32 v112, v176, v177
v_exp_f32 v180, v32
v_mfma_f32_16x16x32_bf16 v[168:171], v[172:175], v[108:111], v[168:171]
v_cvt_pk_bf16_f32 v113, v178, v179
v_exp_f32 v181, v33
v_mfma_f32_32x32x16_bf16 v[36:51], v[160:163], v[104:107], v[36:51]
v_exp_f32 v182, v34
v_exp_f32 v183, v35
v_cvt_pk_bf16_f32 v114, v180, v181
v_cvt_pk_bf16_f32 v115, v182, v183
s_waitcnt lgkmcnt(0)
v_exp_f32 v176, v4
v_mfma_f32_16x16x32_bf16 v[168:171], v[172:175], v[112:115], v[168:171]
v_exp_f32 v177, v5
v_exp_f32 v178, v6
v_exp_f32 v179, v7
v_mfma_f32_32x32x16_bf16 v[20:35], v[132:135], v[124:127], v[84:99]
ds_read_b128 v[140:143], v184 offset:36864
v_cvt_pk_bf16_f32 v100, v176, v177
v_exp_f32 v180, v8
v_cvt_pk_bf16_f32 v101, v178, v179
v_exp_f32 v181, v9
v_exp_f32 v182, v10
v_mfma_f32_32x32x16_bf16 v[20:35], v[136:139], v[128:131], v[20:35]
ds_read_b128 v[144:147], v185 offset:36864
v_exp_f32 v183, v11
v_cvt_pk_bf16_f32 v102, v180, v181
v_exp_f32 v176, v12
v_cvt_pk_bf16_f32 v103, v182, v183
v_exp_f32 v177, v13
v_mfma_f32_32x32x16_bf16 v[52:67], v[156:159], v[108:111], v[52:67]
v_exp_f32 v178, v14
v_exp_f32 v179, v15
v_cvt_pk_bf16_f32 v104, v176, v177
v_exp_f32 v180, v16
v_mfma_f32_16x16x32_bf16 v[164:167], v[172:175], v[100:103], v[164:167]
v_cvt_pk_bf16_f32 v105, v178, v179
v_exp_f32 v181, v17
v_mfma_f32_32x32x16_bf16 v[52:67], v[160:163], v[112:115], v[52:67]
v_exp_f32 v182, v18
v_exp_f32 v183, v19
v_cvt_pk_bf16_f32 v106, v180, v181
v_cvt_pk_bf16_f32 v107, v182, v183
s_waitcnt lgkmcnt(0)
v_exp_f32 v176, v20
v_mfma_f32_16x16x32_bf16 v[164:167], v[172:175], v[104:107], v[164:167]
v_exp_f32 v177, v21
v_exp_f32 v178, v22
v_exp_f32 v179, v23
v_mfma_f32_32x32x16_bf16 v[4:19], v[140:143], v[116:119], v[68:83]
ds_read_b128 v[156:159], v186 offset:36864
v_cvt_pk_bf16_f32 v108, v176, v177
v_exp_f32 v180, v24
v_cvt_pk_bf16_f32 v109, v178, v179
v_exp_f32 v181, v25
v_exp_f32 v182, v26
v_mfma_f32_32x32x16_bf16 v[4:19], v[144:147], v[120:123], v[4:19]
ds_read_b128 v[160:163], v187 offset:36864
v_exp_f32 v183, v27
v_cvt_pk_bf16_f32 v110, v180, v181
v_exp_f32 v176, v28
v_cvt_pk_bf16_f32 v111, v182, v183
v_exp_f32 v177, v29
v_mfma_f32_32x32x16_bf16 v[36:51], v[148:151], v[100:103], v[36:51]
v_exp_f32 v178, v30
v_exp_f32 v179, v31
v_cvt_pk_bf16_f32 v112, v176, v177
v_exp_f32 v180, v32
v_mfma_f32_16x16x32_bf16 v[168:171], v[172:175], v[108:111], v[168:171]
v_cvt_pk_bf16_f32 v113, v178, v179
v_exp_f32 v181, v33
v_mfma_f32_32x32x16_bf16 v[36:51], v[152:155], v[104:107], v[36:51]
v_exp_f32 v182, v34
v_exp_f32 v183, v35
v_cvt_pk_bf16_f32 v114, v180, v181
v_cvt_pk_bf16_f32 v115, v182, v183
s_waitcnt lgkmcnt(0)
v_exp_f32 v176, v4
v_mfma_f32_16x16x32_bf16 v[168:171], v[172:175], v[112:115], v[168:171]
v_exp_f32 v177, v5
v_exp_f32 v178, v6
v_exp_f32 v179, v7
v_mfma_f32_32x32x16_bf16 v[20:35], v[140:143], v[124:127], v[84:99]
ds_read_b128 v[132:135], v184 offset:38912
v_cvt_pk_bf16_f32 v100, v176, v177
v_exp_f32 v180, v8
v_cvt_pk_bf16_f32 v101, v178, v179
v_exp_f32 v181, v9
v_exp_f32 v182, v10
v_mfma_f32_32x32x16_bf16 v[20:35], v[144:147], v[128:131], v[20:35]
ds_read_b128 v[136:139], v185 offset:38912
v_exp_f32 v183, v11
v_cvt_pk_bf16_f32 v102, v180, v181
v_exp_f32 v176, v12
v_cvt_pk_bf16_f32 v103, v182, v183
v_exp_f32 v177, v13
v_mfma_f32_32x32x16_bf16 v[52:67], v[148:151], v[108:111], v[52:67]
v_exp_f32 v178, v14
v_exp_f32 v179, v15
v_cvt_pk_bf16_f32 v104, v176, v177
v_exp_f32 v180, v16
v_mfma_f32_16x16x32_bf16 v[164:167], v[172:175], v[100:103], v[164:167]
v_cvt_pk_bf16_f32 v105, v178, v179
v_exp_f32 v181, v17
v_mfma_f32_32x32x16_bf16 v[52:67], v[152:155], v[112:115], v[52:67]
v_exp_f32 v182, v18
v_exp_f32 v183, v19
v_cvt_pk_bf16_f32 v106, v180, v181
v_cvt_pk_bf16_f32 v107, v182, v183
s_waitcnt lgkmcnt(0)
v_exp_f32 v176, v20
v_mfma_f32_16x16x32_bf16 v[164:167], v[172:175], v[104:107], v[164:167]
v_exp_f32 v177, v21
v_exp_f32 v178, v22
v_exp_f32 v179, v23
v_mfma_f32_32x32x16_bf16 v[4:19], v[132:135], v[116:119], v[68:83]
ds_read_b128 v[148:151], v186 offset:38912
v_cvt_pk_bf16_f32 v108, v176, v177
v_exp_f32 v180, v24
v_cvt_pk_bf16_f32 v109, v178, v179
v_exp_f32 v181, v25
v_exp_f32 v182, v26
v_mfma_f32_32x32x16_bf16 v[4:19], v[136:139], v[120:123], v[4:19]
ds_read_b128 v[152:155], v187 offset:38912
v_exp_f32 v183, v27
v_cvt_pk_bf16_f32 v110, v180, v181
v_exp_f32 v176, v28
v_cvt_pk_bf16_f32 v111, v182, v183
v_exp_f32 v177, v29
v_mfma_f32_32x32x16_bf16 v[36:51], v[156:159], v[100:103], v[36:51]
v_exp_f32 v178, v30
v_exp_f32 v179, v31
v_cvt_pk_bf16_f32 v112, v176, v177
v_exp_f32 v180, v32
v_mfma_f32_16x16x32_bf16 v[168:171], v[172:175], v[108:111], v[168:171]
v_cvt_pk_bf16_f32 v113, v178, v179
v_exp_f32 v181, v33
v_mfma_f32_32x32x16_bf16 v[36:51], v[160:163], v[104:107], v[36:51]
v_exp_f32 v182, v34
v_exp_f32 v183, v35
v_cvt_pk_bf16_f32 v114, v180, v181
v_cvt_pk_bf16_f32 v115, v182, v183
s_waitcnt vmcnt(0) lgkmcnt(0)
s_barrier
v_max_f32 v194, v164, v168
v_cmp_lt_f32 vcc, s20, v194
s_nop 0
s_cbranch_vccnz L_concat_heads__ssm_conv_h3__softmax_full_mha__prompt_kernel_stub3
L_concat_heads__ssm_conv_h3__softmax_full_mha__prompt_kernel_back3:
v_exp_f32 v176, v4
v_mfma_f32_16x16x32_bf16 v[168:171], v[172:175], v[112:115], v[168:171]
v_exp_f32 v177, v5
v_exp_f32 v178, v6
v_exp_f32 v179, v7
v_mfma_f32_32x32x16_bf16 v[20:35], v[132:135], v[124:127], v[84:99]
ds_read_b128 v[140:143], v184 offset:49152
v_cvt_pk_bf16_f32 v100, v176, v177
v_exp_f32 v180, v8
v_cvt_pk_bf16_f32 v101, v178, v179
v_exp_f32 v181, v9
v_exp_f32 v182, v10
v_mfma_f32_32x32x16_bf16 v[20:35], v[136:139], v[128:131], v[20:35]
ds_read_b128 v[144:147], v185 offset:49152
v_exp_f32 v183, v11
v_cvt_pk_bf16_f32 v102, v180, v181
v_exp_f32 v176, v12
v_cvt_pk_bf16_f32 v103, v182, v183
v_exp_f32 v177, v13
v_mfma_f32_32x32x16_bf16 v[52:67], v[156:159], v[108:111], v[52:67]
v_exp_f32 v178, v14
v_exp_f32 v179, v15
v_cvt_pk_bf16_f32 v104, v176, v177
v_exp_f32 v180, v16
v_mfma_f32_16x16x32_bf16 v[164:167], v[172:175], v[100:103], v[164:167]
v_cvt_pk_bf16_f32 v105, v178, v179
v_exp_f32 v181, v17
v_mfma_f32_32x32x16_bf16 v[52:67], v[160:163], v[112:115], v[52:67]
v_exp_f32 v182, v18
v_exp_f32 v183, v19
v_cvt_pk_bf16_f32 v106, v180, v181
v_cvt_pk_bf16_f32 v107, v182, v183
s_waitcnt lgkmcnt(0)
v_exp_f32 v176, v20
v_mfma_f32_16x16x32_bf16 v[164:167], v[172:175], v[104:107], v[164:167]
v_exp_f32 v177, v21
v_exp_f32 v178, v22
v_exp_f32 v179, v23
v_mfma_f32_32x32x16_bf16 v[4:19], v[140:143], v[116:119], v[68:83]
ds_read_b128 v[156:159], v186 offset:49152
v_cvt_pk_bf16_f32 v108, v176, v177
v_exp_f32 v180, v24
v_cvt_pk_bf16_f32 v109, v178, v179
v_exp_f32 v181, v25
v_exp_f32 v182, v26
v_mfma_f32_32x32x16_bf16 v[4:19], v[144:147], v[120:123], v[4:19]
ds_read_b128 v[160:163], v187 offset:49152
v_exp_f32 v183, v27
v_cvt_pk_bf16_f32 v110, v180, v181
v_exp_f32 v176, v28
v_cvt_pk_bf16_f32 v111, v182, v183
v_exp_f32 v177, v29
v_mfma_f32_32x32x16_bf16 v[36:51], v[148:151], v[100:103], v[36:51]
v_exp_f32 v178, v30
v_exp_f32 v179, v31
v_cvt_pk_bf16_f32 v112, v176, v177
v_exp_f32 v180, v32
v_mfma_f32_16x16x32_bf16 v[168:171], v[172:175], v[108:111], v[168:171]
v_cvt_pk_bf16_f32 v113, v178, v179
v_exp_f32 v181, v33
v_mfma_f32_32x32x16_bf16 v[36:51], v[152:155], v[104:107], v[36:51]
v_exp_f32 v182, v34
v_exp_f32 v183, v35
v_cvt_pk_bf16_f32 v114, v180, v181
v_cvt_pk_bf16_f32 v115, v182, v183
s_waitcnt lgkmcnt(0)
v_exp_f32 v176, v4
v_mfma_f32_16x16x32_bf16 v[168:171], v[172:175], v[112:115], v[168:171]
v_exp_f32 v177, v5
v_exp_f32 v178, v6
v_exp_f32 v179, v7
v_mfma_f32_32x32x16_bf16 v[20:35], v[140:143], v[124:127], v[84:99]
ds_read_b128 v[132:135], v184 offset:51200
v_cvt_pk_bf16_f32 v100, v176, v177
v_exp_f32 v180, v8
v_cvt_pk_bf16_f32 v101, v178, v179
v_exp_f32 v181, v9
v_exp_f32 v182, v10
v_mfma_f32_32x32x16_bf16 v[20:35], v[144:147], v[128:131], v[20:35]
ds_read_b128 v[136:139], v185 offset:51200
v_exp_f32 v183, v11
v_cvt_pk_bf16_f32 v102, v180, v181
v_exp_f32 v176, v12
v_cvt_pk_bf16_f32 v103, v182, v183
v_exp_f32 v177, v13
v_mfma_f32_32x32x16_bf16 v[52:67], v[148:151], v[108:111], v[52:67]
v_exp_f32 v178, v14
v_exp_f32 v179, v15
v_cvt_pk_bf16_f32 v104, v176, v177
v_exp_f32 v180, v16
v_mfma_f32_16x16x32_bf16 v[164:167], v[172:175], v[100:103], v[164:167]
v_cvt_pk_bf16_f32 v105, v178, v179
v_exp_f32 v181, v17
v_mfma_f32_32x32x16_bf16 v[52:67], v[152:155], v[112:115], v[52:67]
v_exp_f32 v182, v18
v_exp_f32 v183, v19
v_cvt_pk_bf16_f32 v106, v180, v181
v_cvt_pk_bf16_f32 v107, v182, v183
s_waitcnt lgkmcnt(0)
v_exp_f32 v176, v20
v_mfma_f32_16x16x32_bf16 v[164:167], v[172:175], v[104:107], v[164:167]
v_exp_f32 v177, v21
v_exp_f32 v178, v22
v_exp_f32 v179, v23
v_mfma_f32_32x32x16_bf16 v[4:19], v[132:135], v[116:119], v[68:83]
ds_read_b128 v[148:151], v186 offset:51200
v_cvt_pk_bf16_f32 v108, v176, v177
v_exp_f32 v180, v24
v_cvt_pk_bf16_f32 v109, v178, v179
v_exp_f32 v181, v25
v_exp_f32 v182, v26
v_mfma_f32_32x32x16_bf16 v[4:19], v[136:139], v[120:123], v[4:19]
ds_read_b128 v[152:155], v187 offset:51200
v_exp_f32 v183, v27
v_cvt_pk_bf16_f32 v110, v180, v181
v_exp_f32 v176, v28
v_cvt_pk_bf16_f32 v111, v182, v183
v_exp_f32 v177, v29
v_mfma_f32_32x32x16_bf16 v[36:51], v[156:159], v[100:103], v[36:51]
v_exp_f32 v178, v30
v_exp_f32 v179, v31
v_cvt_pk_bf16_f32 v112, v176, v177
v_exp_f32 v180, v32
v_mfma_f32_16x16x32_bf16 v[168:171], v[172:175], v[108:111], v[168:171]
v_cvt_pk_bf16_f32 v113, v178, v179
v_exp_f32 v181, v33
v_mfma_f32_32x32x16_bf16 v[36:51], v[160:163], v[104:107], v[36:51]
v_exp_f32 v182, v34
v_exp_f32 v183, v35
v_cvt_pk_bf16_f32 v114, v180, v181
v_cvt_pk_bf16_f32 v115, v182, v183
s_waitcnt lgkmcnt(0)
v_exp_f32 v176, v4
v_mfma_f32_16x16x32_bf16 v[168:171], v[172:175], v[112:115], v[168:171]
v_exp_f32 v177, v5
v_exp_f32 v178, v6
v_exp_f32 v179, v7
v_mfma_f32_32x32x16_bf16 v[20:35], v[132:135], v[124:127], v[84:99]
ds_read_b128 v[140:143], v184 offset:53248
v_cvt_pk_bf16_f32 v100, v176, v177
v_exp_f32 v180, v8
v_cvt_pk_bf16_f32 v101, v178, v179
v_exp_f32 v181, v9
v_exp_f32 v182, v10
v_mfma_f32_32x32x16_bf16 v[20:35], v[136:139], v[128:131], v[20:35]
ds_read_b128 v[144:147], v185 offset:53248
v_exp_f32 v183, v11
v_cvt_pk_bf16_f32 v102, v180, v181
v_exp_f32 v176, v12
v_cvt_pk_bf16_f32 v103, v182, v183
v_exp_f32 v177, v13
v_mfma_f32_32x32x16_bf16 v[52:67], v[156:159], v[108:111], v[52:67]
v_exp_f32 v178, v14
v_exp_f32 v179, v15
v_cvt_pk_bf16_f32 v104, v176, v177
v_exp_f32 v180, v16
v_mfma_f32_16x16x32_bf16 v[164:167], v[172:175], v[100:103], v[164:167]
v_cvt_pk_bf16_f32 v105, v178, v179
v_exp_f32 v181, v17
v_mfma_f32_32x32x16_bf16 v[52:67], v[160:163], v[112:115], v[52:67]
v_exp_f32 v182, v18
v_exp_f32 v183, v19
v_cvt_pk_bf16_f32 v106, v180, v181
v_cvt_pk_bf16_f32 v107, v182, v183
s_waitcnt lgkmcnt(0)
v_exp_f32 v176, v20
v_mfma_f32_16x16x32_bf16 v[164:167], v[172:175], v[104:107], v[164:167]
v_exp_f32 v177, v21
v_exp_f32 v178, v22
v_exp_f32 v179, v23
v_mfma_f32_32x32x16_bf16 v[4:19], v[140:143], v[116:119], v[68:83]
ds_read_b128 v[156:159], v186 offset:53248
v_cvt_pk_bf16_f32 v108, v176, v177
v_exp_f32 v180, v24
v_cvt_pk_bf16_f32 v109, v178, v179
v_exp_f32 v181, v25
v_exp_f32 v182, v26
v_mfma_f32_32x32x16_bf16 v[4:19], v[144:147], v[120:123], v[4:19]
ds_read_b128 v[160:163], v187 offset:53248
v_exp_f32 v183, v27
v_cvt_pk_bf16_f32 v110, v180, v181
v_exp_f32 v176, v28
v_cvt_pk_bf16_f32 v111, v182, v183
v_exp_f32 v177, v29
v_mfma_f32_32x32x16_bf16 v[36:51], v[148:151], v[100:103], v[36:51]
v_exp_f32 v178, v30
v_exp_f32 v179, v31
v_cvt_pk_bf16_f32 v112, v176, v177
v_exp_f32 v180, v32
v_mfma_f32_16x16x32_bf16 v[168:171], v[172:175], v[108:111], v[168:171]
v_cvt_pk_bf16_f32 v113, v178, v179
v_exp_f32 v181, v33
v_mfma_f32_32x32x16_bf16 v[36:51], v[152:155], v[104:107], v[36:51]
v_exp_f32 v182, v34
v_exp_f32 v183, v35
v_cvt_pk_bf16_f32 v114, v180, v181
v_cvt_pk_bf16_f32 v115, v182, v183
s_waitcnt lgkmcnt(0)
v_exp_f32 v176, v4
v_mfma_f32_16x16x32_bf16 v[168:171], v[172:175], v[112:115], v[168:171]
v_exp_f32 v177, v5
v_exp_f32 v178, v6
v_exp_f32 v179, v7
v_mfma_f32_32x32x16_bf16 v[20:35], v[140:143], v[124:127], v[84:99]
ds_read_b128 v[132:135], v184 offset:55296
v_cvt_pk_bf16_f32 v100, v176, v177
v_exp_f32 v180, v8
v_cvt_pk_bf16_f32 v101, v178, v179
v_exp_f32 v181, v9
v_exp_f32 v182, v10
v_mfma_f32_32x32x16_bf16 v[20:35], v[144:147], v[128:131], v[20:35]
ds_read_b128 v[136:139], v185 offset:55296
v_exp_f32 v183, v11
v_cvt_pk_bf16_f32 v102, v180, v181
v_exp_f32 v176, v12
v_cvt_pk_bf16_f32 v103, v182, v183
v_exp_f32 v177, v13
v_mfma_f32_32x32x16_bf16 v[52:67], v[148:151], v[108:111], v[52:67]
v_exp_f32 v178, v14
v_exp_f32 v179, v15
v_cvt_pk_bf16_f32 v104, v176, v177
v_exp_f32 v180, v16
v_mfma_f32_16x16x32_bf16 v[164:167], v[172:175], v[100:103], v[164:167]
v_cvt_pk_bf16_f32 v105, v178, v179
v_exp_f32 v181, v17
v_mfma_f32_32x32x16_bf16 v[52:67], v[152:155], v[112:115], v[52:67]
v_exp_f32 v182, v18
v_exp_f32 v183, v19
v_cvt_pk_bf16_f32 v106, v180, v181
v_cvt_pk_bf16_f32 v107, v182, v183
s_waitcnt lgkmcnt(0)
v_exp_f32 v176, v20
v_mfma_f32_16x16x32_bf16 v[164:167], v[172:175], v[104:107], v[164:167]
v_exp_f32 v177, v21
v_exp_f32 v178, v22
v_exp_f32 v179, v23
v_mfma_f32_32x32x16_bf16 v[4:19], v[132:135], v[116:119], v[68:83]
ds_read_b128 v[148:151], v186 offset:55296
v_cvt_pk_bf16_f32 v108, v176, v177
v_exp_f32 v180, v24
v_cvt_pk_bf16_f32 v109, v178, v179
v_exp_f32 v181, v25
v_exp_f32 v182, v26
v_mfma_f32_32x32x16_bf16 v[4:19], v[136:139], v[120:123], v[4:19]
ds_read_b128 v[152:155], v187 offset:55296
v_exp_f32 v183, v27
v_cvt_pk_bf16_f32 v110, v180, v181
v_exp_f32 v176, v28
v_cvt_pk_bf16_f32 v111, v182, v183
v_exp_f32 v177, v29
v_mfma_f32_32x32x16_bf16 v[36:51], v[156:159], v[100:103], v[36:51]
v_exp_f32 v178, v30
v_exp_f32 v179, v31
v_cvt_pk_bf16_f32 v112, v176, v177
v_exp_f32 v180, v32
v_mfma_f32_16x16x32_bf16 v[168:171], v[172:175], v[108:111], v[168:171]
v_cvt_pk_bf16_f32 v113, v178, v179
v_exp_f32 v181, v33
v_mfma_f32_32x32x16_bf16 v[36:51], v[160:163], v[104:107], v[36:51]
v_exp_f32 v182, v34
v_exp_f32 v183, v35
v_cvt_pk_bf16_f32 v114, v180, v181
v_cvt_pk_bf16_f32 v115, v182, v183
s_add_u32 s19, s19, 1
s_cmp_lt_u32 s19, 4
s_cbranch_scc1 L_concat_heads__ssm_conv_h3__softmax_full_mha__prompt_kernel_loop
v_mfma_f32_16x16x32_bf16 v[168:171], v[172:175], v[112:115], v[168:171]
v_mfma_f32_32x32x16_bf16 v[52:67], v[156:159], v[108:111], v[52:67]
v_mfma_f32_32x32x16_bf16 v[52:67], v[160:163], v[112:115], v[52:67]
v_mul_f32 v197, 0, v164
s_nop 4
v_fmac_f32 v197, 0, v168
v_fmac_f32 v197, 0, v36
v_fmac_f32 v197, 0, v37
v_fmac_f32 v197, 0, v38
v_fmac_f32 v197, 0, v39
v_fmac_f32 v197, 0, v40
v_fmac_f32 v197, 0, v41
v_fmac_f32 v197, 0, v42
v_fmac_f32 v197, 0, v43
v_fmac_f32 v197, 0, v44
v_fmac_f32 v197, 0, v45
v_fmac_f32 v197, 0, v46
v_fmac_f32 v197, 0, v47
v_fmac_f32 v197, 0, v48
v_fmac_f32 v197, 0, v49
v_fmac_f32 v197, 0, v50
v_fmac_f32 v197, 0, v51
v_fmac_f32 v197, 0, v52
v_fmac_f32 v197, 0, v53
v_fmac_f32 v197, 0, v54
v_fmac_f32 v197, 0, v55
v_fmac_f32 v197, 0, v56
v_fmac_f32 v197, 0, v57
v_fmac_f32 v197, 0, v58
v_fmac_f32 v197, 0, v59
v_fmac_f32 v197, 0, v60
v_fmac_f32 v197, 0, v61
v_fmac_f32 v197, 0, v62
v_fmac_f32 v197, 0, v63
v_fmac_f32 v197, 0, v64
v_fmac_f32 v197, 0, v65
v_fmac_f32 v197, 0, v66
v_fmac_f32 v197, 0, v67
v_cmp_u_f32 vcc, v197, v197
s_nop 0
s_cbranch_vccnz L_concat_heads__ssm_conv_h3__softmax_full_mha__prompt_kernel_safe
L_concat_heads__ssm_conv_h3__softmax_full_mha__prompt_kernel_fin:
s_lshl_b32 s15, s14, 2
s_add_u32 s15, s15, s12
s_lshl_b32 s15, s15, 12
s_lshl_b32 s16, s13, 17
s_add_u32 s15, s15, s16
s_add_u32 s15, s15, 46137344
s_lshl_b32 s16, s12, 12
s_add_u32 s16, s16, 147456
v_bfe_u32 v195, v191, 1, 2
v_xor_b32 v195, v195, v193
v_lshlrev_b32 v196, 6, v192
v_lshl_add_u32 v196, v195, 4, v196
v_add_u32 v196, s16, v196
v_xor_b32 v197, 32, v196
v_mov_b32 v194, v164
s_nop 1
v_permlane32_swap_b32 v164, v194
v_add_f32 v164, v164, v194
v_rcp_f32 v164, v164
s_nop 0
v_mul_f32 v36, v36, v164
v_mul_f32 v37, v37, v164
v_mul_f32 v38, v38, v164
v_mul_f32 v39, v39, v164
v_mul_f32 v40, v40, v164
v_mul_f32 v41, v41, v164
v_mul_f32 v42, v42, v164
v_mul_f32 v43, v43, v164
v_mul_f32 v44, v44, v164
v_mul_f32 v45, v45, v164
v_mul_f32 v46, v46, v164
v_mul_f32 v47, v47, v164
v_mul_f32 v48, v48, v164
v_mul_f32 v49, v49, v164
v_mul_f32 v50, v50, v164
v_mul_f32 v51, v51, v164
v_cvt_pk_bf16_f32 v36, v36, v37
v_cvt_pk_bf16_f32 v37, v38, v39
v_cvt_pk_bf16_f32 v38, v40, v41
v_cvt_pk_bf16_f32 v39, v42, v43
v_cvt_pk_bf16_f32 v40, v44, v45
v_cvt_pk_bf16_f32 v41, v46, v47
v_cvt_pk_bf16_f32 v42, v48, v49
v_cvt_pk_bf16_f32 v43, v50, v51
v_permlane32_swap_b32 v36, v38
v_permlane32_swap_b32 v37, v39
v_permlane32_swap_b32 v40, v42
v_permlane32_swap_b32 v41, v43
ds_write_b128 v196, v[36:39] offset:0
ds_write_b128 v197, v[40:43] offset:0
v_mov_b32 v194, v168
s_nop 1
v_permlane32_swap_b32 v168, v194
v_add_f32 v168, v168, v194
v_rcp_f32 v168, v168
s_nop 0
v_mul_f32 v52, v52, v168
v_mul_f32 v53, v53, v168
v_mul_f32 v54, v54, v168
v_mul_f32 v55, v55, v168
v_mul_f32 v56, v56, v168
v_mul_f32 v57, v57, v168
v_mul_f32 v58, v58, v168
v_mul_f32 v59, v59, v168
v_mul_f32 v60, v60, v168
v_mul_f32 v61, v61, v168
v_mul_f32 v62, v62, v168
v_mul_f32 v63, v63, v168
v_mul_f32 v64, v64, v168
v_mul_f32 v65, v65, v168
v_mul_f32 v66, v66, v168
v_mul_f32 v67, v67, v168
v_cvt_pk_bf16_f32 v52, v52, v53
v_cvt_pk_bf16_f32 v53, v54, v55
v_cvt_pk_bf16_f32 v54, v56, v57
v_cvt_pk_bf16_f32 v55, v58, v59
v_cvt_pk_bf16_f32 v56, v60, v61
v_cvt_pk_bf16_f32 v57, v62, v63
v_cvt_pk_bf16_f32 v58, v64, v65
v_cvt_pk_bf16_f32 v59, v66, v67
v_permlane32_swap_b32 v52, v54
v_permlane32_swap_b32 v53, v55
v_permlane32_swap_b32 v56, v58
v_permlane32_swap_b32 v57, v59
ds_write_b128 v196, v[52:55] offset:2048
ds_write_b128 v197, v[56:59] offset:2048
v_bfe_u32 v195, v191, 3, 2
v_lshlrev_b32 v195, 4, v195
v_lshlrev_b32 v194, 4, v191
v_xor_b32 v195, v194, v195
v_add_u32 v195, s16, v195
s_waitcnt lgkmcnt(0)
ds_read_b128 v[68:71], v195 offset:0
ds_read_b128 v[72:75], v195 offset:1024
ds_read_b128 v[76:79], v195 offset:2048
ds_read_b128 v[80:83], v195 offset:3072
s_waitcnt lgkmcnt(3)
buffer_store_dwordx4 v[68:71], v194, s[8:11], s15 offen offset:0 sc1
s_waitcnt lgkmcnt(2)
buffer_store_dwordx4 v[72:75], v194, s[8:11], s15 offen offset:1024 sc1
s_waitcnt lgkmcnt(1)
buffer_store_dwordx4 v[76:79], v194, s[8:11], s15 offen offset:2048 sc1
s_waitcnt lgkmcnt(0)
buffer_store_dwordx4 v[80:83], v194, s[8:11], s15 offen offset:3072 sc1
s_load_dwordx4 s[36:39], s[0:1], 64
s_and_b32 s44, s2, 7
s_lshl_b32 s44, s44, 1
s_bfe_u32 s46, s2, 0x10003
s_add_u32 s44, s44, s46
s_lshr_b32 s45, s2, 4
s_and_b32 s51, s12, 1
s_lshr_b32 s52, s12, 1
s_add_u32 s40, s4, 41951232
s_addc_u32 s41, s5, 0
s_lshl_b32 s46, s14, 1
s_add_u32 s46, s46, s52
s_lshl_b32 s46, s46, 6
s_lshl_b32 s47, s13, 1
s_add_u32 s46, s46, s47
s_add_u32 s46, s46, s51
s_lshl_b32 s46, s46, 2
v_mov_b32 v196, s46
v_mov_b32 v197, s100
s_lshl_b32 s46, s44, 8
v_lshl_add_u32 v104, v191, 2, s46
v_lshrrev_b32 v193, 4, v191
v_and_b32 v194, 3, v191
v_xor_b32 v194, v194, v193
v_lshrrev_b32 v192, 2, v191
v_lshlrev_b32 v192, 6, v192
v_lshl_add_u32 v192, v194, 4, v192
s_lshl_b32 s46, s44, 13
s_lshl_b32 s47, s12, 11
s_add_u32 s46, s46, s47
v_add_u32 v180, s46, v192
v_add_u32 v181, 131072, v180
v_lshrrev_b32 v192, 3, v191
s_lshl_b32 s46, s12, 4
v_add_u32 v192, s46, v192
v_lshlrev_b32 v192, 11, v192
v_and_b32 v193, 1, v193
v_lshlrev_b32 v193, 2, v193
v_and_b32 v194, 7, v191
v_xor_b32 v194, v194, v193
v_lshl_add_u32 v192, v194, 4, v192
s_lshl_b32 s46, s45, 7
v_add_u32 v102, s46, v192
v_add_u32 v103, 16384, v102
s_waitcnt vmcnt(0)
s_mov_b64 exec, 1
global_store_dword v196, v197, s[40:41] sc1
s_mov_b64 exec, -1
v_and_b32 v192, 31, v191
v_lshrrev_b32 v193, 5, v191
v_bfe_u32 v194, v191, 2, 2
v_xor_b32 v194, v194, v193
s_lshl_b32 s46, s51, 6
v_add_u32 v192, s46, v192
v_lshlrev_b32 v192, 6, v192
v_lshl_add_u32 v176, v194, 4, v192
v_xor_b32 v177, 32, v176
v_lshrrev_b32 v192, 5, v191
v_lshlrev_b32 v192, 3, v192
v_bfe_u32 v193, v191, 2, 2
v_add_u32 v192, v192, v193
v_lshlrev_b32 v192, 7, v192
v_lshrrev_b32 v193, 1, v193
v_xor_b32 v193, s52, v193
v_lshl_add_u32 v192, v193, 6, v192
v_bfe_u32 v193, v191, 4, 1
v_lshl_add_u32 v192, v193, 5, v192
v_and_b32 v193, 3, v191
v_lshl_add_u32 v192, v193, 3, v192
v_add_u32 v100, 65536, v192
v_add_u32 v101, 106496, v192
v_mov_b32 v4, 0
v_mov_b32 v5, 0
v_mov_b32 v6, 0
v_mov_b32 v7, 0
v_mov_b32 v8, 0
v_mov_b32 v9, 0
v_mov_b32 v10, 0
v_mov_b32 v11, 0
v_mov_b32 v12, 0
v_mov_b32 v13, 0
v_mov_b32 v14, 0
v_mov_b32 v15, 0
v_mov_b32 v16, 0
v_mov_b32 v17, 0
v_mov_b32 v18, 0
v_mov_b32 v19, 0
v_mov_b32 v20, 0
v_mov_b32 v21, 0
v_mov_b32 v22, 0
v_mov_b32 v23, 0
v_mov_b32 v24, 0
v_mov_b32 v25, 0
v_mov_b32 v26, 0
v_mov_b32 v27, 0
v_mov_b32 v28, 0
v_mov_b32 v29, 0
v_mov_b32 v30, 0
v_mov_b32 v31, 0
v_mov_b32 v32, 0
v_mov_b32 v33, 0
v_mov_b32 v34, 0
v_mov_b32 v35, 0
s_lshl_b32 s50, s12, 12
s_lshl_b32 s47, s12, 11
s_lshr_b32 s48, s2, 6
s_mul_i32 s48, s48, 0
s_add_u32 s49, s48, 10
s_and_b32 s49, s49, 15
s_lshl_b32 s49, s49, 17
s_lshl_b32 s48, s48, 18
s_waitcnt lgkmcnt(0)
s_add_u32 s24, s4, 46137344
s_addc_u32 s25, s5, 0
s_and_b32 s25, s25, 0xffff
s_mov_b32 s26, 4194304
s_mov_b32 s27, 0x20000
s_mov_b32 s28, s36
s_and_b32 s29, s37, 0xffff
s_mov_b32 s30, 2097152
s_mov_b32 s31, 0x20000
s_mov_b32 s32, s38
s_and_b32 s33, s39, 0xffff
s_mov_b32 s34, 8388608
s_mov_b32 s35, 0x20000
s_barrier
s_mov_b64 s[42:43], 0
s_mov_b32 s46, 0
L_concat_heads__ssm_conv_h3__softmax_full_mha__prompt_kernel_chk0:
s_bfe_u32 s53, s42, 262144
s_cmp_eq_u32 s53, 15
s_cbranch_scc1 L_concat_heads__ssm_conv_h3__softmax_full_mha__prompt_kernel_ok0
global_load_dword v197, v104, s[40:41] sc1
s_waitcnt vmcnt(0)
v_cmp_eq_u32 s[42:43], s100, v197
s_add_u32 s46, s46, 1
s_cmp_lt_u32 s46, 0x400000
s_cbranch_scc1 L_concat_heads__ssm_conv_h3__softmax_full_mha__prompt_kernel_chk0
L_concat_heads__ssm_conv_h3__softmax_full_mha__prompt_kernel_ok0:
s_add_u32 m0, s47, 0
s_nop 0
buffer_load_dwordx4 v180, s[24:27], s48 offen offset:0 lds
s_add_u32 m0, s47, 0
s_nop 0
buffer_load_dwordx4 v180, s[24:27], s48 offen offset:1024 lds
s_add_u32 m0, s47, 8192
s_nop 0
buffer_load_dwordx4 v181, s[24:27], s48 offen offset:0 lds
s_add_u32 m0, s47, 8192
s_nop 0
buffer_load_dwordx4 v181, s[24:27], s48 offen offset:1024 lds
s_add_u32 s48, s48, 262144
s_and_b32 s48, s48, 4194303
L_concat_heads__ssm_conv_h3__softmax_full_mha__prompt_kernel_chk1:
s_bfe_u32 s53, s42, 262148
s_cmp_eq_u32 s53, 15
s_cbranch_scc1 L_concat_heads__ssm_conv_h3__softmax_full_mha__prompt_kernel_ok1
global_load_dword v197, v104, s[40:41] sc1
s_waitcnt vmcnt(0)
v_cmp_eq_u32 s[42:43], s100, v197
s_add_u32 s46, s46, 1
s_cmp_lt_u32 s46, 0x400000
s_cbranch_scc1 L_concat_heads__ssm_conv_h3__softmax_full_mha__prompt_kernel_chk1
L_concat_heads__ssm_conv_h3__softmax_full_mha__prompt_kernel_ok1:
s_add_u32 m0, s47, 16384
s_nop 0
buffer_load_dwordx4 v180, s[24:27], s48 offen offset:0 lds
s_add_u32 m0, s47, 16384
s_nop 0
buffer_load_dwordx4 v180, s[24:27], s48 offen offset:1024 lds
s_add_u32 m0, s47, 24576
s_nop 0
buffer_load_dwordx4 v181, s[24:27], s48 offen offset:0 lds
s_add_u32 m0, s47, 24576
s_nop 0
buffer_load_dwordx4 v181, s[24:27], s48 offen offset:1024 lds
s_add_u32 s48, s48, 262144
s_and_b32 s48, s48, 4194303
L_concat_heads__ssm_conv_h3__softmax_full_mha__prompt_kernel_chk2:
s_bfe_u32 s53, s42, 262152
s_cmp_eq_u32 s53, 15
s_cbranch_scc1 L_concat_heads__ssm_conv_h3__softmax_full_mha__prompt_kernel_ok2
global_load_dword v197, v104, s[40:41] sc1
s_waitcnt vmcnt(0)
v_cmp_eq_u32 s[42:43], s100, v197
s_add_u32 s46, s46, 1
s_cmp_lt_u32 s46, 0x400000
s_cbranch_scc1 L_concat_heads__ssm_conv_h3__softmax_full_mha__prompt_kernel_chk2
L_concat_heads__ssm_conv_h3__softmax_full_mha__prompt_kernel_ok2:
s_add_u32 m0, s47, 32768
s_nop 0
buffer_load_dwordx4 v180, s[24:27], s48 offen offset:0 lds
s_add_u32 m0, s47, 32768
s_nop 0
buffer_load_dwordx4 v180, s[24:27], s48 offen offset:1024 lds
s_add_u32 m0, s47, 40960
s_nop 0
buffer_load_dwordx4 v181, s[24:27], s48 offen offset:0 lds
s_add_u32 m0, s47, 40960
s_nop 0
buffer_load_dwordx4 v181, s[24:27], s48 offen offset:1024 lds
s_add_u32 s48, s48, 262144
s_and_b32 s48, s48, 4194303
L_concat_heads__ssm_conv_h3__softmax_full_mha__prompt_kernel_chk3:
s_bfe_u32 s53, s42, 262156
s_cmp_eq_u32 s53, 15
s_cbranch_scc1 L_concat_heads__ssm_conv_h3__softmax_full_mha__prompt_kernel_ok3
global_load_dword v197, v104, s[40:41] sc1
s_waitcnt vmcnt(0)
v_cmp_eq_u32 s[42:43], s100, v197
s_add_u32 s46, s46, 1
s_cmp_lt_u32 s46, 0x400000
s_cbranch_scc1 L_concat_heads__ssm_conv_h3__softmax_full_mha__prompt_kernel_chk3
L_concat_heads__ssm_conv_h3__softmax_full_mha__prompt_kernel_ok3:
s_add_u32 m0, s47, 49152
s_nop 0
buffer_load_dwordx4 v180, s[24:27], s48 offen offset:0 lds
s_add_u32 m0, s47, 49152
s_nop 0
buffer_load_dwordx4 v180, s[24:27], s48 offen offset:1024 lds
s_add_u32 m0, s47, 57344
s_nop 0
buffer_load_dwordx4 v181, s[24:27], s48 offen offset:0 lds
s_add_u32 m0, s47, 57344
s_nop 0
buffer_load_dwordx4 v181, s[24:27], s48 offen offset:1024 lds
s_add_u32 s48, s48, 262144
s_and_b32 s48, s48, 4194303
s_waitcnt vmcnt(12)
s_barrier
ds_read_b128 v[36:39], v176 offset:0
ds_read_b128 v[40:43], v176 offset:2048
ds_read_b64_tr_b16 v[44:45], v100 offset:0
ds_read_b64_tr_b16 v[46:47], v100 offset:512
ds_read_b128 v[48:51], v177 offset:0
ds_read_b128 v[52:55], v177 offset:2048
ds_read_b64_tr_b16 v[56:57], v100 offset:2048
ds_read_b64_tr_b16 v[58:59], v100 offset:2560
ds_read_b128 v[60:63], v176 offset:8192
ds_read_b128 v[64:67], v176 offset:10240
ds_read_b64_tr_b16 v[68:69], v100 offset:4096
ds_read_b64_tr_b16 v[70:71], v100 offset:4608
ds_read_b128 v[72:75], v177 offset:8192
ds_read_b128 v[76:79], v177 offset:10240
ds_read_b64_tr_b16 v[80:81], v100 offset:6144
ds_read_b64_tr_b16 v[82:83], v100 offset:6656
s_waitcnt lgkmcnt(0)
s_waitcnt vmcnt(8)
s_barrier
v_mfma_f32_32x32x16_bf16 v[4:19], v[44:47], v[36:39], v[4:19]
ds_read_b128 v[116:119], v176 offset:16384
ds_read_b128 v[120:123], v176 offset:18432
ds_read_b64_tr_b16 v[124:125], v100 offset:8192
v_mfma_f32_32x32x16_bf16 v[20:35], v[44:47], v[40:43], v[20:35]
ds_read_b64_tr_b16 v[126:127], v100 offset:8704
ds_read_b128 v[128:131], v177 offset:16384
ds_read_b128 v[132:135], v177 offset:18432
v_mfma_f32_32x32x16_bf16 v[4:19], v[56:59], v[48:51], v[4:19]
ds_read_b64_tr_b16 v[136:137], v100 offset:10240
ds_read_b64_tr_b16 v[138:139], v100 offset:10752
ds_read_b128 v[140:143], v176 offset:24576
v_mfma_f32_32x32x16_bf16 v[20:35], v[56:59], v[52:55], v[20:35]
ds_read_b128 v[144:147], v176 offset:26624
ds_read_b64_tr_b16 v[148:149], v100 offset:12288
ds_read_b64_tr_b16 v[150:151], v100 offset:12800
v_mfma_f32_32x32x16_bf16 v[4:19], v[68:71], v[60:63], v[4:19]
ds_read_b128 v[152:155], v177 offset:24576
ds_read_b128 v[156:159], v177 offset:26624
ds_read_b64_tr_b16 v[160:161], v100 offset:14336
v_mfma_f32_32x32x16_bf16 v[20:35], v[68:71], v[64:67], v[20:35]
ds_read_b64_tr_b16 v[162:163], v100 offset:14848
L_concat_heads__ssm_conv_h3__softmax_full_mha__prompt_kernel_chk4:
s_bfe_u32 s53, s42, 262160
s_cmp_eq_u32 s53, 15
s_cbranch_scc1 L_concat_heads__ssm_conv_h3__softmax_full_mha__prompt_kernel_ok4
global_load_dword v197, v104, s[40:41] sc1
s_waitcnt vmcnt(0)
v_cmp_eq_u32 s[42:43], s100, v197
s_add_u32 s46, s46, 1
s_cmp_lt_u32 s46, 0x400000
s_cbranch_scc1 L_concat_heads__ssm_conv_h3__softmax_full_mha__prompt_kernel_chk4
L_concat_heads__ssm_conv_h3__softmax_full_mha__prompt_kernel_ok4:
s_add_u32 m0, s47, 0
s_nop 0
buffer_load_dwordx4 v180, s[24:27], s48 offen offset:0 lds
s_add_u32 m0, s47, 0
s_nop 0
buffer_load_dwordx4 v180, s[24:27], s48 offen offset:1024 lds
s_add_u32 m0, s47, 8192
s_nop 0
buffer_load_dwordx4 v181, s[24:27], s48 offen offset:0 lds
v_mfma_f32_32x32x16_bf16 v[4:19], v[80:83], v[72:75], v[4:19]
s_add_u32 m0, s47, 8192
s_nop 0
buffer_load_dwordx4 v181, s[24:27], s48 offen offset:1024 lds
s_add_u32 s48, s48, 262144
s_and_b32 s48, s48, 4194303
s_add_u32 m0, s47, 65536
s_nop 0
buffer_load_dwordx4 v102, s[28:31], s49 offen lds
s_add_u32 m0, s47, 66560
s_nop 0
buffer_load_dwordx4 v103, s[28:31], s49 offen lds
s_add_u32 s49, s49, 131072
s_and_b32 s49, s49, 2097151
v_mfma_f32_32x32x16_bf16 v[20:35], v[80:83], v[76:79], v[20:35]
s_waitcnt lgkmcnt(0)
s_waitcnt vmcnt(10)
s_barrier
v_mfma_f32_32x32x16_bf16 v[4:19], v[124:127], v[116:119], v[4:19]
ds_read_b128 v[36:39], v176 offset:32768
ds_read_b128 v[40:43], v176 offset:34816
ds_read_b64_tr_b16 v[44:45], v100 offset:16384
v_mfma_f32_32x32x16_bf16 v[20:35], v[124:127], v[120:123], v[20:35]
ds_read_b64_tr_b16 v[46:47], v100 offset:16896
ds_read_b128 v[48:51], v177 offset:32768
ds_read_b128 v[52:55], v177 offset:34816
v_mfma_f32_32x32x16_bf16 v[4:19], v[136:139], v[128:131], v[4:19]
ds_read_b64_tr_b16 v[56:57], v100 offset:18432
ds_read_b64_tr_b16 v[58:59], v100 offset:18944
ds_read_b128 v[60:63], v176 offset:40960
v_mfma_f32_32x32x16_bf16 v[20:35], v[136:139], v[132:135], v[20:35]
ds_read_b128 v[64:67], v176 offset:43008
ds_read_b64_tr_b16 v[68:69], v100 offset:20480
ds_read_b64_tr_b16 v[70:71], v100 offset:20992
v_mfma_f32_32x32x16_bf16 v[4:19], v[148:151], v[140:143], v[4:19]
ds_read_b128 v[72:75], v177 offset:40960
ds_read_b128 v[76:79], v177 offset:43008
ds_read_b64_tr_b16 v[80:81], v100 offset:22528
v_mfma_f32_32x32x16_bf16 v[20:35], v[148:151], v[144:147], v[20:35]
ds_read_b64_tr_b16 v[82:83], v100 offset:23040
L_concat_heads__ssm_conv_h3__softmax_full_mha__prompt_kernel_chk5:
s_bfe_u32 s53, s42, 262164
s_cmp_eq_u32 s53, 15
s_cbranch_scc1 L_concat_heads__ssm_conv_h3__softmax_full_mha__prompt_kernel_ok5
global_load_dword v197, v104, s[40:41] sc1
s_waitcnt vmcnt(0)
v_cmp_eq_u32 s[42:43], s100, v197
s_add_u32 s46, s46, 1
s_cmp_lt_u32 s46, 0x400000
s_cbranch_scc1 L_concat_heads__ssm_conv_h3__softmax_full_mha__prompt_kernel_chk5
L_concat_heads__ssm_conv_h3__softmax_full_mha__prompt_kernel_ok5:
s_add_u32 m0, s47, 16384
s_nop 0
buffer_load_dwordx4 v180, s[24:27], s48 offen offset:0 lds
s_add_u32 m0, s47, 16384
s_nop 0
buffer_load_dwordx4 v180, s[24:27], s48 offen offset:1024 lds
s_add_u32 m0, s47, 24576
s_nop 0
buffer_load_dwordx4 v181, s[24:27], s48 offen offset:0 lds
v_mfma_f32_32x32x16_bf16 v[4:19], v[160:163], v[152:155], v[4:19]
s_add_u32 m0, s47, 24576
s_nop 0
buffer_load_dwordx4 v181, s[24:27], s48 offen offset:1024 lds
s_add_u32 s48, s48, 262144
s_and_b32 s48, s48, 4194303
s_add_u32 m0, s47, 73728
s_nop 0
buffer_load_dwordx4 v102, s[28:31], s49 offen lds
s_add_u32 m0, s47, 74752
s_nop 0
buffer_load_dwordx4 v103, s[28:31], s49 offen lds
s_add_u32 s49, s49, 131072
s_and_b32 s49, s49, 2097151
v_mfma_f32_32x32x16_bf16 v[20:35], v[160:163], v[156:159], v[20:35]
s_waitcnt lgkmcnt(0)
s_waitcnt vmcnt(12)
s_barrier
v_mfma_f32_32x32x16_bf16 v[4:19], v[44:47], v[36:39], v[4:19]
ds_read_b128 v[116:119], v176 offset:49152
ds_read_b128 v[120:123], v176 offset:51200
ds_read_b64_tr_b16 v[124:125], v100 offset:24576
v_mfma_f32_32x32x16_bf16 v[20:35], v[44:47], v[40:43], v[20:35]
ds_read_b64_tr_b16 v[126:127], v100 offset:25088
ds_read_b128 v[128:131], v177 offset:49152
ds_read_b128 v[132:135], v177 offset:51200
v_mfma_f32_32x32x16_bf16 v[4:19], v[56:59], v[48:51], v[4:19]
ds_read_b64_tr_b16 v[136:137], v100 offset:26624
ds_read_b64_tr_b16 v[138:139], v100 offset:27136
ds_read_b128 v[140:143], v176 offset:57344
v_mfma_f32_32x32x16_bf16 v[20:35], v[56:59], v[52:55], v[20:35]
ds_read_b128 v[144:147], v176 offset:59392
ds_read_b64_tr_b16 v[148:149], v100 offset:28672
ds_read_b64_tr_b16 v[150:151], v100 offset:29184
v_mfma_f32_32x32x16_bf16 v[4:19], v[68:71], v[60:63], v[4:19]
ds_read_b128 v[152:155], v177 offset:57344
ds_read_b128 v[156:159], v177 offset:59392
ds_read_b64_tr_b16 v[160:161], v100 offset:30720
v_mfma_f32_32x32x16_bf16 v[20:35], v[68:71], v[64:67], v[20:35]
ds_read_b64_tr_b16 v[162:163], v100 offset:31232
L_concat_heads__ssm_conv_h3__softmax_full_mha__prompt_kernel_chk6:
s_bfe_u32 s53, s42, 262168
s_cmp_eq_u32 s53, 15
s_cbranch_scc1 L_concat_heads__ssm_conv_h3__softmax_full_mha__prompt_kernel_ok6
global_load_dword v197, v104, s[40:41] sc1
s_waitcnt vmcnt(0)
v_cmp_eq_u32 s[42:43], s100, v197
s_add_u32 s46, s46, 1
s_cmp_lt_u32 s46, 0x400000
s_cbranch_scc1 L_concat_heads__ssm_conv_h3__softmax_full_mha__prompt_kernel_chk6
L_concat_heads__ssm_conv_h3__softmax_full_mha__prompt_kernel_ok6:
s_add_u32 m0, s47, 32768
s_nop 0
buffer_load_dwordx4 v180, s[24:27], s48 offen offset:0 lds
s_add_u32 m0, s47, 32768
s_nop 0
buffer_load_dwordx4 v180, s[24:27], s48 offen offset:1024 lds
s_add_u32 m0, s47, 40960
s_nop 0
buffer_load_dwordx4 v181, s[24:27], s48 offen offset:0 lds
v_mfma_f32_32x32x16_bf16 v[4:19], v[80:83], v[72:75], v[4:19]
s_add_u32 m0, s47, 40960
s_nop 0
buffer_load_dwordx4 v181, s[24:27], s48 offen offset:1024 lds
s_add_u32 s48, s48, 262144
s_and_b32 s48, s48, 4194303
s_add_u32 m0, s47, 81920
s_nop 0
buffer_load_dwordx4 v102, s[28:31], s49 offen lds
s_add_u32 m0, s47, 82944
s_nop 0
buffer_load_dwordx4 v103, s[28:31], s49 offen lds
s_add_u32 s49, s49, 131072
s_and_b32 s49, s49, 2097151
v_mfma_f32_32x32x16_bf16 v[20:35], v[80:83], v[76:79], v[20:35]
s_waitcnt lgkmcnt(0)
s_waitcnt vmcnt(14)
s_barrier
v_mfma_f32_32x32x16_bf16 v[4:19], v[124:127], v[116:119], v[4:19]
ds_read_b128 v[36:39], v176 offset:0
ds_read_b128 v[40:43], v176 offset:2048
ds_read_b64_tr_b16 v[44:45], v100 offset:32768
v_mfma_f32_32x32x16_bf16 v[20:35], v[124:127], v[120:123], v[20:35]
ds_read_b64_tr_b16 v[46:47], v100 offset:33280
ds_read_b128 v[48:51], v177 offset:0
ds_read_b128 v[52:55], v177 offset:2048
v_mfma_f32_32x32x16_bf16 v[4:19], v[136:139], v[128:131], v[4:19]
ds_read_b64_tr_b16 v[56:57], v100 offset:34816
ds_read_b64_tr_b16 v[58:59], v100 offset:35328
ds_read_b128 v[60:63], v176 offset:8192
v_mfma_f32_32x32x16_bf16 v[20:35], v[136:139], v[132:135], v[20:35]
ds_read_b128 v[64:67], v176 offset:10240
ds_read_b64_tr_b16 v[68:69], v100 offset:36864
ds_read_b64_tr_b16 v[70:71], v100 offset:37376
v_mfma_f32_32x32x16_bf16 v[4:19], v[148:151], v[140:143], v[4:19]
ds_read_b128 v[72:75], v177 offset:8192
ds_read_b128 v[76:79], v177 offset:10240
ds_read_b64_tr_b16 v[80:81], v100 offset:38912
v_mfma_f32_32x32x16_bf16 v[20:35], v[148:151], v[144:147], v[20:35]
ds_read_b64_tr_b16 v[82:83], v100 offset:39424
L_concat_heads__ssm_conv_h3__softmax_full_mha__prompt_kernel_chk7:
s_bfe_u32 s53, s42, 262172
s_cmp_eq_u32 s53, 15
s_cbranch_scc1 L_concat_heads__ssm_conv_h3__softmax_full_mha__prompt_kernel_ok7
global_load_dword v197, v104, s[40:41] sc1
s_waitcnt vmcnt(0)
v_cmp_eq_u32 s[42:43], s100, v197
s_add_u32 s46, s46, 1
s_cmp_lt_u32 s46, 0x400000
s_cbranch_scc1 L_concat_heads__ssm_conv_h3__softmax_full_mha__prompt_kernel_chk7
L_concat_heads__ssm_conv_h3__softmax_full_mha__prompt_kernel_ok7:
s_add_u32 m0, s47, 49152
s_nop 0
buffer_load_dwordx4 v180, s[24:27], s48 offen offset:0 lds
s_add_u32 m0, s47, 49152
s_nop 0
buffer_load_dwordx4 v180, s[24:27], s48 offen offset:1024 lds
s_add_u32 m0, s47, 57344
s_nop 0
buffer_load_dwordx4 v181, s[24:27], s48 offen offset:0 lds
v_mfma_f32_32x32x16_bf16 v[4:19], v[160:163], v[152:155], v[4:19]
s_add_u32 m0, s47, 57344
s_nop 0
buffer_load_dwordx4 v181, s[24:27], s48 offen offset:1024 lds
s_add_u32 s48, s48, 262144
s_and_b32 s48, s48, 4194303
s_add_u32 m0, s47, 90112
s_nop 0
buffer_load_dwordx4 v102, s[28:31], s49 offen lds
s_add_u32 m0, s47, 91136
s_nop 0
buffer_load_dwordx4 v103, s[28:31], s49 offen lds
s_add_u32 s49, s49, 131072
s_and_b32 s49, s49, 2097151
v_mfma_f32_32x32x16_bf16 v[20:35], v[160:163], v[156:159], v[20:35]
s_waitcnt lgkmcnt(0)
s_waitcnt vmcnt(14)
s_barrier
v_mfma_f32_32x32x16_bf16 v[4:19], v[44:47], v[36:39], v[4:19]
ds_read_b128 v[116:119], v176 offset:16384
ds_read_b128 v[120:123], v176 offset:18432
ds_read_b64_tr_b16 v[124:125], v101 offset:0
v_mfma_f32_32x32x16_bf16 v[20:35], v[44:47], v[40:43], v[20:35]
ds_read_b64_tr_b16 v[126:127], v101 offset:512
ds_read_b128 v[128:131], v177 offset:16384
ds_read_b128 v[132:135], v177 offset:18432
v_mfma_f32_32x32x16_bf16 v[4:19], v[56:59], v[48:51], v[4:19]
ds_read_b64_tr_b16 v[136:137], v101 offset:2048
ds_read_b64_tr_b16 v[138:139], v101 offset:2560
ds_read_b128 v[140:143], v176 offset:24576
v_mfma_f32_32x32x16_bf16 v[20:35], v[56:59], v[52:55], v[20:35]
ds_read_b128 v[144:147], v176 offset:26624
ds_read_b64_tr_b16 v[148:149], v101 offset:4096
ds_read_b64_tr_b16 v[150:151], v101 offset:4608
v_mfma_f32_32x32x16_bf16 v[4:19], v[68:71], v[60:63], v[4:19]
ds_read_b128 v[152:155], v177 offset:24576
ds_read_b128 v[156:159], v177 offset:26624
ds_read_b64_tr_b16 v[160:161], v101 offset:6144
v_mfma_f32_32x32x16_bf16 v[20:35], v[68:71], v[64:67], v[20:35]
ds_read_b64_tr_b16 v[162:163], v101 offset:6656
L_concat_heads__ssm_conv_h3__softmax_full_mha__prompt_kernel_chk8:
s_bfe_u32 s53, s43, 262144
s_cmp_eq_u32 s53, 15
s_cbranch_scc1 L_concat_heads__ssm_conv_h3__softmax_full_mha__prompt_kernel_ok8
global_load_dword v197, v104, s[40:41] sc1
s_waitcnt vmcnt(0)
v_cmp_eq_u32 s[42:43], s100, v197
s_add_u32 s46, s46, 1
s_cmp_lt_u32 s46, 0x400000
s_cbranch_scc1 L_concat_heads__ssm_conv_h3__softmax_full_mha__prompt_kernel_chk8
L_concat_heads__ssm_conv_h3__softmax_full_mha__prompt_kernel_ok8:
s_add_u32 m0, s47, 0
s_nop 0
buffer_load_dwordx4 v180, s[24:27], s48 offen offset:0 lds
s_add_u32 m0, s47, 0
s_nop 0
buffer_load_dwordx4 v180, s[24:27], s48 offen offset:1024 lds
s_add_u32 m0, s47, 8192
s_nop 0
buffer_load_dwordx4 v181, s[24:27], s48 offen offset:0 lds
v_mfma_f32_32x32x16_bf16 v[4:19], v[80:83], v[72:75], v[4:19]
s_add_u32 m0, s47, 8192
s_nop 0
buffer_load_dwordx4 v181, s[24:27], s48 offen offset:1024 lds
s_add_u32 s48, s48, 262144
s_and_b32 s48, s48, 4194303
s_add_u32 m0, s47, 98304
s_nop 0
buffer_load_dwordx4 v102, s[28:31], s49 offen lds
s_add_u32 m0, s47, 99328
s_nop 0
buffer_load_dwordx4 v103, s[28:31], s49 offen lds
s_add_u32 s49, s49, 131072
s_and_b32 s49, s49, 2097151
v_mfma_f32_32x32x16_bf16 v[20:35], v[80:83], v[76:79], v[20:35]
s_waitcnt lgkmcnt(0)
s_waitcnt vmcnt(14)
s_barrier
v_mfma_f32_32x32x16_bf16 v[4:19], v[124:127], v[116:119], v[4:19]
ds_read_b128 v[36:39], v176 offset:32768
ds_read_b128 v[40:43], v176 offset:34816
ds_read_b64_tr_b16 v[44:45], v101 offset:8192
v_mfma_f32_32x32x16_bf16 v[20:35], v[124:127], v[120:123], v[20:35]
ds_read_b64_tr_b16 v[46:47], v101 offset:8704
ds_read_b128 v[48:51], v177 offset:32768
ds_read_b128 v[52:55], v177 offset:34816
v_mfma_f32_32x32x16_bf16 v[4:19], v[136:139], v[128:131], v[4:19]
ds_read_b64_tr_b16 v[56:57], v101 offset:10240
ds_read_b64_tr_b16 v[58:59], v101 offset:10752
ds_read_b128 v[60:63], v176 offset:40960
v_mfma_f32_32x32x16_bf16 v[20:35], v[136:139], v[132:135], v[20:35]
ds_read_b128 v[64:67], v176 offset:43008
ds_read_b64_tr_b16 v[68:69], v101 offset:12288
ds_read_b64_tr_b16 v[70:71], v101 offset:12800
v_mfma_f32_32x32x16_bf16 v[4:19], v[148:151], v[140:143], v[4:19]
ds_read_b128 v[72:75], v177 offset:40960
ds_read_b128 v[76:79], v177 offset:43008
ds_read_b64_tr_b16 v[80:81], v101 offset:14336
v_mfma_f32_32x32x16_bf16 v[20:35], v[148:151], v[144:147], v[20:35]
ds_read_b64_tr_b16 v[82:83], v101 offset:14848
L_concat_heads__ssm_conv_h3__softmax_full_mha__prompt_kernel_chk9:
s_bfe_u32 s53, s43, 262148
s_cmp_eq_u32 s53, 15
s_cbranch_scc1 L_concat_heads__ssm_conv_h3__softmax_full_mha__prompt_kernel_ok9
global_load_dword v197, v104, s[40:41] sc1
s_waitcnt vmcnt(0)
v_cmp_eq_u32 s[42:43], s100, v197
s_add_u32 s46, s46, 1
s_cmp_lt_u32 s46, 0x400000
s_cbranch_scc1 L_concat_heads__ssm_conv_h3__softmax_full_mha__prompt_kernel_chk9
L_concat_heads__ssm_conv_h3__softmax_full_mha__prompt_kernel_ok9:
s_add_u32 m0, s47, 16384
s_nop 0
buffer_load_dwordx4 v180, s[24:27], s48 offen offset:0 lds
s_add_u32 m0, s47, 16384
s_nop 0
buffer_load_dwordx4 v180, s[24:27], s48 offen offset:1024 lds
s_add_u32 m0, s47, 24576
s_nop 0
buffer_load_dwordx4 v181, s[24:27], s48 offen offset:0 lds
v_mfma_f32_32x32x16_bf16 v[4:19], v[160:163], v[152:155], v[4:19]
s_add_u32 m0, s47, 24576
s_nop 0
buffer_load_dwordx4 v181, s[24:27], s48 offen offset:1024 lds
s_add_u32 s48, s48, 262144
s_and_b32 s48, s48, 4194303
s_add_u32 m0, s47, 106496
s_nop 0
buffer_load_dwordx4 v102, s[28:31], s49 offen lds
s_add_u32 m0, s47, 107520
s_nop 0
buffer_load_dwordx4 v103, s[28:31], s49 offen lds
s_add_u32 s49, s49, 131072
s_and_b32 s49, s49, 2097151
v_mfma_f32_32x32x16_bf16 v[20:35], v[160:163], v[156:159], v[20:35]
s_waitcnt lgkmcnt(0)
s_waitcnt vmcnt(14)
s_barrier
v_mfma_f32_32x32x16_bf16 v[4:19], v[44:47], v[36:39], v[4:19]
ds_read_b128 v[116:119], v176 offset:49152
ds_read_b128 v[120:123], v176 offset:51200
ds_read_b64_tr_b16 v[124:125], v101 offset:16384
v_mfma_f32_32x32x16_bf16 v[20:35], v[44:47], v[40:43], v[20:35]
ds_read_b64_tr_b16 v[126:127], v101 offset:16896
ds_read_b128 v[128:131], v177 offset:49152
ds_read_b128 v[132:135], v177 offset:51200
v_mfma_f32_32x32x16_bf16 v[4:19], v[56:59], v[48:51], v[4:19]
ds_read_b64_tr_b16 v[136:137], v101 offset:18432
ds_read_b64_tr_b16 v[138:139], v101 offset:18944
ds_read_b128 v[140:143], v176 offset:57344
v_mfma_f32_32x32x16_bf16 v[20:35], v[56:59], v[52:55], v[20:35]
ds_read_b128 v[144:147], v176 offset:59392
ds_read_b64_tr_b16 v[148:149], v101 offset:20480
ds_read_b64_tr_b16 v[150:151], v101 offset:20992
v_mfma_f32_32x32x16_bf16 v[4:19], v[68:71], v[60:63], v[4:19]
ds_read_b128 v[152:155], v177 offset:57344
ds_read_b128 v[156:159], v177 offset:59392
ds_read_b64_tr_b16 v[160:161], v101 offset:22528
v_mfma_f32_32x32x16_bf16 v[20:35], v[68:71], v[64:67], v[20:35]
ds_read_b64_tr_b16 v[162:163], v101 offset:23040
L_concat_heads__ssm_conv_h3__softmax_full_mha__prompt_kernel_chk10:
s_bfe_u32 s53, s43, 262152
s_cmp_eq_u32 s53, 15
s_cbranch_scc1 L_concat_heads__ssm_conv_h3__softmax_full_mha__prompt_kernel_ok10
global_load_dword v197, v104, s[40:41] sc1
s_waitcnt vmcnt(0)
v_cmp_eq_u32 s[42:43], s100, v197
s_add_u32 s46, s46, 1
s_cmp_lt_u32 s46, 0x400000
s_cbranch_scc1 L_concat_heads__ssm_conv_h3__softmax_full_mha__prompt_kernel_chk10
L_concat_heads__ssm_conv_h3__softmax_full_mha__prompt_kernel_ok10:
s_add_u32 m0, s47, 32768
s_nop 0
buffer_load_dwordx4 v180, s[24:27], s48 offen offset:0 lds
s_add_u32 m0, s47, 32768
s_nop 0
buffer_load_dwordx4 v180, s[24:27], s48 offen offset:1024 lds
s_add_u32 m0, s47, 40960
s_nop 0
buffer_load_dwordx4 v181, s[24:27], s48 offen offset:0 lds
v_mfma_f32_32x32x16_bf16 v[4:19], v[80:83], v[72:75], v[4:19]
s_add_u32 m0, s47, 40960
s_nop 0
buffer_load_dwordx4 v181, s[24:27], s48 offen offset:1024 lds
s_add_u32 s48, s48, 262144
s_and_b32 s48, s48, 4194303
v_mfma_f32_32x32x16_bf16 v[20:35], v[80:83], v[76:79], v[20:35]
s_waitcnt lgkmcnt(0)
s_waitcnt vmcnt(12)
s_barrier
v_mfma_f32_32x32x16_bf16 v[4:19], v[124:127], v[116:119], v[4:19]
ds_read_b128 v[36:39], v176 offset:0
ds_read_b128 v[40:43], v176 offset:2048
ds_read_b64_tr_b16 v[44:45], v101 offset:24576
v_mfma_f32_32x32x16_bf16 v[20:35], v[124:127], v[120:123], v[20:35]
ds_read_b64_tr_b16 v[46:47], v101 offset:25088
ds_read_b128 v[48:51], v177 offset:0
ds_read_b128 v[52:55], v177 offset:2048
v_mfma_f32_32x32x16_bf16 v[4:19], v[136:139], v[128:131], v[4:19]
ds_read_b64_tr_b16 v[56:57], v101 offset:26624
ds_read_b64_tr_b16 v[58:59], v101 offset:27136
ds_read_b128 v[60:63], v176 offset:8192
v_mfma_f32_32x32x16_bf16 v[20:35], v[136:139], v[132:135], v[20:35]
ds_read_b128 v[64:67], v176 offset:10240
ds_read_b64_tr_b16 v[68:69], v101 offset:28672
ds_read_b64_tr_b16 v[70:71], v101 offset:29184
v_mfma_f32_32x32x16_bf16 v[4:19], v[148:151], v[140:143], v[4:19]
ds_read_b128 v[72:75], v177 offset:8192
ds_read_b128 v[76:79], v177 offset:10240
ds_read_b64_tr_b16 v[80:81], v101 offset:30720
v_mfma_f32_32x32x16_bf16 v[20:35], v[148:151], v[144:147], v[20:35]
ds_read_b64_tr_b16 v[82:83], v101 offset:31232
L_concat_heads__ssm_conv_h3__softmax_full_mha__prompt_kernel_chk11:
s_bfe_u32 s53, s43, 262156
s_cmp_eq_u32 s53, 15
s_cbranch_scc1 L_concat_heads__ssm_conv_h3__softmax_full_mha__prompt_kernel_ok11
global_load_dword v197, v104, s[40:41] sc1
s_waitcnt vmcnt(0)
v_cmp_eq_u32 s[42:43], s100, v197
s_add_u32 s46, s46, 1
s_cmp_lt_u32 s46, 0x400000
s_cbranch_scc1 L_concat_heads__ssm_conv_h3__softmax_full_mha__prompt_kernel_chk11
L_concat_heads__ssm_conv_h3__softmax_full_mha__prompt_kernel_ok11:
s_add_u32 m0, s47, 49152
s_nop 0
buffer_load_dwordx4 v180, s[24:27], s48 offen offset:0 lds
s_add_u32 m0, s47, 49152
s_nop 0
buffer_load_dwordx4 v180, s[24:27], s48 offen offset:1024 lds
s_add_u32 m0, s47, 57344
s_nop 0
buffer_load_dwordx4 v181, s[24:27], s48 offen offset:0 lds
v_mfma_f32_32x32x16_bf16 v[4:19], v[160:163], v[152:155], v[4:19]
s_add_u32 m0, s47, 57344
s_nop 0
buffer_load_dwordx4 v181, s[24:27], s48 offen offset:1024 lds
s_add_u32 s48, s48, 262144
s_and_b32 s48, s48, 4194303
v_mfma_f32_32x32x16_bf16 v[20:35], v[160:163], v[156:159], v[20:35]
s_waitcnt lgkmcnt(0)
s_waitcnt vmcnt(10)
s_barrier
v_mfma_f32_32x32x16_bf16 v[4:19], v[44:47], v[36:39], v[4:19]
ds_read_b128 v[116:119], v176 offset:16384
ds_read_b128 v[120:123], v176 offset:18432
ds_read_b64_tr_b16 v[124:125], v101 offset:32768
v_mfma_f32_32x32x16_bf16 v[20:35], v[44:47], v[40:43], v[20:35]
ds_read_b64_tr_b16 v[126:127], v101 offset:33280
ds_read_b128 v[128:131], v177 offset:16384
ds_read_b128 v[132:135], v177 offset:18432
v_mfma_f32_32x32x16_bf16 v[4:19], v[56:59], v[48:51], v[4:19]
ds_read_b64_tr_b16 v[136:137], v101 offset:34816
ds_read_b64_tr_b16 v[138:139], v101 offset:35328
ds_read_b128 v[140:143], v176 offset:24576
v_mfma_f32_32x32x16_bf16 v[20:35], v[56:59], v[52:55], v[20:35]
ds_read_b128 v[144:147], v176 offset:26624
ds_read_b64_tr_b16 v[148:149], v101 offset:36864
ds_read_b64_tr_b16 v[150:151], v101 offset:37376
v_mfma_f32_32x32x16_bf16 v[4:19], v[68:71], v[60:63], v[4:19]
ds_read_b128 v[152:155], v177 offset:24576
ds_read_b128 v[156:159], v177 offset:26624
ds_read_b64_tr_b16 v[160:161], v101 offset:38912
v_mfma_f32_32x32x16_bf16 v[20:35], v[68:71], v[64:67], v[20:35]
ds_read_b64_tr_b16 v[162:163], v101 offset:39424
L_concat_heads__ssm_conv_h3__softmax_full_mha__prompt_kernel_chk12:
s_bfe_u32 s53, s43, 262160
s_cmp_eq_u32 s53, 15
s_cbranch_scc1 L_concat_heads__ssm_conv_h3__softmax_full_mha__prompt_kernel_ok12
global_load_dword v197, v104, s[40:41] sc1
s_waitcnt vmcnt(0)
v_cmp_eq_u32 s[42:43], s100, v197
s_add_u32 s46, s46, 1
s_cmp_lt_u32 s46, 0x400000
s_cbranch_scc1 L_concat_heads__ssm_conv_h3__softmax_full_mha__prompt_kernel_chk12
L_concat_heads__ssm_conv_h3__softmax_full_mha__prompt_kernel_ok12:
s_add_u32 m0, s47, 0
s_nop 0
buffer_load_dwordx4 v180, s[24:27], s48 offen offset:0 lds
s_add_u32 m0, s47, 0
s_nop 0
buffer_load_dwordx4 v180, s[24:27], s48 offen offset:1024 lds
s_add_u32 m0, s47, 8192
s_nop 0
buffer_load_dwordx4 v181, s[24:27], s48 offen offset:0 lds
v_mfma_f32_32x32x16_bf16 v[4:19], v[80:83], v[72:75], v[4:19]
s_add_u32 m0, s47, 8192
s_nop 0
buffer_load_dwordx4 v181, s[24:27], s48 offen offset:1024 lds
s_add_u32 s48, s48, 262144
s_and_b32 s48, s48, 4194303
v_mfma_f32_32x32x16_bf16 v[20:35], v[80:83], v[76:79], v[20:35]
s_waitcnt lgkmcnt(0)
s_waitcnt vmcnt(8)
s_barrier
v_mfma_f32_32x32x16_bf16 v[4:19], v[124:127], v[116:119], v[4:19]
ds_read_b128 v[36:39], v176 offset:32768
ds_read_b128 v[40:43], v176 offset:34816
ds_read_b64_tr_b16 v[44:45], v100 offset:0
v_mfma_f32_32x32x16_bf16 v[20:35], v[124:127], v[120:123], v[20:35]
ds_read_b64_tr_b16 v[46:47], v100 offset:512
ds_read_b128 v[48:51], v177 offset:32768
ds_read_b128 v[52:55], v177 offset:34816
v_mfma_f32_32x32x16_bf16 v[4:19], v[136:139], v[128:131], v[4:19]
ds_read_b64_tr_b16 v[56:57], v100 offset:2048
ds_read_b64_tr_b16 v[58:59], v100 offset:2560
ds_read_b128 v[60:63], v176 offset:40960
v_mfma_f32_32x32x16_bf16 v[20:35], v[136:139], v[132:135], v[20:35]
ds_read_b128 v[64:67], v176 offset:43008
ds_read_b64_tr_b16 v[68:69], v100 offset:4096
ds_read_b64_tr_b16 v[70:71], v100 offset:4608
v_mfma_f32_32x32x16_bf16 v[4:19], v[148:151], v[140:143], v[4:19]
ds_read_b128 v[72:75], v177 offset:40960
ds_read_b128 v[76:79], v177 offset:43008
ds_read_b64_tr_b16 v[80:81], v100 offset:6144
v_mfma_f32_32x32x16_bf16 v[20:35], v[148:151], v[144:147], v[20:35]
ds_read_b64_tr_b16 v[82:83], v100 offset:6656
L_concat_heads__ssm_conv_h3__softmax_full_mha__prompt_kernel_chk13:
s_bfe_u32 s53, s43, 262164
s_cmp_eq_u32 s53, 15
s_cbranch_scc1 L_concat_heads__ssm_conv_h3__softmax_full_mha__prompt_kernel_ok13
global_load_dword v197, v104, s[40:41] sc1
s_waitcnt vmcnt(0)
v_cmp_eq_u32 s[42:43], s100, v197
s_add_u32 s46, s46, 1
s_cmp_lt_u32 s46, 0x400000
s_cbranch_scc1 L_concat_heads__ssm_conv_h3__softmax_full_mha__prompt_kernel_chk13
L_concat_heads__ssm_conv_h3__softmax_full_mha__prompt_kernel_ok13:
s_add_u32 m0, s47, 16384
s_nop 0
buffer_load_dwordx4 v180, s[24:27], s48 offen offset:0 lds
s_add_u32 m0, s47, 16384
s_nop 0
buffer_load_dwordx4 v180, s[24:27], s48 offen offset:1024 lds
s_add_u32 m0, s47, 24576
s_nop 0
buffer_load_dwordx4 v181, s[24:27], s48 offen offset:0 lds
v_mfma_f32_32x32x16_bf16 v[4:19], v[160:163], v[152:155], v[4:19]
s_add_u32 m0, s47, 24576
s_nop 0
buffer_load_dwordx4 v181, s[24:27], s48 offen offset:1024 lds
s_add_u32 s48, s48, 262144
s_and_b32 s48, s48, 4194303
v_mfma_f32_32x32x16_bf16 v[20:35], v[160:163], v[156:159], v[20:35]
s_waitcnt lgkmcnt(0)
s_waitcnt vmcnt(8)
s_barrier
v_mfma_f32_32x32x16_bf16 v[4:19], v[44:47], v[36:39], v[4:19]
ds_read_b128 v[116:119], v176 offset:49152
ds_read_b128 v[120:123], v176 offset:51200
ds_read_b64_tr_b16 v[124:125], v100 offset:8192
v_mfma_f32_32x32x16_bf16 v[20:35], v[44:47], v[40:43], v[20:35]
ds_read_b64_tr_b16 v[126:127], v100 offset:8704
ds_read_b128 v[128:131], v177 offset:49152
ds_read_b128 v[132:135], v177 offset:51200
v_mfma_f32_32x32x16_bf16 v[4:19], v[56:59], v[48:51], v[4:19]
ds_read_b64_tr_b16 v[136:137], v100 offset:10240
ds_read_b64_tr_b16 v[138:139], v100 offset:10752
ds_read_b128 v[140:143], v176 offset:57344
v_mfma_f32_32x32x16_bf16 v[20:35], v[56:59], v[52:55], v[20:35]
ds_read_b128 v[144:147], v176 offset:59392
ds_read_b64_tr_b16 v[148:149], v100 offset:12288
ds_read_b64_tr_b16 v[150:151], v100 offset:12800
v_mfma_f32_32x32x16_bf16 v[4:19], v[68:71], v[60:63], v[4:19]
ds_read_b128 v[152:155], v177 offset:57344
ds_read_b128 v[156:159], v177 offset:59392
ds_read_b64_tr_b16 v[160:161], v100 offset:14336
v_mfma_f32_32x32x16_bf16 v[20:35], v[68:71], v[64:67], v[20:35]
ds_read_b64_tr_b16 v[162:163], v100 offset:14848
L_concat_heads__ssm_conv_h3__softmax_full_mha__prompt_kernel_chk14:
s_bfe_u32 s53, s43, 262168
s_cmp_eq_u32 s53, 15
s_cbranch_scc1 L_concat_heads__ssm_conv_h3__softmax_full_mha__prompt_kernel_ok14
global_load_dword v197, v104, s[40:41] sc1
s_waitcnt vmcnt(0)
v_cmp_eq_u32 s[42:43], s100, v197
s_add_u32 s46, s46, 1
s_cmp_lt_u32 s46, 0x400000
s_cbranch_scc1 L_concat_heads__ssm_conv_h3__softmax_full_mha__prompt_kernel_chk14
L_concat_heads__ssm_conv_h3__softmax_full_mha__prompt_kernel_ok14:
s_add_u32 m0, s47, 32768
s_nop 0
buffer_load_dwordx4 v180, s[24:27], s48 offen offset:0 lds
s_add_u32 m0, s47, 32768
s_nop 0
buffer_load_dwordx4 v180, s[24:27], s48 offen offset:1024 lds
s_add_u32 m0, s47, 40960
s_nop 0
buffer_load_dwordx4 v181, s[24:27], s48 offen offset:0 lds
v_mfma_f32_32x32x16_bf16 v[4:19], v[80:83], v[72:75], v[4:19]
s_add_u32 m0, s47, 40960
s_nop 0
buffer_load_dwordx4 v181, s[24:27], s48 offen offset:1024 lds
s_add_u32 s48, s48, 262144
s_and_b32 s48, s48, 4194303
v_mfma_f32_32x32x16_bf16 v[20:35], v[80:83], v[76:79], v[20:35]
s_waitcnt lgkmcnt(0)
s_waitcnt vmcnt(8)
s_barrier
v_mfma_f32_32x32x16_bf16 v[4:19], v[124:127], v[116:119], v[4:19]
ds_read_b128 v[36:39], v176 offset:0
ds_read_b128 v[40:43], v176 offset:2048
ds_read_b64_tr_b16 v[44:45], v100 offset:16384
v_mfma_f32_32x32x16_bf16 v[20:35], v[124:127], v[120:123], v[20:35]
ds_read_b64_tr_b16 v[46:47], v100 offset:16896
ds_read_b128 v[48:51], v177 offset:0
ds_read_b128 v[52:55], v177 offset:2048
v_mfma_f32_32x32x16_bf16 v[4:19], v[136:139], v[128:131], v[4:19]
ds_read_b64_tr_b16 v[56:57], v100 offset:18432
ds_read_b64_tr_b16 v[58:59], v100 offset:18944
ds_read_b128 v[60:63], v176 offset:8192
v_mfma_f32_32x32x16_bf16 v[20:35], v[136:139], v[132:135], v[20:35]
ds_read_b128 v[64:67], v176 offset:10240
ds_read_b64_tr_b16 v[68:69], v100 offset:20480
ds_read_b64_tr_b16 v[70:71], v100 offset:20992
v_mfma_f32_32x32x16_bf16 v[4:19], v[148:151], v[140:143], v[4:19]
ds_read_b128 v[72:75], v177 offset:8192
ds_read_b128 v[76:79], v177 offset:10240
ds_read_b64_tr_b16 v[80:81], v100 offset:22528
v_mfma_f32_32x32x16_bf16 v[20:35], v[148:151], v[144:147], v[20:35]
ds_read_b64_tr_b16 v[82:83], v100 offset:23040
L_concat_heads__ssm_conv_h3__softmax_full_mha__prompt_kernel_chk15:
s_bfe_u32 s53, s43, 262172
s_cmp_eq_u32 s53, 15
s_cbranch_scc1 L_concat_heads__ssm_conv_h3__softmax_full_mha__prompt_kernel_ok15
global_load_dword v197, v104, s[40:41] sc1
s_waitcnt vmcnt(0)
v_cmp_eq_u32 s[42:43], s100, v197
s_add_u32 s46, s46, 1
s_cmp_lt_u32 s46, 0x400000
s_cbranch_scc1 L_concat_heads__ssm_conv_h3__softmax_full_mha__prompt_kernel_chk15
L_concat_heads__ssm_conv_h3__softmax_full_mha__prompt_kernel_ok15:
s_add_u32 m0, s47, 49152
s_nop 0
buffer_load_dwordx4 v180, s[24:27], s48 offen offset:0 lds
s_add_u32 m0, s47, 49152
s_nop 0
buffer_load_dwordx4 v180, s[24:27], s48 offen offset:1024 lds
s_add_u32 m0, s47, 57344
s_nop 0
buffer_load_dwordx4 v181, s[24:27], s48 offen offset:0 lds
v_mfma_f32_32x32x16_bf16 v[4:19], v[160:163], v[152:155], v[4:19]
s_add_u32 m0, s47, 57344
s_nop 0
buffer_load_dwordx4 v181, s[24:27], s48 offen offset:1024 lds
s_add_u32 s48, s48, 262144
s_and_b32 s48, s48, 4194303
v_mfma_f32_32x32x16_bf16 v[20:35], v[160:163], v[156:159], v[20:35]
s_waitcnt lgkmcnt(0)
s_waitcnt vmcnt(8)
s_barrier
v_mfma_f32_32x32x16_bf16 v[4:19], v[44:47], v[36:39], v[4:19]
ds_read_b128 v[116:119], v176 offset:16384
ds_read_b128 v[120:123], v176 offset:18432
ds_read_b64_tr_b16 v[124:125], v100 offset:24576
v_mfma_f32_32x32x16_bf16 v[20:35], v[44:47], v[40:43], v[20:35]
ds_read_b64_tr_b16 v[126:127], v100 offset:25088
ds_read_b128 v[128:131], v177 offset:16384
ds_read_b128 v[132:135], v177 offset:18432
v_mfma_f32_32x32x16_bf16 v[4:19], v[56:59], v[48:51], v[4:19]
ds_read_b64_tr_b16 v[136:137], v100 offset:26624
ds_read_b64_tr_b16 v[138:139], v100 offset:27136
ds_read_b128 v[140:143], v176 offset:24576
v_mfma_f32_32x32x16_bf16 v[20:35], v[56:59], v[52:55], v[20:35]
ds_read_b128 v[144:147], v176 offset:26624
ds_read_b64_tr_b16 v[148:149], v100 offset:28672
ds_read_b64_tr_b16 v[150:151], v100 offset:29184
v_mfma_f32_32x32x16_bf16 v[4:19], v[68:71], v[60:63], v[4:19]
ds_read_b128 v[152:155], v177 offset:24576
ds_read_b128 v[156:159], v177 offset:26624
ds_read_b64_tr_b16 v[160:161], v100 offset:30720
v_mfma_f32_32x32x16_bf16 v[20:35], v[68:71], v[64:67], v[20:35]
ds_read_b64_tr_b16 v[162:163], v100 offset:31232
v_mfma_f32_32x32x16_bf16 v[4:19], v[80:83], v[72:75], v[4:19]
v_mfma_f32_32x32x16_bf16 v[20:35], v[80:83], v[76:79], v[20:35]
s_waitcnt lgkmcnt(0)
s_waitcnt vmcnt(4)
s_barrier
v_mfma_f32_32x32x16_bf16 v[4:19], v[124:127], v[116:119], v[4:19]
ds_read_b128 v[36:39], v176 offset:32768
ds_read_b128 v[40:43], v176 offset:34816
ds_read_b64_tr_b16 v[44:45], v100 offset:32768
v_mfma_f32_32x32x16_bf16 v[20:35], v[124:127], v[120:123], v[20:35]
ds_read_b64_tr_b16 v[46:47], v100 offset:33280
ds_read_b128 v[48:51], v177 offset:32768
ds_read_b128 v[52:55], v177 offset:34816
v_mfma_f32_32x32x16_bf16 v[4:19], v[136:139], v[128:131], v[4:19]
ds_read_b64_tr_b16 v[56:57], v100 offset:34816
ds_read_b64_tr_b16 v[58:59], v100 offset:35328
ds_read_b128 v[60:63], v176 offset:40960
v_mfma_f32_32x32x16_bf16 v[20:35], v[136:139], v[132:135], v[20:35]
ds_read_b128 v[64:67], v176 offset:43008
ds_read_b64_tr_b16 v[68:69], v100 offset:36864
ds_read_b64_tr_b16 v[70:71], v100 offset:37376
v_mfma_f32_32x32x16_bf16 v[4:19], v[148:151], v[140:143], v[4:19]
ds_read_b128 v[72:75], v177 offset:40960
ds_read_b128 v[76:79], v177 offset:43008
ds_read_b64_tr_b16 v[80:81], v100 offset:38912
v_mfma_f32_32x32x16_bf16 v[20:35], v[148:151], v[144:147], v[20:35]
ds_read_b64_tr_b16 v[82:83], v100 offset:39424
v_mfma_f32_32x32x16_bf16 v[4:19], v[160:163], v[152:155], v[4:19]
v_mfma_f32_32x32x16_bf16 v[20:35], v[160:163], v[156:159], v[20:35]
s_waitcnt lgkmcnt(0)
s_waitcnt vmcnt(0)
s_barrier
v_mfma_f32_32x32x16_bf16 v[4:19], v[44:47], v[36:39], v[4:19]
ds_read_b128 v[116:119], v176 offset:49152
ds_read_b128 v[120:123], v176 offset:51200
ds_read_b64_tr_b16 v[124:125], v101 offset:0
v_mfma_f32_32x32x16_bf16 v[20:35], v[44:47], v[40:43], v[20:35]
ds_read_b64_tr_b16 v[126:127], v101 offset:512
ds_read_b128 v[128:131], v177 offset:49152
ds_read_b128 v[132:135], v177 offset:51200
v_mfma_f32_32x32x16_bf16 v[4:19], v[56:59], v[48:51], v[4:19]
ds_read_b64_tr_b16 v[136:137], v101 offset:2048
ds_read_b64_tr_b16 v[138:139], v101 offset:2560
ds_read_b128 v[140:143], v176 offset:57344
v_mfma_f32_32x32x16_bf16 v[20:35], v[56:59], v[52:55], v[20:35]
ds_read_b128 v[144:147], v176 offset:59392
ds_read_b64_tr_b16 v[148:149], v101 offset:4096
ds_read_b64_tr_b16 v[150:151], v101 offset:4608
v_mfma_f32_32x32x16_bf16 v[4:19], v[68:71], v[60:63], v[4:19]
ds_read_b128 v[152:155], v177 offset:57344
ds_read_b128 v[156:159], v177 offset:59392
ds_read_b64_tr_b16 v[160:161], v101 offset:6144
v_mfma_f32_32x32x16_bf16 v[20:35], v[68:71], v[64:67], v[20:35]
ds_read_b64_tr_b16 v[162:163], v101 offset:6656
v_mfma_f32_32x32x16_bf16 v[4:19], v[80:83], v[72:75], v[4:19]
v_mfma_f32_32x32x16_bf16 v[20:35], v[80:83], v[76:79], v[20:35]
s_waitcnt lgkmcnt(0)
v_mfma_f32_32x32x16_bf16 v[4:19], v[124:127], v[116:119], v[4:19]
v_mfma_f32_32x32x16_bf16 v[20:35], v[124:127], v[120:123], v[20:35]
v_mfma_f32_32x32x16_bf16 v[4:19], v[136:139], v[128:131], v[4:19]
v_mfma_f32_32x32x16_bf16 v[20:35], v[136:139], v[132:135], v[20:35]
v_mfma_f32_32x32x16_bf16 v[4:19], v[148:151], v[140:143], v[4:19]
v_mfma_f32_32x32x16_bf16 v[20:35], v[148:151], v[144:147], v[20:35]
v_mfma_f32_32x32x16_bf16 v[4:19], v[160:163], v[152:155], v[4:19]
v_mfma_f32_32x32x16_bf16 v[20:35], v[160:163], v[156:159], v[20:35]
s_lshl_b32 s46, s44, 1
s_add_u32 s46, s46, s51
s_lshl_b32 s46, s46, 18
s_lshl_b32 s47, s45, 1
s_add_u32 s47, s47, s52
s_lshl_b32 s47, s47, 6
s_add_u32 s46, s46, s47
s_add_u32 s46, s46, 2048
v_and_b32 v192, 31, v191
v_lshrrev_b32 v193, 5, v191
v_lshlrev_b32 v193, 4, v193
v_lshl_add_u32 v194, v192, 12, v193
v_add_u32 v194, s46, v194
v_add_u32 v195, 131072, v194
v_cvt_pk_bf16_f32 v4, v4, v5
v_cvt_pk_bf16_f32 v5, v6, v7
v_cvt_pk_bf16_f32 v6, v8, v9
v_cvt_pk_bf16_f32 v7, v10, v11
v_cvt_pk_bf16_f32 v8, v12, v13
v_cvt_pk_bf16_f32 v9, v14, v15
v_cvt_pk_bf16_f32 v10, v16, v17
v_cvt_pk_bf16_f32 v11, v18, v19
v_permlane32_swap_b32 v4, v6
v_permlane32_swap_b32 v5, v7
v_permlane32_swap_b32 v8, v10
v_permlane32_swap_b32 v9, v11
buffer_store_dwordx4 v[4:7], v194, s[32:35], 0 offen offset:0
buffer_store_dwordx4 v[8:11], v194, s[32:35], 0 offen offset:32
v_cvt_pk_bf16_f32 v20, v20, v21
v_cvt_pk_bf16_f32 v21, v22, v23
v_cvt_pk_bf16_f32 v22, v24, v25
v_cvt_pk_bf16_f32 v23, v26, v27
v_cvt_pk_bf16_f32 v24, v28, v29
v_cvt_pk_bf16_f32 v25, v30, v31
v_cvt_pk_bf16_f32 v26, v32, v33
v_cvt_pk_bf16_f32 v27, v34, v35
v_permlane32_swap_b32 v20, v22
v_permlane32_swap_b32 v21, v23
v_permlane32_swap_b32 v24, v26
v_permlane32_swap_b32 v25, v27
buffer_store_dwordx4 v[20:23], v195, s[32:35], 0 offen offset:0
buffer_store_dwordx4 v[24:27], v195, s[32:35], 0 offen offset:32
L_concat_heads__ssm_conv_h3__softmax_full_mha__prompt_kernel_end:
s_endpgm
L_concat_heads__ssm_conv_h3__softmax_full_mha__prompt_kernel_stub0:
s_mov_b32 s22, 0
s_branch L_concat_heads__ssm_conv_h3__softmax_full_mha__prompt_kernel_resc
L_concat_heads__ssm_conv_h3__softmax_full_mha__prompt_kernel_stub1:
s_mov_b32 s22, 1
s_branch L_concat_heads__ssm_conv_h3__softmax_full_mha__prompt_kernel_resc
L_concat_heads__ssm_conv_h3__softmax_full_mha__prompt_kernel_stub2:
s_mov_b32 s22, 2
s_branch L_concat_heads__ssm_conv_h3__softmax_full_mha__prompt_kernel_resc
L_concat_heads__ssm_conv_h3__softmax_full_mha__prompt_kernel_stub3:
s_mov_b32 s22, 3
s_branch L_concat_heads__ssm_conv_h3__softmax_full_mha__prompt_kernel_resc
L_concat_heads__ssm_conv_h3__softmax_full_mha__prompt_kernel_resc:
s_nop 15
v_mov_b32 v195, v164
v_mov_b32 v194, v164
s_nop 1
v_permlane32_swap_b32 v195, v194
v_max_f32 v195, v195, v194
v_frexp_exp_i32_f32 v195, v195
v_max_i32 v195, 0, v195
v_cvt_f32_i32 v196, v195
v_sub_u32 v195, 0, v195
v_ldexp_f32 v36, v36, v195
v_ldexp_f32 v37, v37, v195
v_ldexp_f32 v38, v38, v195
v_ldexp_f32 v39, v39, v195
v_ldexp_f32 v40, v40, v195
v_ldexp_f32 v41, v41, v195
v_ldexp_f32 v42, v42, v195
v_ldexp_f32 v43, v43, v195
v_ldexp_f32 v44, v44, v195
v_ldexp_f32 v45, v45, v195
v_ldexp_f32 v46, v46, v195
v_ldexp_f32 v47, v47, v195
v_ldexp_f32 v48, v48, v195
v_ldexp_f32 v49, v49, v195
v_ldexp_f32 v50, v50, v195
v_ldexp_f32 v51, v51, v195
v_ldexp_f32 v164, v164, v195
v_sub_f32 v68, v68, v196
v_sub_f32 v69, v69, v196
v_sub_f32 v70, v70, v196
v_sub_f32 v71, v71, v196
v_sub_f32 v72, v72, v196
v_sub_f32 v73, v73, v196
v_sub_f32 v74, v74, v196
v_sub_f32 v75, v75, v196
v_sub_f32 v76, v76, v196
v_sub_f32 v77, v77, v196
v_sub_f32 v78, v78, v196
v_sub_f32 v79, v79, v196
v_sub_f32 v80, v80, v196
v_sub_f32 v81, v81, v196
v_sub_f32 v82, v82, v196
v_sub_f32 v83, v83, v196
v_sub_f32 v4, v4, v196
v_sub_f32 v5, v5, v196
v_sub_f32 v6, v6, v196
v_sub_f32 v7, v7, v196
v_sub_f32 v8, v8, v196
v_sub_f32 v9, v9, v196
v_sub_f32 v10, v10, v196
v_sub_f32 v11, v11, v196
v_sub_f32 v12, v12, v196
v_sub_f32 v13, v13, v196
v_sub_f32 v14, v14, v196
v_sub_f32 v15, v15, v196
v_sub_f32 v16, v16, v196
v_sub_f32 v17, v17, v196
v_sub_f32 v18, v18, v196
v_sub_f32 v19, v19, v196
v_mov_b32 v195, v168
v_mov_b32 v194, v168
s_nop 1
v_permlane32_swap_b32 v195, v194
v_max_f32 v195, v195, v194
v_frexp_exp_i32_f32 v195, v195
v_max_i32 v195, 0, v195
v_cvt_f32_i32 v196, v195
v_sub_u32 v195, 0, v195
v_ldexp_f32 v52, v52, v195
v_ldexp_f32 v53, v53, v195
v_ldexp_f32 v54, v54, v195
v_ldexp_f32 v55, v55, v195
v_ldexp_f32 v56, v56, v195
v_ldexp_f32 v57, v57, v195
v_ldexp_f32 v58, v58, v195
v_ldexp_f32 v59, v59, v195
v_ldexp_f32 v60, v60, v195
v_ldexp_f32 v61, v61, v195
v_ldexp_f32 v62, v62, v195
v_ldexp_f32 v63, v63, v195
v_ldexp_f32 v64, v64, v195
v_ldexp_f32 v65, v65, v195
v_ldexp_f32 v66, v66, v195
v_ldexp_f32 v67, v67, v195
v_ldexp_f32 v168, v168, v195
v_sub_f32 v84, v84, v196
v_sub_f32 v85, v85, v196
v_sub_f32 v86, v86, v196
v_sub_f32 v87, v87, v196
v_sub_f32 v88, v88, v196
v_sub_f32 v89, v89, v196
v_sub_f32 v90, v90, v196
v_sub_f32 v91, v91, v196
v_sub_f32 v92, v92, v196
v_sub_f32 v93, v93, v196
v_sub_f32 v94, v94, v196
v_sub_f32 v95, v95, v196
v_sub_f32 v96, v96, v196
v_sub_f32 v97, v97, v196
v_sub_f32 v98, v98, v196
v_sub_f32 v99, v99, v196
v_lshlrev_b32 v194, 16, v108
v_and_b32 v197, 0xffff0000, v108
v_ldexp_f32 v194, v194, v195
v_ldexp_f32 v197, v197, v195
v_cvt_pk_bf16_f32 v108, v194, v197
v_lshlrev_b32 v194, 16, v109
v_and_b32 v197, 0xffff0000, v109
v_ldexp_f32 v194, v194, v195
v_ldexp_f32 v197, v197, v195
v_cvt_pk_bf16_f32 v109, v194, v197
v_lshlrev_b32 v194, 16, v110
v_and_b32 v197, 0xffff0000, v110
v_ldexp_f32 v194, v194, v195
v_ldexp_f32 v197, v197, v195
v_cvt_pk_bf16_f32 v110, v194, v197
v_lshlrev_b32 v194, 16, v111
v_and_b32 v197, 0xffff0000, v111
v_ldexp_f32 v194, v194, v195
v_ldexp_f32 v197, v197, v195
v_cvt_pk_bf16_f32 v111, v194, v197
v_lshlrev_b32 v194, 16, v112
v_and_b32 v197, 0xffff0000, v112
v_ldexp_f32 v194, v194, v195
v_ldexp_f32 v197, v197, v195
v_cvt_pk_bf16_f32 v112, v194, v197
v_lshlrev_b32 v194, 16, v113
v_and_b32 v197, 0xffff0000, v113
v_ldexp_f32 v194, v194, v195
v_ldexp_f32 v197, v197, v195
v_cvt_pk_bf16_f32 v113, v194, v197
v_lshlrev_b32 v194, 16, v114
v_and_b32 v197, 0xffff0000, v114
v_ldexp_f32 v194, v194, v195
v_ldexp_f32 v197, v197, v195
v_cvt_pk_bf16_f32 v114, v194, v197
v_lshlrev_b32 v194, 16, v115
v_and_b32 v197, 0xffff0000, v115
v_ldexp_f32 v194, v194, v195
v_ldexp_f32 v197, v197, v195
v_cvt_pk_bf16_f32 v115, v194, v197
s_nop 3
s_cmp_eq_u32 s22, 0
s_cbranch_scc1 L_concat_heads__ssm_conv_h3__softmax_full_mha__prompt_kernel_back0
s_cmp_eq_u32 s22, 1
s_cbranch_scc1 L_concat_heads__ssm_conv_h3__softmax_full_mha__prompt_kernel_back1
s_cmp_eq_u32 s22, 2
s_cbranch_scc1 L_concat_heads__ssm_conv_h3__softmax_full_mha__prompt_kernel_back2
s_branch L_concat_heads__ssm_conv_h3__softmax_full_mha__prompt_kernel_back3
L_concat_heads__ssm_conv_h3__softmax_full_mha__prompt_kernel_safe:
s_waitcnt vmcnt(0) lgkmcnt(0)
s_nop 15
v_mov_b32 v36, 0
v_mov_b32 v37, 0
v_mov_b32 v38, 0
v_mov_b32 v39, 0
v_mov_b32 v40, 0
v_mov_b32 v41, 0
v_mov_b32 v42, 0
v_mov_b32 v43, 0
v_mov_b32 v44, 0
v_mov_b32 v45, 0
v_mov_b32 v46, 0
v_mov_b32 v47, 0
v_mov_b32 v48, 0
v_mov_b32 v49, 0
v_mov_b32 v50, 0
v_mov_b32 v51, 0
v_mov_b32 v164, 0
v_mov_b32 v165, 0
v_mov_b32 v166, 0
v_mov_b32 v167, 0
v_mov_b32 v68, 0xff7fffff
v_mov_b32 v52, 0
v_mov_b32 v53, 0
v_mov_b32 v54, 0
v_mov_b32 v55, 0
v_mov_b32 v56, 0
v_mov_b32 v57, 0
v_mov_b32 v58, 0
v_mov_b32 v59, 0
v_mov_b32 v60, 0
v_mov_b32 v61, 0
v_mov_b32 v62, 0
v_mov_b32 v63, 0
v_mov_b32 v64, 0
v_mov_b32 v65, 0
v_mov_b32 v66, 0
v_mov_b32 v67, 0
v_mov_b32 v168, 0
v_mov_b32 v169, 0
v_mov_b32 v170, 0
v_mov_b32 v171, 0
v_mov_b32 v84, 0xff7fffff
s_mov_b32 s17, s21
s_mov_b32 s19, 0
L_concat_heads__ssm_conv_h3__softmax_full_mha__prompt_kernel_safeloop:
buffer_load_dwordx4 v[132:135], v189, s[8:11], s17 offen offset:0
buffer_load_dwordx4 v[136:139], v189, s[8:11], s17 offen offset:32
buffer_load_dwordx4 v[148:151], v190, s[8:11], s17 offen offset:0
buffer_load_dwordx4 v[152:155], v190, s[8:11], s17 offen offset:32
s_waitcnt vmcnt(0)
v_mfma_f32_32x32x16_bf16 v[4:19], v[132:135], v[116:119], 0
v_mfma_f32_32x32x16_bf16 v[4:19], v[136:139], v[120:123], v[4:19]
s_nop 11
v_max3_f32 v195, v4, v5, v6
v_max3_f32 v195, v195, v7, v8
v_max3_f32 v195, v195, v9, v10
v_max3_f32 v195, v195, v11, v12
v_max3_f32 v195, v195, v13, v14
v_max3_f32 v195, v195, v15, v16
v_max3_f32 v195, v195, v17, v18
v_max_f32 v195, v195, v19
v_mov_b32 v194, v195
s_nop 1
v_permlane32_swap_b32 v195, v194
v_max_f32 v195, v195, v194
v_max_f32 v195, v195, v68
v_sub_f32 v196, v68, v195
v_exp_f32 v196, v196
v_mov_b32 v68, v195
v_sub_f32 v4, v4, v195
v_sub_f32 v5, v5, v195
v_sub_f32 v6, v6, v195
v_sub_f32 v7, v7, v195
v_sub_f32 v8, v8, v195
v_sub_f32 v9, v9, v195
v_sub_f32 v10, v10, v195
v_sub_f32 v11, v11, v195
v_sub_f32 v12, v12, v195
v_sub_f32 v13, v13, v195
v_sub_f32 v14, v14, v195
v_sub_f32 v15, v15, v195
v_sub_f32 v16, v16, v195
v_sub_f32 v17, v17, v195
v_sub_f32 v18, v18, v195
v_sub_f32 v19, v19, v195
v_mul_f32 v36, v36, v196
v_mul_f32 v37, v37, v196
v_mul_f32 v38, v38, v196
v_mul_f32 v39, v39, v196
v_mul_f32 v40, v40, v196
v_mul_f32 v41, v41, v196
v_mul_f32 v42, v42, v196
v_mul_f32 v43, v43, v196
v_mul_f32 v44, v44, v196
v_mul_f32 v45, v45, v196
v_mul_f32 v46, v46, v196
v_mul_f32 v47, v47, v196
v_mul_f32 v48, v48, v196
v_mul_f32 v49, v49, v196
v_mul_f32 v50, v50, v196
v_mul_f32 v51, v51, v196
v_mul_f32 v164, v164, v196
v_exp_f32 v176, v4
v_exp_f32 v177, v5
v_exp_f32 v178, v6
v_exp_f32 v179, v7
v_cvt_pk_bf16_f32 v100, v176, v177
v_cvt_pk_bf16_f32 v101, v178, v179
v_exp_f32 v180, v8
v_exp_f32 v181, v9
v_exp_f32 v182, v10
v_exp_f32 v183, v11
v_cvt_pk_bf16_f32 v102, v180, v181
v_cvt_pk_bf16_f32 v103, v182, v183
s_nop 1
v_mfma_f32_16x16x32_bf16 v[164:167], v[172:175], v[100:103], v[164:167]
v_exp_f32 v176, v12
v_exp_f32 v177, v13
v_exp_f32 v178, v14
v_exp_f32 v179, v15
v_cvt_pk_bf16_f32 v104, v176, v177
v_cvt_pk_bf16_f32 v105, v178, v179
v_exp_f32 v180, v16
v_exp_f32 v181, v17
v_exp_f32 v182, v18
v_exp_f32 v183, v19
v_cvt_pk_bf16_f32 v106, v180, v181
v_cvt_pk_bf16_f32 v107, v182, v183
s_nop 1
v_mfma_f32_16x16x32_bf16 v[164:167], v[172:175], v[104:107], v[164:167]
v_mfma_f32_32x32x16_bf16 v[36:51], v[148:151], v[100:103], v[36:51]
v_mfma_f32_32x32x16_bf16 v[36:51], v[152:155], v[104:107], v[36:51]
v_mfma_f32_32x32x16_bf16 v[20:35], v[132:135], v[124:127], 0
v_mfma_f32_32x32x16_bf16 v[20:35], v[136:139], v[128:131], v[20:35]
s_nop 11
v_max3_f32 v195, v20, v21, v22
v_max3_f32 v195, v195, v23, v24
v_max3_f32 v195, v195, v25, v26
v_max3_f32 v195, v195, v27, v28
v_max3_f32 v195, v195, v29, v30
v_max3_f32 v195, v195, v31, v32
v_max3_f32 v195, v195, v33, v34
v_max_f32 v195, v195, v35
v_mov_b32 v194, v195
s_nop 1
v_permlane32_swap_b32 v195, v194
v_max_f32 v195, v195, v194
v_max_f32 v195, v195, v84
v_sub_f32 v196, v84, v195
v_exp_f32 v196, v196
v_mov_b32 v84, v195
v_sub_f32 v20, v20, v195
v_sub_f32 v21, v21, v195
v_sub_f32 v22, v22, v195
v_sub_f32 v23, v23, v195
v_sub_f32 v24, v24, v195
v_sub_f32 v25, v25, v195
v_sub_f32 v26, v26, v195
v_sub_f32 v27, v27, v195
v_sub_f32 v28, v28, v195
v_sub_f32 v29, v29, v195
v_sub_f32 v30, v30, v195
v_sub_f32 v31, v31, v195
v_sub_f32 v32, v32, v195
v_sub_f32 v33, v33, v195
v_sub_f32 v34, v34, v195
v_sub_f32 v35, v35, v195
v_mul_f32 v52, v52, v196
v_mul_f32 v53, v53, v196
v_mul_f32 v54, v54, v196
v_mul_f32 v55, v55, v196
v_mul_f32 v56, v56, v196
v_mul_f32 v57, v57, v196
v_mul_f32 v58, v58, v196
v_mul_f32 v59, v59, v196
v_mul_f32 v60, v60, v196
v_mul_f32 v61, v61, v196
v_mul_f32 v62, v62, v196
v_mul_f32 v63, v63, v196
v_mul_f32 v64, v64, v196
v_mul_f32 v65, v65, v196
v_mul_f32 v66, v66, v196
v_mul_f32 v67, v67, v196
v_mul_f32 v168, v168, v196
v_exp_f32 v176, v20
v_exp_f32 v177, v21
v_exp_f32 v178, v22
v_exp_f32 v179, v23
v_cvt_pk_bf16_f32 v108, v176, v177
v_cvt_pk_bf16_f32 v109, v178, v179
v_exp_f32 v180, v24
v_exp_f32 v181, v25
v_exp_f32 v182, v26
v_exp_f32 v183, v27
v_cvt_pk_bf16_f32 v110, v180, v181
v_cvt_pk_bf16_f32 v111, v182, v183
s_nop 1
v_mfma_f32_16x16x32_bf16 v[168:171], v[172:175], v[108:111], v[168:171]
v_exp_f32 v176, v28
v_exp_f32 v177, v29
v_exp_f32 v178, v30
v_exp_f32 v179, v31
v_cvt_pk_bf16_f32 v112, v176, v177
v_cvt_pk_bf16_f32 v113, v178, v179
v_exp_f32 v180, v32
v_exp_f32 v181, v33
v_exp_f32 v182, v34
v_exp_f32 v183, v35
v_cvt_pk_bf16_f32 v114, v180, v181
v_cvt_pk_bf16_f32 v115, v182, v183
s_nop 1
v_mfma_f32_16x16x32_bf16 v[168:171], v[172:175], v[112:115], v[168:171]
v_mfma_f32_32x32x16_bf16 v[52:67], v[148:151], v[108:111], v[52:67]
v_mfma_f32_32x32x16_bf16 v[52:67], v[152:155], v[112:115], v[52:67]
s_add_u32 s17, s17, 2048
s_add_u32 s19, s19, 1
s_cmp_lt_u32 s19, 64
s_cbranch_scc1 L_concat_heads__ssm_conv_h3__softmax_full_mha__prompt_kernel_safeloop
s_nop 15
s_branch L_concat_heads__ssm_conv_h3__softmax_full_mha__prompt_kernel_fin
L_concat_heads__ssm_conv_h3__softmax_full_mha__prompt_kernel_aux:
s_sub_u32 s3, s12, 4
s_setprio 2
s_load_dwordx4 s[48:51], s[0:1], 8
s_load_dwordx2 s[52:53], s[0:1], 24
s_load_dwordx2 s[54:55], s[0:1], 88
s_load_dwordx4 s[8:11], s[0:1], 32
s_load_dwordx2 s[12:13], s[0:1], 64
s_load_dwordx4 s[84:87], s[0:1], 72
s_load_dwordx2 s[14:15], s[0:1], 88
s_memrealtime s[16:17]
s_and_b32 s68, s2, 7
s_lshl_b32 s68, s68, 5
s_lshr_b32 s69, s2, 3
s_add_u32 s68, s68, s69
s_lshl_b32 s68, s68, 2
s_add_u32 s68, s68, s3
v_and_b32 v108, 63, v0
s_lshl_b32 s70, s68, 12
s_mul_i32 s73, s68, 4608
s_mul_i32 s72, s3, 10240
s_add_u32 s72, s72, 122880
s_mul_i32 s71, s3, 8704
s_add_u32 s71, s71, 65536
s_and_b32 s88, s2, 7
s_lshl_b32 s88, s88, 9
v_lshlrev_b32 v109, 4, v108
s_waitcnt lgkmcnt(0)
s_or_b32 s69, s2, s3
s_cmp_lg_u32 s69, 0
s_cbranch_scc1 L_concat_heads__ssm_conv_h3__softmax_full_mha__prompt_kernel_notok
s_or_b32 s16, s16, 1
v_mov_b32 v110, 0
v_mov_b32 v111, s16
s_mov_b64 exec, 1
global_store_dword v110, v111, s[86:87] sc1
s_mov_b64 exec, -1
s_waitcnt vmcnt(0)
L_concat_heads__ssm_conv_h3__softmax_full_mha__prompt_kernel_notok:
v_and_b32 v224, 63, v0
s_lshr_b32 s56, s2, 3
s_and_b32 s57, s2, 7
s_lshl_b32 s57, s57, 2
s_add_u32 s57, s57, s3
s_lshl_b32 s57, s57, 5
s_mul_i32 s60, s3, 10240
s_add_u32 s60, s60, 122880
s_mov_b32 s32, s48
s_and_b32 s33, s49, 0xffff
s_mov_b32 s34, 4194304
s_mov_b32 s35, 0x20000
s_mov_b32 s36, s50
s_and_b32 s37, s51, 0xffff
s_mov_b32 s38, 4194304
s_mov_b32 s39, 0x20000
s_mov_b32 s40, s52
s_and_b32 s41, s53, 0xffff
s_mov_b32 s42, 8192
s_mov_b32 s43, 0x20000
s_add_u32 s44, s54, 16777216
s_addc_u32 s45, s55, 0
s_and_b32 s45, s45, 0xffff
s_mov_b32 s46, 4718592
s_mov_b32 s47, 0x20000
s_lshl_b32 s58, s56, 17
s_lshl_b32 s59, s57, 1
s_add_u32 s58, s58, s59
s_sub_u32 s58, s58, 8192
v_and_b32 v226, 3, v224
v_lshrrev_b32 v227, 2, v224
v_lshl_add_u32 v225, v226, 4, s58
v_lshl_add_u32 v225, v227, 11, v225
v_and_b32 v226, 15, v224
v_lshrrev_b32 v227, 4, v224
v_lshlrev_b32 v233, 10, v227
v_lshl_add_u32 v233, v226, 2, v233
v_add_u32 v233, s60, v233
v_and_b32 v228, 7, v224
v_xor_b32 v228, v228, v227
v_lshrrev_b32 v231, 3, v224
v_lshlrev_b32 v231, 7, v231
v_lshl_add_u32 v231, v228, 4, v231
v_add_u32 v231, s60, v231
v_xor_b32 v232, 64, v231
v_lshlrev_b32 v227, 1, v227
v_sub_u32 v227, 6, v227
v_and_b32 v228, 7, v226
v_xor_b32 v227, v227, v228
v_lshlrev_b32 v229, 8, v226
v_lshl_add_u32 v229, v227, 4, v229
v_add_u32 v229, s60, v229
v_xor_b32 v230, 16, v229
v_lshrrev_b32 v227, 3, v224
v_add_u32 v227, s57, v227
v_mul_u32_u24 v228, 4608, v227
v_and_b32 v227, 7, v224
v_lshl_add_u32 v228, v227, 4, v228
s_sub_u32 s58, 31, s56
s_mul_i32 s58, s58, 144
v_add_u32 v228, s58, v228
v_lshl_add_u32 v226, v226, 1, s57
v_lshlrev_b32 v226, 3, v226
s_mov_b32 s59, 8192
s_mov_b64 s[20:21], s[8:9]
s_mov_b64 s[22:23], s[10:11]
s_mov_b64 s[28:29], s[12:13]
s_mov_b64 s[30:31], s[14:15]
s_mov_b32 s76, s30
s_and_b32 s77, s31, 0xffff
s_mov_b32 s78, 16777216
s_mov_b32 s79, 0x20000
s_add_u32 s84, s30, 41943040
s_addc_u32 s85, s31, 0
s_and_b32 s69, s68, 0xfffffffe
s_lshl_b32 s69, s69, 1
s_add_u32 s22, s22, s69
s_addc_u32 s23, s23, 0
s_load_dword s64, s[22:23], 0
s_add_u32 s8, s30, 16777216
s_addc_u32 s9, s31, 0
s_and_b32 s9, s9, 0xffff
s_mov_b32 s10, 4718592
s_mov_b32 s11, 0x20000
s_mov_b32 s12, s20
s_and_b32 s13, s21, 0xffff
s_mov_b32 s14, 4194304
s_mov_b32 s15, 0x20000
s_add_u32 s16, s30, 33554432
s_addc_u32 s17, s31, 0
s_and_b32 s17, s17, 0xffff
s_mov_b32 s18, 4194304
s_mov_b32 s19, 0x20000
s_mov_b32 s24, s28
s_and_b32 s25, s29, 0xffff
s_mov_b32 s26, 2097152
s_mov_b32 s27, 0x20000
s_barrier
s_and_b32 s80, s2, 7
s_lshl_b32 s80, s80, 2
s_lshr_b32 s81, s2, 6
s_add_u32 s80, s80, s81
s_mul_i32 s80, s80, 131072
s_add_u32 s81, s80, 8404992
s_add_u32 s80, s80, 4210688
s_lshl_b32 s82, s3, 11
s_and_b32 s89, s2, 7
s_lshl_b32 s89, s89, 2
s_lshr_b32 s90, s2, 6
s_add_u32 s89, s89, s90
s_lshl_b32 s89, s89, 7
s_add_u32 s89, s89, 12288
v_and_b32 v122, 31, v108
v_lshl_add_u32 v122, v122, 2, s89
s_mov_b32 s89, 0
s_mov_b32 s90, 0
v_lshrrev_b32 v110, 4, v108
v_and_b32 v112, 3, v108
v_xor_b32 v112, v112, v110
v_lshrrev_b32 v116, 2, v108
v_lshlrev_b32 v116, 6, v116
v_lshl_add_u32 v116, v112, 4, v116
v_add_u32 v116, s82, v116
v_add_u32 v116, 2048, v116
v_and_b32 v111, 31, v108
v_lshrrev_b32 v112, 5, v108
v_lshlrev_b32 v114, 2, v111
v_lshl_add_u32 v114, v112, 4, v114
v_bfe_u32 v110, v108, 4, 1
v_xor_b32 v110, 1, v110
v_mul_u32_u24 v117, 5120, v110
v_add_u32 v117, s72, v117
v_and_b32 v110, 15, v108
v_sub_u32 v110, 15, v110
v_mul_u32_u24 v113, 144, v110
v_lshl_add_u32 v113, v112, 4, v113
v_add_u32 v113, v113, v117
v_add_u32 v117, 4608, v117
v_and_b32 v110, 15, v108
v_mul_u32_u24 v115, 272, v110
v_lshl_add_u32 v115, v112, 5, v115
v_bfe_u32 v110, v108, 4, 1
v_lshl_add_u32 v115, v110, 2, v115
v_add_u32 v115, s71, v115
s_barrier
buffer_load_dwordx4 v[160:163], v226, s[40:43], 0 offen
v_add_u32 v227, 8192, v225
s_add_u32 m0, s60, 0
s_nop 0
buffer_load_dwordx4 v225, s[32:35], 0 offen lds
s_add_u32 m0, s60, 5120
s_nop 0
buffer_load_dwordx4 v227, s[36:39], 0 offen lds
s_barrier
v_add_u32 v225, 32768, v225
v_add_u32 v227, 32768, v227
s_add_u32 m0, s60, 1024
s_nop 0
buffer_load_dwordx4 v225, s[32:35], 0 offen lds
s_add_u32 m0, s60, 6144
s_nop 0
buffer_load_dwordx4 v227, s[36:39], 0 offen lds
v_add_u32 v225, 32768, v225
v_add_u32 v227, 32768, v227
s_add_u32 m0, s60, 2048
s_nop 0
buffer_load_dwordx4 v225, s[32:35], 0 offen lds
s_barrier
s_add_u32 m0, s60, 7168
s_nop 0
buffer_load_dwordx4 v227, s[36:39], 0 offen lds
v_add_u32 v225, 32768, v225
v_add_u32 v227, 32768, v227
s_add_u32 m0, s60, 3072
s_nop 0
buffer_load_dwordx4 v225, s[32:35], 0 offen lds
s_add_u32 m0, s60, 8192
s_nop 0
buffer_load_dwordx4 v227, s[36:39], 0 offen lds
s_barrier
v_add_u32 v225, 32768, v225
v_add_u32 v227, 32768, v227
s_add_u32 m0, s60, 4096
s_nop 0
buffer_load_dwordx4 v225, s[32:35], 0 offen lds
v_mov_b32 v4, 0
v_mov_b32 v5, 0
v_mov_b32 v6, 0
v_mov_b32 v7, 0
v_mov_b32 v8, 0
v_mov_b32 v9, 0
v_mov_b32 v10, 0
v_mov_b32 v11, 0
v_mov_b32 v12, 0
v_mov_b32 v13, 0
v_mov_b32 v14, 0
v_mov_b32 v15, 0
v_mov_b32 v16, 0
v_mov_b32 v17, 0
v_mov_b32 v18, 0
v_mov_b32 v19, 0
v_mov_b32 v20, 0
v_mov_b32 v21, 0
v_mov_b32 v22, 0
v_mov_b32 v23, 0
v_mov_b32 v24, 0
v_mov_b32 v25, 0
v_mov_b32 v26, 0
v_mov_b32 v27, 0
v_mov_b32 v28, 0
v_mov_b32 v29, 0
v_mov_b32 v30, 0
v_mov_b32 v31, 0
v_mov_b32 v32, 0
v_mov_b32 v33, 0
v_mov_b32 v34, 0
v_mov_b32 v35, 0
s_barrier
s_barrier
s_waitcnt vmcnt(0) lgkmcnt(0)
buffer_load_dwordx4 v[92:95], v109, s[12:15], s70 offen offset:0
buffer_load_dwordx4 v[96:99], v109, s[12:15], s70 offen offset:1024
buffer_load_dwordx4 v[100:103], v109, s[12:15], s70 offen offset:2048
buffer_load_dwordx4 v[104:107], v109, s[12:15], s70 offen offset:3072
ds_read_b32 v124, v233 offset:64
ds_read_b32 v125, v233 offset:128
ds_read_b32 v126, v233 offset:192
ds_read_b32 v127, v233 offset:256
ds_read_b32 v128, v233 offset:320
ds_read_b32 v129, v233 offset:384
ds_read_b32 v130, v233 offset:448
ds_read_b32 v131, v233 offset:512
ds_read_b32 v132, v233 offset:576
ds_read_b32 v133, v233 offset:640
ds_read_b32 v134, v233 offset:704
ds_read_b32 v135, v233 offset:768
ds_read_b32 v136, v233 offset:832
ds_read_b32 v137, v233 offset:896
ds_read_b32 v138, v233 offset:960
ds_read_b32 v139, v233 offset:1024
ds_read_b32 v140, v233 offset:1088
ds_read_b32 v141, v233 offset:1152
ds_read_b32 v142, v233 offset:1216
ds_read_b32 v143, v233 offset:5120
ds_read_b32 v144, v233 offset:5184
ds_read_b32 v145, v233 offset:5248
ds_read_b32 v146, v233 offset:5312
ds_read_b32 v147, v233 offset:5376
ds_read_b32 v148, v233 offset:5440
ds_read_b32 v149, v233 offset:5504
ds_read_b32 v150, v233 offset:5568
ds_read_b32 v151, v233 offset:5632
ds_read_b32 v152, v233 offset:5696
ds_read_b32 v153, v233 offset:5760
ds_read_b32 v154, v233 offset:5824
ds_read_b32 v155, v233 offset:5888
ds_read_b32 v156, v233 offset:5952
ds_read_b32 v157, v233 offset:6016
ds_read_b32 v158, v233 offset:6080
v_lshlrev_b32 v164, 16, v160
v_and_b32 v165, 0xffff0000, v160
v_lshlrev_b32 v166, 16, v161
v_and_b32 v167, 0xffff0000, v161
v_lshlrev_b32 v168, 16, v162
v_and_b32 v169, 0xffff0000, v162
v_lshlrev_b32 v170, 16, v163
v_and_b32 v171, 0xffff0000, v163
s_waitcnt lgkmcnt(0)
v_lshlrev_b32 v172, 16, v124
v_lshlrev_b32 v173, 16, v125
v_lshlrev_b32 v174, 16, v126
v_lshlrev_b32 v175, 16, v127
v_lshlrev_b32 v176, 16, v128
v_lshlrev_b32 v177, 16, v129
v_lshlrev_b32 v178, 16, v130
v_lshlrev_b32 v179, 16, v131
v_lshlrev_b32 v180, 16, v132
v_lshlrev_b32 v181, 16, v133
v_lshlrev_b32 v182, 16, v134
v_lshlrev_b32 v183, 16, v135
v_lshlrev_b32 v184, 16, v136
v_lshlrev_b32 v185, 16, v137
v_lshlrev_b32 v186, 16, v138
v_lshlrev_b32 v187, 16, v139
v_lshlrev_b32 v188, 16, v140
v_lshlrev_b32 v189, 16, v141
v_lshlrev_b32 v190, 16, v142
v_mul_f32 v191, v167, v172
v_mul_f32 v192, v167, v173
v_mul_f32 v193, v167, v174
v_mul_f32 v194, v167, v175
v_mul_f32 v195, v167, v176
v_mul_f32 v196, v167, v177
v_mul_f32 v197, v167, v178
v_mul_f32 v198, v167, v179
v_mul_f32 v199, v167, v180
v_mul_f32 v200, v167, v181
v_mul_f32 v201, v167, v182
v_mul_f32 v202, v167, v183
s_barrier
v_mul_f32 v203, v167, v184
v_mul_f32 v204, v167, v185
v_mul_f32 v205, v167, v186
v_mul_f32 v206, v167, v187
v_fmac_f32 v191, v166, v173
v_fmac_f32 v192, v166, v174
v_fmac_f32 v193, v166, v175
v_fmac_f32 v194, v166, v176
v_fmac_f32 v195, v166, v177
v_fmac_f32 v196, v166, v178
v_fmac_f32 v197, v166, v179
v_fmac_f32 v198, v166, v180
v_fmac_f32 v199, v166, v181
v_fmac_f32 v200, v166, v182
v_fmac_f32 v201, v166, v183
v_fmac_f32 v202, v166, v184
v_fmac_f32 v203, v166, v185
v_fmac_f32 v204, v166, v186
v_fmac_f32 v205, v166, v187
v_fmac_f32 v206, v166, v188
v_fmac_f32 v191, v165, v174
v_fmac_f32 v192, v165, v175
v_fmac_f32 v193, v165, v176
v_fmac_f32 v194, v165, v177
v_fmac_f32 v195, v165, v178
v_fmac_f32 v196, v165, v179
v_fmac_f32 v197, v165, v180
v_fmac_f32 v198, v165, v181
v_fmac_f32 v199, v165, v182
v_fmac_f32 v200, v165, v183
v_fmac_f32 v201, v165, v184
v_fmac_f32 v202, v165, v185
v_fmac_f32 v203, v165, v186
v_fmac_f32 v204, v165, v187
v_fmac_f32 v205, v165, v188
v_fmac_f32 v206, v165, v189
v_fmac_f32 v191, v164, v175
v_fmac_f32 v192, v164, v176
v_fmac_f32 v193, v164, v177
v_fmac_f32 v194, v164, v178
v_fmac_f32 v195, v164, v179
v_fmac_f32 v196, v164, v180
v_fmac_f32 v197, v164, v181
v_fmac_f32 v198, v164, v182
v_fmac_f32 v199, v164, v183
v_fmac_f32 v200, v164, v184
v_fmac_f32 v201, v164, v185
v_fmac_f32 v202, v164, v186
v_fmac_f32 v203, v164, v187
v_fmac_f32 v204, v164, v188
v_fmac_f32 v205, v164, v189
v_fmac_f32 v206, v164, v190
v_lshlrev_b32 v172, 16, v143
v_lshlrev_b32 v173, 16, v144
v_lshlrev_b32 v174, 16, v145
v_lshlrev_b32 v175, 16, v146
v_lshlrev_b32 v176, 16, v147
v_lshlrev_b32 v177, 16, v148
v_lshlrev_b32 v178, 16, v149
v_lshlrev_b32 v179, 16, v150
v_lshlrev_b32 v180, 16, v151
v_lshlrev_b32 v181, 16, v152
v_lshlrev_b32 v182, 16, v153
v_lshlrev_b32 v183, 16, v154
v_lshlrev_b32 v184, 16, v155
v_lshlrev_b32 v185, 16, v156
v_lshlrev_b32 v186, 16, v157
v_lshlrev_b32 v187, 16, v158
v_mul_f32 v191, v191, v172
v_mul_f32 v192, v192, v173
v_mul_f32 v193, v193, v174
v_mul_f32 v194, v194, v175
v_mul_f32 v195, v195, v176
v_mul_f32 v196, v196, v177
v_mul_f32 v197, v197, v178
s_barrier
v_mul_f32 v198, v198, v179
v_mul_f32 v199, v199, v180
v_mul_f32 v200, v200, v181
v_mul_f32 v201, v201, v182
v_mul_f32 v202, v202, v183
v_mul_f32 v203, v203, v184
v_mul_f32 v204, v204, v185
v_mul_f32 v205, v205, v186
v_mul_f32 v206, v206, v187
v_cvt_pk_bf16_f32 v208, v206, v205
v_cvt_pk_bf16_f32 v209, v204, v203
v_cvt_pk_bf16_f32 v210, v202, v201
v_cvt_pk_bf16_f32 v211, v200, v199
v_cvt_pk_bf16_f32 v212, v198, v197
v_cvt_pk_bf16_f32 v213, v196, v195
v_cvt_pk_bf16_f32 v214, v194, v193
v_cvt_pk_bf16_f32 v215, v192, v191
v_and_b32 v172, 0xffff0000, v124
v_and_b32 v173, 0xffff0000, v125
v_and_b32 v174, 0xffff0000, v126
v_and_b32 v175, 0xffff0000, v127
v_and_b32 v176, 0xffff0000, v128
v_and_b32 v177, 0xffff0000, v129
v_and_b32 v178, 0xffff0000, v130
v_and_b32 v179, 0xffff0000, v131
v_and_b32 v180, 0xffff0000, v132
v_and_b32 v181, 0xffff0000, v133
v_and_b32 v182, 0xffff0000, v134
v_and_b32 v183, 0xffff0000, v135
v_and_b32 v184, 0xffff0000, v136
v_and_b32 v185, 0xffff0000, v137
v_and_b32 v186, 0xffff0000, v138
v_and_b32 v187, 0xffff0000, v139
v_and_b32 v188, 0xffff0000, v140
v_and_b32 v189, 0xffff0000, v141
v_and_b32 v190, 0xffff0000, v142
v_mul_f32 v191, v171, v172
v_mul_f32 v192, v171, v173
v_mul_f32 v193, v171, v174
v_mul_f32 v194, v171, v175
v_mul_f32 v195, v171, v176
v_mul_f32 v196, v171, v177
v_mul_f32 v197, v171, v178
v_mul_f32 v198, v171, v179
v_mul_f32 v199, v171, v180
v_mul_f32 v200, v171, v181
v_mul_f32 v201, v171, v182
v_mul_f32 v202, v171, v183
v_mul_f32 v203, v171, v184
v_mul_f32 v204, v171, v185
v_mul_f32 v205, v171, v186
v_mul_f32 v206, v171, v187
v_fmac_f32 v191, v170, v173
v_fmac_f32 v192, v170, v174
v_fmac_f32 v193, v170, v175
v_fmac_f32 v194, v170, v176
v_fmac_f32 v195, v170, v177
v_fmac_f32 v196, v170, v178
v_fmac_f32 v197, v170, v179
v_fmac_f32 v198, v170, v180
v_fmac_f32 v199, v170, v181
v_fmac_f32 v200, v170, v182
v_fmac_f32 v201, v170, v183
v_fmac_f32 v202, v170, v184
v_fmac_f32 v203, v170, v185
v_fmac_f32 v204, v170, v186
v_fmac_f32 v205, v170, v187
v_fmac_f32 v206, v170, v188
v_fmac_f32 v191, v169, v174
v_fmac_f32 v192, v169, v175
v_fmac_f32 v193, v169, v176
v_fmac_f32 v194, v169, v177
v_fmac_f32 v195, v169, v178
v_fmac_f32 v196, v169, v179
v_fmac_f32 v197, v169, v180
s_barrier
v_fmac_f32 v198, v169, v181
v_fmac_f32 v199, v169, v182
v_fmac_f32 v200, v169, v183
v_fmac_f32 v201, v169, v184
v_fmac_f32 v202, v169, v185
v_fmac_f32 v203, v169, v186
v_fmac_f32 v204, v169, v187
v_fmac_f32 v205, v169, v188
v_fmac_f32 v206, v169, v189
v_fmac_f32 v191, v168, v175
v_fmac_f32 v192, v168, v176
v_fmac_f32 v193, v168, v177
v_fmac_f32 v194, v168, v178
v_fmac_f32 v195, v168, v179
v_fmac_f32 v196, v168, v180
v_fmac_f32 v197, v168, v181
v_fmac_f32 v198, v168, v182
v_fmac_f32 v199, v168, v183
v_fmac_f32 v200, v168, v184
v_fmac_f32 v201, v168, v185
v_fmac_f32 v202, v168, v186
v_fmac_f32 v203, v168, v187
v_fmac_f32 v204, v168, v188
v_fmac_f32 v205, v168, v189
v_fmac_f32 v206, v168, v190
v_and_b32 v172, 0xffff0000, v143
v_and_b32 v173, 0xffff0000, v144
v_and_b32 v174, 0xffff0000, v145
v_and_b32 v175, 0xffff0000, v146
v_and_b32 v176, 0xffff0000, v147
v_and_b32 v177, 0xffff0000, v148
v_and_b32 v178, 0xffff0000, v149
v_and_b32 v179, 0xffff0000, v150
v_and_b32 v180, 0xffff0000, v151
v_and_b32 v181, 0xffff0000, v152
v_and_b32 v182, 0xffff0000, v153
v_and_b32 v183, 0xffff0000, v154
v_and_b32 v184, 0xffff0000, v155
v_and_b32 v185, 0xffff0000, v156
v_and_b32 v186, 0xffff0000, v157
v_and_b32 v187, 0xffff0000, v158
v_mul_f32 v191, v191, v172
v_mul_f32 v192, v192, v173
v_mul_f32 v193, v193, v174
v_mul_f32 v194, v194, v175
v_mul_f32 v195, v195, v176
v_mul_f32 v196, v196, v177
v_mul_f32 v197, v197, v178
v_mul_f32 v198, v198, v179
v_mul_f32 v199, v199, v180
v_mul_f32 v200, v200, v181
v_mul_f32 v201, v201, v182
v_mul_f32 v202, v202, v183
v_mul_f32 v203, v203, v184
v_mul_f32 v204, v204, v185
v_mul_f32 v205, v205, v186
v_mul_f32 v206, v206, v187
v_cvt_pk_bf16_f32 v216, v206, v205
v_cvt_pk_bf16_f32 v217, v204, v203
v_cvt_pk_bf16_f32 v218, v202, v201
v_cvt_pk_bf16_f32 v219, v200, v199
v_cvt_pk_bf16_f32 v220, v198, v197
v_cvt_pk_bf16_f32 v221, v196, v195
v_cvt_pk_bf16_f32 v222, v194, v193
v_cvt_pk_bf16_f32 v223, v192, v191
ds_write_b128 v229, v[208:211] offset:0
ds_write_b128 v230, v[212:215] offset:0
ds_write_b128 v229, v[216:219] offset:128
s_barrier
ds_write_b128 v230, v[220:223] offset:128
s_waitcnt lgkmcnt(0)
ds_read_b128 v[208:211], v231 offset:0
ds_read_b128 v[212:215], v232 offset:1024
ds_read_b128 v[216:219], v231 offset:2048
ds_read_b128 v[220:223], v232 offset:3072
s_mov_b32 s58, 0
s_waitcnt lgkmcnt(0)
buffer_store_dwordx4 v[208:211], v228, s[44:47], s58 offen sc1
s_add_u32 s58, s58, 36864
buffer_store_dwordx4 v[212:215], v228, s[44:47], s58 offen sc1
s_add_u32 s58, s58, 36864
buffer_store_dwordx4 v[216:219], v228, s[44:47], s58 offen sc1
s_add_u32 s58, s58, 36864
buffer_store_dwordx4 v[220:223], v228, s[44:47], s58 offen sc1
s_add_u32 s58, s58, 36864
s_barrier
s_barrier
v_mov_b32 v110, 0
s_mov_b32 s101, 0
L_toka:
global_load_dword v111, v110, s[86:87] sc1
s_waitcnt vmcnt(0)
v_readfirstlane_b32 s100, v111
s_add_u32 s101, s101, 1
s_cmp_ge_u32 s101, 0x400000
s_cbranch_scc1 L_tokxa
s_cmp_eq_u32 s100, 0
s_cbranch_scc1 L_toka
L_tokxa:
s_lshl_b32 s66, s3, 7
s_lshr_b32 s67, s2, 3
s_lshl_b32 s67, s67, 2
s_add_u32 s66, s66, s67
s_add_u32 s66, s66, s88
v_mov_b32 v110, s66
v_mov_b32 v111, s100
s_waitcnt vmcnt(0)
s_mov_b64 exec, 1
global_store_dword v110, v111, s[84:85] sc1
s_mov_b64 exec, -1
s_lshr_b32 s66, s2, 6
s_lshl_b32 s66, s66, 7
s_add_u32 s66, s66, s88
v_and_b32 v119, 31, v108
v_lshl_add_u32 v119, v119, 2, s66
s_lshl_b32 s65, s64, 16
s_and_b32 s64, s64, 0xffff0000
s_and_b32 s69, s3, 1
s_cmp_eq_u32 s69, 0
s_cselect_b32 s64, s65, s64
s_barrier
s_barrier
s_barrier
s_barrier
s_mov_b32 s69, 0
L_pollz1:
global_load_dword v111, v119, s[84:85] sc1
s_waitcnt vmcnt(0)
v_cmp_ne_u32 vcc, s100, v111
s_nop 0
s_cbranch_vccz L_readyz1
s_sleep 4
s_add_u32 s69, s69, 1
s_cmp_lt_u32 s69, 0x200000
s_cbranch_scc1 L_pollz1
L_readyz1:
s_add_u32 m0, s72, 0
s_add_u32 s69, s73, 0
buffer_load_dwordx4 v109, s[8:11], s69 offen sc1 lds
s_add_u32 m0, s72, 1024
s_add_u32 s69, s73, 1024
buffer_load_dwordx4 v109, s[8:11], s69 offen sc1 lds
s_add_u32 m0, s72, 2048
s_add_u32 s69, s73, 2048
buffer_load_dwordx4 v109, s[8:11], s69 offen sc1 lds
s_add_u32 m0, s72, 3072
s_add_u32 s69, s73, 3072
buffer_load_dwordx4 v109, s[8:11], s69 offen sc1 lds
s_add_u32 m0, s72, 4096
s_add_u32 s69, s73, 4096
s_mov_b64 exec, 0xffffffff
buffer_load_dwordx4 v109, s[8:11], s69 offen sc1 lds
s_mov_b64 exec, -1
ds_write_b128 v117, v[4:7]
v_lshrrev_b32 v110, 3, v108
v_add_lshl_u32 v110, v110, v108, 4
v_add_u32 v110, s72, v110
v_add_u32 v111, 1, v108
v_lshrrev_b32 v112, 3, v111
v_add_lshl_u32 v111, v112, v111, 4
v_add_u32 v111, s72, v111
s_waitcnt vmcnt(0) lgkmcnt(0)
ds_read_b128 v[124:127], v110 offset:0
ds_read_b32 v128, v111 offset:0
ds_read_b128 v[132:135], v110 offset:1152
ds_read_b32 v136, v111 offset:1152
ds_read_b128 v[140:143], v110 offset:2304
ds_read_b32 v144, v111 offset:2304
ds_read_b128 v[148:151], v110 offset:3456
ds_read_b32 v152, v111 offset:3456
s_waitcnt lgkmcnt(0)
v_alignbit_b32 v124, v125, v124, 16
v_alignbit_b32 v125, v126, v125, 16
v_alignbit_b32 v126, v127, v126, 16
v_alignbit_b32 v127, v128, v127, 16
ds_write_b128 v110, v[124:127] offset:5120
v_alignbit_b32 v132, v133, v132, 16
v_alignbit_b32 v133, v134, v133, 16
v_alignbit_b32 v134, v135, v134, 16
v_alignbit_b32 v135, v136, v135, 16
ds_write_b128 v110, v[132:135] offset:6272
v_alignbit_b32 v140, v141, v140, 16
v_alignbit_b32 v141, v142, v141, 16
v_alignbit_b32 v142, v143, v142, 16
v_alignbit_b32 v143, v144, v143, 16
ds_write_b128 v110, v[140:143] offset:7424
v_alignbit_b32 v148, v149, v148, 16
v_alignbit_b32 v149, v150, v149, 16
v_alignbit_b32 v150, v151, v150, 16
v_alignbit_b32 v151, v152, v151, 16
ds_write_b128 v110, v[148:151] offset:8576
s_waitcnt lgkmcnt(0)
s_mul_i32 s69, s3, 4352
s_add_u32 s69, s69, 100352
v_add_u32 v110, s69, v109
v_and_b32 v111, 7, v108
v_lshl_add_u32 v111, v111, 4, s69
ds_write_b128 v111, v[4:7]
ds_write_b128 v110, v[92:95] offset:128
ds_write_b128 v110, v[96:99] offset:1152
ds_write_b128 v110, v[100:103] offset:2176
ds_write_b128 v110, v[104:107] offset:3200
v_add_u32 v114, s69, v114
v_add_u32 v114, 4, v114
v_add_u32 v120, 2048, v114
s_waitcnt lgkmcnt(0)
s_setprio 0
v_add_u32 v118, 2304, v113
v_min_u32 v118, v118, v117
ds_read_b128 v[68:71], v118
ds_read_b128 v[72:75], v113 offset:0
ds_read2_b32 v[36:37], v114 offset0:0 offset1:1
ds_read2_b32 v[38:39], v114 offset0:2 offset1:3
ds_read2_b32 v[40:41], v120 offset0:0 offset1:1
ds_read2_b32 v[42:43], v120 offset0:2 offset1:3
v_add_u32 v118, 2336, v113
v_min_u32 v118, v118, v117
ds_read_b128 v[76:79], v118
ds_read_b128 v[80:83], v113 offset:32
ds_read2_b32 v[44:45], v114 offset0:8 offset1:9
ds_read2_b32 v[46:47], v114 offset0:10 offset1:11
ds_read2_b32 v[48:49], v120 offset0:8 offset1:9
ds_read2_b32 v[50:51], v120 offset0:10 offset1:11
s_waitcnt lgkmcnt(6)
v_mfma_f32_32x32x16_bf16 v[4:19], v[36:39], v[68:71], v[4:19]
v_add_u32 v118, 2368, v113
v_min_u32 v118, v118, v117
ds_read_b128 v[84:87], v118
v_mfma_f32_32x32x16_bf16 v[20:35], v[36:39], v[72:75], v[20:35]
ds_read_b128 v[88:91], v113 offset:64
ds_read2_b32 v[52:53], v114 offset0:16 offset1:17
ds_read2_b32 v[54:55], v114 offset0:18 offset1:19
v_mfma_f32_32x32x16_bf16 v[20:35], v[40:43], v[68:71], v[20:35]
ds_read2_b32 v[56:57], v120 offset0:16 offset1:17
ds_read2_b32 v[58:59], v120 offset0:18 offset1:19
s_waitcnt lgkmcnt(6)
v_mfma_f32_32x32x16_bf16 v[4:19], v[44:47], v[76:79], v[4:19]
v_add_u32 v118, 2400, v113
v_min_u32 v118, v118, v117
ds_read_b128 v[68:71], v118
v_mfma_f32_32x32x16_bf16 v[20:35], v[44:47], v[80:83], v[20:35]
ds_read_b128 v[72:75], v113 offset:96
ds_read2_b32 v[36:37], v114 offset0:24 offset1:25
ds_read2_b32 v[38:39], v114 offset0:26 offset1:27
v_mfma_f32_32x32x16_bf16 v[20:35], v[48:51], v[76:79], v[20:35]
ds_read2_b32 v[40:41], v120 offset0:24 offset1:25
ds_read2_b32 v[42:43], v120 offset0:26 offset1:27
s_waitcnt lgkmcnt(6)
v_mfma_f32_32x32x16_bf16 v[4:19], v[52:55], v[84:87], v[4:19]
v_add_u32 v118, 2448, v113
v_min_u32 v118, v118, v117
ds_read_b128 v[76:79], v118
v_mfma_f32_32x32x16_bf16 v[20:35], v[52:55], v[88:91], v[20:35]
ds_read_b128 v[80:83], v113 offset:144
ds_read2_b32 v[44:45], v114 offset0:32 offset1:33
ds_read2_b32 v[46:47], v114 offset0:34 offset1:35
v_mfma_f32_32x32x16_bf16 v[20:35], v[56:59], v[84:87], v[20:35]
ds_read2_b32 v[48:49], v120 offset0:32 offset1:33
ds_read2_b32 v[50:51], v120 offset0:34 offset1:35
s_waitcnt lgkmcnt(6)
v_mfma_f32_32x32x16_bf16 v[4:19], v[36:39], v[68:71], v[4:19]
v_add_u32 v118, 2480, v113
v_min_u32 v118, v118, v117
ds_read_b128 v[84:87], v118
v_mfma_f32_32x32x16_bf16 v[20:35], v[36:39], v[72:75], v[20:35]
ds_read_b128 v[88:91], v113 offset:176
ds_read2_b32 v[52:53], v114 offset0:40 offset1:41
ds_read2_b32 v[54:55], v114 offset0:42 offset1:43
v_mfma_f32_32x32x16_bf16 v[20:35], v[40:43], v[68:71], v[20:35]
ds_read2_b32 v[56:57], v120 offset0:40 offset1:41
ds_read2_b32 v[58:59], v120 offset0:42 offset1:43
s_waitcnt lgkmcnt(6)
v_mfma_f32_32x32x16_bf16 v[4:19], v[44:47], v[76:79], v[4:19]
v_add_u32 v118, 2512, v113
v_min_u32 v118, v118, v117
ds_read_b128 v[68:71], v118
v_mfma_f32_32x32x16_bf16 v[20:35], v[44:47], v[80:83], v[20:35]
ds_read_b128 v[72:75], v113 offset:208
ds_read2_b32 v[36:37], v114 offset0:48 offset1:49
ds_read2_b32 v[38:39], v114 offset0:50 offset1:51
v_mfma_f32_32x32x16_bf16 v[20:35], v[48:51], v[76:79], v[20:35]
ds_read2_b32 v[40:41], v120 offset0:48 offset1:49
ds_read2_b32 v[42:43], v120 offset0:50 offset1:51
s_waitcnt lgkmcnt(6)
v_mfma_f32_32x32x16_bf16 v[4:19], v[52:55], v[84:87], v[4:19]
v_add_u32 v118, 2544, v113
v_min_u32 v118, v118, v117
ds_read_b128 v[76:79], v118
v_mfma_f32_32x32x16_bf16 v[20:35], v[52:55], v[88:91], v[20:35]
ds_read_b128 v[80:83], v113 offset:240
ds_read2_b32 v[44:45], v114 offset0:56 offset1:57
ds_read2_b32 v[46:47], v114 offset0:58 offset1:59
v_mfma_f32_32x32x16_bf16 v[20:35], v[56:59], v[84:87], v[20:35]
ds_read2_b32 v[48:49], v120 offset0:56 offset1:57
ds_read2_b32 v[50:51], v120 offset0:58 offset1:59
s_waitcnt lgkmcnt(6)
v_mfma_f32_32x32x16_bf16 v[4:19], v[36:39], v[68:71], v[4:19]
v_add_u32 v118, 2592, v113
v_min_u32 v118, v118, v117
ds_read_b128 v[84:87], v118
v_mfma_f32_32x32x16_bf16 v[20:35], v[36:39], v[72:75], v[20:35]
ds_read_b128 v[88:91], v113 offset:288
ds_read2_b32 v[52:53], v114 offset0:64 offset1:65
ds_read2_b32 v[54:55], v114 offset0:66 offset1:67
v_mfma_f32_32x32x16_bf16 v[20:35], v[40:43], v[68:71], v[20:35]
ds_read2_b32 v[56:57], v120 offset0:64 offset1:65
ds_read2_b32 v[58:59], v120 offset0:66 offset1:67
s_waitcnt lgkmcnt(6)
v_mfma_f32_32x32x16_bf16 v[4:19], v[44:47], v[76:79], v[4:19]
v_add_u32 v118, 2624, v113
v_min_u32 v118, v118, v117
ds_read_b128 v[68:71], v118
v_mfma_f32_32x32x16_bf16 v[20:35], v[44:47], v[80:83], v[20:35]
ds_read_b128 v[72:75], v113 offset:320
ds_read2_b32 v[36:37], v114 offset0:72 offset1:73
ds_read2_b32 v[38:39], v114 offset0:74 offset1:75
v_mfma_f32_32x32x16_bf16 v[20:35], v[48:51], v[76:79], v[20:35]
ds_read2_b32 v[40:41], v120 offset0:72 offset1:73
ds_read2_b32 v[42:43], v120 offset0:74 offset1:75
s_waitcnt lgkmcnt(6)
v_mfma_f32_32x32x16_bf16 v[4:19], v[52:55], v[84:87], v[4:19]
v_add_u32 v118, 2656, v113
v_min_u32 v118, v118, v117
ds_read_b128 v[76:79], v118
v_mfma_f32_32x32x16_bf16 v[20:35], v[52:55], v[88:91], v[20:35]
ds_read_b128 v[80:83], v113 offset:352
ds_read2_b32 v[44:45], v114 offset0:80 offset1:81
ds_read2_b32 v[46:47], v114 offset0:82 offset1:83
v_mfma_f32_32x32x16_bf16 v[20:35], v[56:59], v[84:87], v[20:35]
ds_read2_b32 v[48:49], v120 offset0:80 offset1:81
ds_read2_b32 v[50:51], v120 offset0:82 offset1:83
s_waitcnt lgkmcnt(6)
v_mfma_f32_32x32x16_bf16 v[4:19], v[36:39], v[68:71], v[4:19]
v_add_u32 v118, 2688, v113
v_min_u32 v118, v118, v117
ds_read_b128 v[84:87], v118
v_mfma_f32_32x32x16_bf16 v[20:35], v[36:39], v[72:75], v[20:35]
ds_read_b128 v[88:91], v113 offset:384
ds_read2_b32 v[52:53], v114 offset0:88 offset1:89
ds_read2_b32 v[54:55], v114 offset0:90 offset1:91
v_mfma_f32_32x32x16_bf16 v[20:35], v[40:43], v[68:71], v[20:35]
ds_read2_b32 v[56:57], v120 offset0:88 offset1:89
ds_read2_b32 v[58:59], v120 offset0:90 offset1:91
s_waitcnt lgkmcnt(6)
v_mfma_f32_32x32x16_bf16 v[4:19], v[44:47], v[76:79], v[4:19]
v_add_u32 v118, 2736, v113
v_min_u32 v118, v118, v117
ds_read_b128 v[68:71], v118
v_mfma_f32_32x32x16_bf16 v[20:35], v[44:47], v[80:83], v[20:35]
ds_read_b128 v[72:75], v113 offset:432
ds_read2_b32 v[36:37], v114 offset0:96 offset1:97
ds_read2_b32 v[38:39], v114 offset0:98 offset1:99
v_mfma_f32_32x32x16_bf16 v[20:35], v[48:51], v[76:79], v[20:35]
ds_read2_b32 v[40:41], v120 offset0:96 offset1:97
ds_read2_b32 v[42:43], v120 offset0:98 offset1:99
s_waitcnt lgkmcnt(6)
v_mfma_f32_32x32x16_bf16 v[4:19], v[52:55], v[84:87], v[4:19]
v_add_u32 v118, 2768, v113
v_min_u32 v118, v118, v117
ds_read_b128 v[76:79], v118
v_mfma_f32_32x32x16_bf16 v[20:35], v[52:55], v[88:91], v[20:35]
ds_read_b128 v[80:83], v113 offset:464
ds_read2_b32 v[44:45], v114 offset0:104 offset1:105
ds_read2_b32 v[46:47], v114 offset0:106 offset1:107
v_mfma_f32_32x32x16_bf16 v[20:35], v[56:59], v[84:87], v[20:35]
ds_read2_b32 v[48:49], v120 offset0:104 offset1:105
ds_read2_b32 v[50:51], v120 offset0:106 offset1:107
s_waitcnt lgkmcnt(6)
v_mfma_f32_32x32x16_bf16 v[4:19], v[36:39], v[68:71], v[4:19]
v_add_u32 v118, 2800, v113
v_min_u32 v118, v118, v117
ds_read_b128 v[84:87], v118
v_mfma_f32_32x32x16_bf16 v[20:35], v[36:39], v[72:75], v[20:35]
ds_read_b128 v[88:91], v113 offset:496
ds_read2_b32 v[52:53], v114 offset0:112 offset1:113
ds_read2_b32 v[54:55], v114 offset0:114 offset1:115
v_mfma_f32_32x32x16_bf16 v[20:35], v[40:43], v[68:71], v[20:35]
ds_read2_b32 v[56:57], v120 offset0:112 offset1:113
ds_read2_b32 v[58:59], v120 offset0:114 offset1:115
s_waitcnt lgkmcnt(6)
v_mfma_f32_32x32x16_bf16 v[4:19], v[44:47], v[76:79], v[4:19]
v_add_u32 v118, 2832, v113
v_min_u32 v118, v118, v117
ds_read_b128 v[68:71], v118
v_mfma_f32_32x32x16_bf16 v[20:35], v[44:47], v[80:83], v[20:35]
ds_read_b128 v[72:75], v113 offset:528
ds_read2_b32 v[36:37], v114 offset0:120 offset1:121
ds_read2_b32 v[38:39], v114 offset0:122 offset1:123
v_mfma_f32_32x32x16_bf16 v[20:35], v[48:51], v[76:79], v[20:35]
ds_read2_b32 v[40:41], v120 offset0:120 offset1:121
ds_read2_b32 v[42:43], v120 offset0:122 offset1:123
s_waitcnt lgkmcnt(6)
v_mfma_f32_32x32x16_bf16 v[4:19], v[52:55], v[84:87], v[4:19]
v_add_u32 v118, 2880, v113
v_min_u32 v118, v118, v117
ds_read_b128 v[76:79], v118
v_mfma_f32_32x32x16_bf16 v[20:35], v[52:55], v[88:91], v[20:35]
ds_read_b128 v[80:83], v113 offset:576
ds_read2_b32 v[44:45], v114 offset0:128 offset1:129
ds_read2_b32 v[46:47], v114 offset0:130 offset1:131
v_mfma_f32_32x32x16_bf16 v[20:35], v[56:59], v[84:87], v[20:35]
ds_read2_b32 v[48:49], v120 offset0:128 offset1:129
ds_read2_b32 v[50:51], v120 offset0:130 offset1:131
s_waitcnt lgkmcnt(6)
v_mfma_f32_32x32x16_bf16 v[4:19], v[36:39], v[68:71], v[4:19]
v_add_u32 v118, 2912, v113
v_min_u32 v118, v118, v117
ds_read_b128 v[84:87], v118
v_mfma_f32_32x32x16_bf16 v[20:35], v[36:39], v[72:75], v[20:35]
ds_read_b128 v[88:91], v113 offset:608
ds_read2_b32 v[52:53], v114 offset0:136 offset1:137
ds_read2_b32 v[54:55], v114 offset0:138 offset1:139
v_mfma_f32_32x32x16_bf16 v[20:35], v[40:43], v[68:71], v[20:35]
ds_read2_b32 v[56:57], v120 offset0:136 offset1:137
ds_read2_b32 v[58:59], v120 offset0:138 offset1:139
s_waitcnt lgkmcnt(6)
v_mfma_f32_32x32x16_bf16 v[4:19], v[44:47], v[76:79], v[4:19]
v_add_u32 v118, 2944, v113
v_min_u32 v118, v118, v117
ds_read_b128 v[68:71], v118
v_mfma_f32_32x32x16_bf16 v[20:35], v[44:47], v[80:83], v[20:35]
ds_read_b128 v[72:75], v113 offset:640
ds_read2_b32 v[36:37], v114 offset0:144 offset1:145
ds_read2_b32 v[38:39], v114 offset0:146 offset1:147
v_mfma_f32_32x32x16_bf16 v[20:35], v[48:51], v[76:79], v[20:35]
ds_read2_b32 v[40:41], v120 offset0:144 offset1:145
ds_read2_b32 v[42:43], v120 offset0:146 offset1:147
s_waitcnt lgkmcnt(6)
v_mfma_f32_32x32x16_bf16 v[4:19], v[52:55], v[84:87], v[4:19]
v_add_u32 v118, 2976, v113
v_min_u32 v118, v118, v117
ds_read_b128 v[76:79], v118
v_mfma_f32_32x32x16_bf16 v[20:35], v[52:55], v[88:91], v[20:35]
ds_read_b128 v[80:83], v113 offset:672
ds_read2_b32 v[44:45], v114 offset0:152 offset1:153
ds_read2_b32 v[46:47], v114 offset0:154 offset1:155
v_mfma_f32_32x32x16_bf16 v[20:35], v[56:59], v[84:87], v[20:35]
ds_read2_b32 v[48:49], v120 offset0:152 offset1:153
ds_read2_b32 v[50:51], v120 offset0:154 offset1:155
s_waitcnt lgkmcnt(6)
v_mfma_f32_32x32x16_bf16 v[4:19], v[36:39], v[68:71], v[4:19]
v_add_u32 v118, 3024, v113
v_min_u32 v118, v118, v117
ds_read_b128 v[84:87], v118
v_mfma_f32_32x32x16_bf16 v[20:35], v[36:39], v[72:75], v[20:35]
ds_read_b128 v[88:91], v113 offset:720
ds_read2_b32 v[52:53], v114 offset0:160 offset1:161
ds_read2_b32 v[54:55], v114 offset0:162 offset1:163
v_mfma_f32_32x32x16_bf16 v[20:35], v[40:43], v[68:71], v[20:35]
ds_read2_b32 v[56:57], v120 offset0:160 offset1:161
ds_read2_b32 v[58:59], v120 offset0:162 offset1:163
s_waitcnt lgkmcnt(6)
v_mfma_f32_32x32x16_bf16 v[4:19], v[44:47], v[76:79], v[4:19]
v_add_u32 v118, 3056, v113
v_min_u32 v118, v118, v117
ds_read_b128 v[68:71], v118
v_mfma_f32_32x32x16_bf16 v[20:35], v[44:47], v[80:83], v[20:35]
ds_read_b128 v[72:75], v113 offset:752
ds_read2_b32 v[36:37], v114 offset0:168 offset1:169
ds_read2_b32 v[38:39], v114 offset0:170 offset1:171
v_mfma_f32_32x32x16_bf16 v[20:35], v[48:51], v[76:79], v[20:35]
ds_read2_b32 v[40:41], v120 offset0:168 offset1:169
ds_read2_b32 v[42:43], v120 offset0:170 offset1:171
s_waitcnt lgkmcnt(6)
v_mfma_f32_32x32x16_bf16 v[4:19], v[52:55], v[84:87], v[4:19]
v_add_u32 v118, 3088, v113
v_min_u32 v118, v118, v117
ds_read_b128 v[76:79], v118
v_mfma_f32_32x32x16_bf16 v[20:35], v[52:55], v[88:91], v[20:35]
ds_read_b128 v[80:83], v113 offset:784
ds_read2_b32 v[44:45], v114 offset0:176 offset1:177
ds_read2_b32 v[46:47], v114 offset0:178 offset1:179
v_mfma_f32_32x32x16_bf16 v[20:35], v[56:59], v[84:87], v[20:35]
ds_read2_b32 v[48:49], v120 offset0:176 offset1:177
ds_read2_b32 v[50:51], v120 offset0:178 offset1:179
s_waitcnt lgkmcnt(6)
v_mfma_f32_32x32x16_bf16 v[4:19], v[36:39], v[68:71], v[4:19]
v_add_u32 v118, 3120, v113
v_min_u32 v118, v118, v117
ds_read_b128 v[84:87], v118
v_mfma_f32_32x32x16_bf16 v[20:35], v[36:39], v[72:75], v[20:35]
ds_read_b128 v[88:91], v113 offset:816
ds_read2_b32 v[52:53], v114 offset0:184 offset1:185
ds_read2_b32 v[54:55], v114 offset0:186 offset1:187
v_mfma_f32_32x32x16_bf16 v[20:35], v[40:43], v[68:71], v[20:35]
ds_read2_b32 v[56:57], v120 offset0:184 offset1:185
ds_read2_b32 v[58:59], v120 offset0:186 offset1:187
s_waitcnt lgkmcnt(6)
v_mfma_f32_32x32x16_bf16 v[4:19], v[44:47], v[76:79], v[4:19]
v_add_u32 v118, 3168, v113
v_min_u32 v118, v118, v117
ds_read_b128 v[68:71], v118
v_mfma_f32_32x32x16_bf16 v[20:35], v[44:47], v[80:83], v[20:35]
ds_read_b128 v[72:75], v113 offset:864
ds_read2_b32 v[36:37], v114 offset0:192 offset1:193
ds_read2_b32 v[38:39], v114 offset0:194 offset1:195
v_mfma_f32_32x32x16_bf16 v[20:35], v[48:51], v[76:79], v[20:35]
ds_read2_b32 v[40:41], v120 offset0:192 offset1:193
ds_read2_b32 v[42:43], v120 offset0:194 offset1:195
s_waitcnt lgkmcnt(6)
v_mfma_f32_32x32x16_bf16 v[4:19], v[52:55], v[84:87], v[4:19]
v_add_u32 v118, 3200, v113
v_min_u32 v118, v118, v117
ds_read_b128 v[76:79], v118
v_mfma_f32_32x32x16_bf16 v[20:35], v[52:55], v[88:91], v[20:35]
ds_read_b128 v[80:83], v113 offset:896
ds_read2_b32 v[44:45], v114 offset0:200 offset1:201
ds_read2_b32 v[46:47], v114 offset0:202 offset1:203
v_mfma_f32_32x32x16_bf16 v[20:35], v[56:59], v[84:87], v[20:35]
ds_read2_b32 v[48:49], v120 offset0:200 offset1:201
ds_read2_b32 v[50:51], v120 offset0:202 offset1:203
s_waitcnt lgkmcnt(6)
v_mfma_f32_32x32x16_bf16 v[4:19], v[36:39], v[68:71], v[4:19]
v_add_u32 v118, 3232, v113
v_min_u32 v118, v118, v117
ds_read_b128 v[84:87], v118
v_mfma_f32_32x32x16_bf16 v[20:35], v[36:39], v[72:75], v[20:35]
ds_read_b128 v[88:91], v113 offset:928
ds_read2_b32 v[52:53], v114 offset0:208 offset1:209
ds_read2_b32 v[54:55], v114 offset0:210 offset1:211
v_mfma_f32_32x32x16_bf16 v[20:35], v[40:43], v[68:71], v[20:35]
ds_read2_b32 v[56:57], v120 offset0:208 offset1:209
ds_read2_b32 v[58:59], v120 offset0:210 offset1:211
s_waitcnt lgkmcnt(6)
v_mfma_f32_32x32x16_bf16 v[4:19], v[44:47], v[76:79], v[4:19]
v_add_u32 v118, 3264, v113
v_min_u32 v118, v118, v117
ds_read_b128 v[68:71], v118
v_mfma_f32_32x32x16_bf16 v[20:35], v[44:47], v[80:83], v[20:35]
ds_read_b128 v[72:75], v113 offset:960
ds_read2_b32 v[36:37], v114 offset0:216 offset1:217
ds_read2_b32 v[38:39], v114 offset0:218 offset1:219
v_mfma_f32_32x32x16_bf16 v[20:35], v[48:51], v[76:79], v[20:35]
ds_read2_b32 v[40:41], v120 offset0:216 offset1:217
ds_read2_b32 v[42:43], v120 offset0:218 offset1:219
s_waitcnt lgkmcnt(6)
v_mfma_f32_32x32x16_bf16 v[4:19], v[52:55], v[84:87], v[4:19]
v_add_u32 v118, 3312, v113
v_min_u32 v118, v118, v117
ds_read_b128 v[76:79], v118
v_mfma_f32_32x32x16_bf16 v[20:35], v[52:55], v[88:91], v[20:35]
ds_read_b128 v[80:83], v113 offset:1008
ds_read2_b32 v[44:45], v114 offset0:224 offset1:225
ds_read2_b32 v[46:47], v114 offset0:226 offset1:227
v_mfma_f32_32x32x16_bf16 v[20:35], v[56:59], v[84:87], v[20:35]
ds_read2_b32 v[48:49], v120 offset0:224 offset1:225
ds_read2_b32 v[50:51], v120 offset0:226 offset1:227
s_waitcnt lgkmcnt(6)
v_mfma_f32_32x32x16_bf16 v[4:19], v[36:39], v[68:71], v[4:19]
v_add_u32 v118, 3344, v113
v_min_u32 v118, v118, v117
ds_read_b128 v[84:87], v118
v_mfma_f32_32x32x16_bf16 v[20:35], v[36:39], v[72:75], v[20:35]
ds_read_b128 v[88:91], v113 offset:1040
ds_read2_b32 v[52:53], v114 offset0:232 offset1:233
ds_read2_b32 v[54:55], v114 offset0:234 offset1:235
v_mfma_f32_32x32x16_bf16 v[20:35], v[40:43], v[68:71], v[20:35]
ds_read2_b32 v[56:57], v120 offset0:232 offset1:233
ds_read2_b32 v[58:59], v120 offset0:234 offset1:235
s_waitcnt lgkmcnt(6)
v_mfma_f32_32x32x16_bf16 v[4:19], v[44:47], v[76:79], v[4:19]
v_add_u32 v118, 3376, v113
v_min_u32 v118, v118, v117
ds_read_b128 v[68:71], v118
v_mfma_f32_32x32x16_bf16 v[20:35], v[44:47], v[80:83], v[20:35]
ds_read_b128 v[72:75], v113 offset:1072
ds_read2_b32 v[36:37], v114 offset0:240 offset1:241
ds_read2_b32 v[38:39], v114 offset0:242 offset1:243
v_mfma_f32_32x32x16_bf16 v[20:35], v[48:51], v[76:79], v[20:35]
ds_read2_b32 v[40:41], v120 offset0:240 offset1:241
ds_read2_b32 v[42:43], v120 offset0:242 offset1:243
s_waitcnt lgkmcnt(6)
v_mfma_f32_32x32x16_bf16 v[4:19], v[52:55], v[84:87], v[4:19]
v_add_u32 v118, 3408, v113
v_min_u32 v118, v118, v117
ds_read_b128 v[76:79], v118
ds_read_b128 v[80:83], v113 offset:1104
v_mfma_f32_32x32x16_bf16 v[20:35], v[52:55], v[88:91], v[20:35]
v_add_u32 v114, 992, v114
v_add_u32 v120, 992, v120
ds_read2_b32 v[44:45], v114 offset0:0 offset1:1
ds_read2_b32 v[46:47], v114 offset0:2 offset1:3
v_mfma_f32_32x32x16_bf16 v[20:35], v[56:59], v[84:87], v[20:35]
ds_read2_b32 v[48:49], v120 offset0:0 offset1:1
ds_read2_b32 v[50:51], v120 offset0:2 offset1:3
s_waitcnt lgkmcnt(6)
v_mfma_f32_32x32x16_bf16 v[4:19], v[36:39], v[68:71], v[4:19]
v_add_u32 v118, 3456, v113
v_min_u32 v118, v118, v117
ds_read_b128 v[84:87], v118
v_mfma_f32_32x32x16_bf16 v[20:35], v[36:39], v[72:75], v[20:35]
ds_read_b128 v[88:91], v113 offset:1152
ds_read2_b32 v[52:53], v114 offset0:8 offset1:9
ds_read2_b32 v[54:55], v114 offset0:10 offset1:11
v_mfma_f32_32x32x16_bf16 v[20:35], v[40:43], v[68:71], v[20:35]
ds_read2_b32 v[56:57], v120 offset0:8 offset1:9
ds_read2_b32 v[58:59], v120 offset0:10 offset1:11
s_waitcnt lgkmcnt(6)
v_mfma_f32_32x32x16_bf16 v[4:19], v[44:47], v[76:79], v[4:19]
v_add_u32 v118, 3488, v113
v_min_u32 v118, v118, v117
ds_read_b128 v[68:71], v118
v_mfma_f32_32x32x16_bf16 v[20:35], v[44:47], v[80:83], v[20:35]
ds_read_b128 v[72:75], v113 offset:1184
ds_read2_b32 v[36:37], v114 offset0:16 offset1:17
ds_read2_b32 v[38:39], v114 offset0:18 offset1:19
v_mfma_f32_32x32x16_bf16 v[20:35], v[48:51], v[76:79], v[20:35]
ds_read2_b32 v[40:41], v120 offset0:16 offset1:17
ds_read2_b32 v[42:43], v120 offset0:18 offset1:19
s_waitcnt lgkmcnt(6)
v_mfma_f32_32x32x16_bf16 v[4:19], v[52:55], v[84:87], v[4:19]
v_add_u32 v118, 3520, v113
v_min_u32 v118, v118, v117
ds_read_b128 v[76:79], v118
v_mfma_f32_32x32x16_bf16 v[20:35], v[52:55], v[88:91], v[20:35]
ds_read_b128 v[80:83], v113 offset:1216
ds_read2_b32 v[44:45], v114 offset0:24 offset1:25
ds_read2_b32 v[46:47], v114 offset0:26 offset1:27
v_mfma_f32_32x32x16_bf16 v[20:35], v[56:59], v[84:87], v[20:35]
ds_read2_b32 v[48:49], v120 offset0:24 offset1:25
ds_read2_b32 v[50:51], v120 offset0:26 offset1:27
s_waitcnt lgkmcnt(6)
v_mfma_f32_32x32x16_bf16 v[4:19], v[36:39], v[68:71], v[4:19]
v_add_u32 v118, 3552, v113
v_min_u32 v118, v118, v117
ds_read_b128 v[84:87], v118
v_mfma_f32_32x32x16_bf16 v[20:35], v[36:39], v[72:75], v[20:35]
ds_read_b128 v[88:91], v113 offset:1248
ds_read2_b32 v[52:53], v114 offset0:32 offset1:33
ds_read2_b32 v[54:55], v114 offset0:34 offset1:35
v_mfma_f32_32x32x16_bf16 v[20:35], v[40:43], v[68:71], v[20:35]
ds_read2_b32 v[56:57], v120 offset0:32 offset1:33
ds_read2_b32 v[58:59], v120 offset0:34 offset1:35
s_waitcnt lgkmcnt(6)
v_mfma_f32_32x32x16_bf16 v[4:19], v[44:47], v[76:79], v[4:19]
v_add_u32 v118, 3600, v113
v_min_u32 v118, v118, v117
ds_read_b128 v[68:71], v118
v_mfma_f32_32x32x16_bf16 v[20:35], v[44:47], v[80:83], v[20:35]
ds_read_b128 v[72:75], v113 offset:1296
ds_read2_b32 v[36:37], v114 offset0:40 offset1:41
ds_read2_b32 v[38:39], v114 offset0:42 offset1:43
v_mfma_f32_32x32x16_bf16 v[20:35], v[48:51], v[76:79], v[20:35]
ds_read2_b32 v[40:41], v120 offset0:40 offset1:41
ds_read2_b32 v[42:43], v120 offset0:42 offset1:43
s_waitcnt lgkmcnt(6)
v_mfma_f32_32x32x16_bf16 v[4:19], v[52:55], v[84:87], v[4:19]
v_add_u32 v118, 3632, v113
v_min_u32 v118, v118, v117
ds_read_b128 v[76:79], v118
v_mfma_f32_32x32x16_bf16 v[20:35], v[52:55], v[88:91], v[20:35]
ds_read_b128 v[80:83], v113 offset:1328
ds_read2_b32 v[44:45], v114 offset0:48 offset1:49
ds_read2_b32 v[46:47], v114 offset0:50 offset1:51
v_mfma_f32_32x32x16_bf16 v[20:35], v[56:59], v[84:87], v[20:35]
ds_read2_b32 v[48:49], v120 offset0:48 offset1:49
ds_read2_b32 v[50:51], v120 offset0:50 offset1:51
s_waitcnt lgkmcnt(6)
v_mfma_f32_32x32x16_bf16 v[4:19], v[36:39], v[68:71], v[4:19]
v_add_u32 v118, 3664, v113
v_min_u32 v118, v118, v117
ds_read_b128 v[84:87], v118
v_mfma_f32_32x32x16_bf16 v[20:35], v[36:39], v[72:75], v[20:35]
ds_read_b128 v[88:91], v113 offset:1360
ds_read2_b32 v[52:53], v114 offset0:56 offset1:57
ds_read2_b32 v[54:55], v114 offset0:58 offset1:59
v_mfma_f32_32x32x16_bf16 v[20:35], v[40:43], v[68:71], v[20:35]
ds_read2_b32 v[56:57], v120 offset0:56 offset1:57
ds_read2_b32 v[58:59], v120 offset0:58 offset1:59
s_waitcnt lgkmcnt(6)
v_mfma_f32_32x32x16_bf16 v[4:19], v[44:47], v[76:79], v[4:19]
v_add_u32 v118, 3696, v113
v_min_u32 v118, v118, v117
ds_read_b128 v[68:71], v118
v_mfma_f32_32x32x16_bf16 v[20:35], v[44:47], v[80:83], v[20:35]
ds_read_b128 v[72:75], v113 offset:1392
ds_read2_b32 v[36:37], v114 offset0:64 offset1:65
ds_read2_b32 v[38:39], v114 offset0:66 offset1:67
v_mfma_f32_32x32x16_bf16 v[20:35], v[48:51], v[76:79], v[20:35]
ds_read2_b32 v[40:41], v120 offset0:64 offset1:65
ds_read2_b32 v[42:43], v120 offset0:66 offset1:67
s_waitcnt lgkmcnt(6)
v_mfma_f32_32x32x16_bf16 v[4:19], v[52:55], v[84:87], v[4:19]
v_add_u32 v118, 3744, v113
v_min_u32 v118, v118, v117
ds_read_b128 v[76:79], v118
v_mfma_f32_32x32x16_bf16 v[20:35], v[52:55], v[88:91], v[20:35]
ds_read_b128 v[80:83], v113 offset:1440
ds_read2_b32 v[44:45], v114 offset0:72 offset1:73
ds_read2_b32 v[46:47], v114 offset0:74 offset1:75
v_mfma_f32_32x32x16_bf16 v[20:35], v[56:59], v[84:87], v[20:35]
ds_read2_b32 v[48:49], v120 offset0:72 offset1:73
ds_read2_b32 v[50:51], v120 offset0:74 offset1:75
s_waitcnt lgkmcnt(6)
v_mfma_f32_32x32x16_bf16 v[4:19], v[36:39], v[68:71], v[4:19]
v_add_u32 v118, 3776, v113
v_min_u32 v118, v118, v117
ds_read_b128 v[84:87], v118
v_mfma_f32_32x32x16_bf16 v[20:35], v[36:39], v[72:75], v[20:35]
ds_read_b128 v[88:91], v113 offset:1472
ds_read2_b32 v[52:53], v114 offset0:80 offset1:81
ds_read2_b32 v[54:55], v114 offset0:82 offset1:83
v_mfma_f32_32x32x16_bf16 v[20:35], v[40:43], v[68:71], v[20:35]
ds_read2_b32 v[56:57], v120 offset0:80 offset1:81
ds_read2_b32 v[58:59], v120 offset0:82 offset1:83
s_barrier
L_concat_heads__ssm_conv_h3__softmax_full_mha__prompt_kernel_kchk2:
s_and_b32 s67, s89, 127
s_cmp_eq_u32 s67, 127
s_cbranch_scc1 L_concat_heads__ssm_conv_h3__softmax_full_mha__prompt_kernel_kok2
global_load_dword v121, v122, s[84:85] sc1
s_waitcnt vmcnt(0)
v_cmp_eq_u32 vcc, s100, v121
s_nop 0
s_mov_b32 s89, vcc_lo
s_add_u32 s90, s90, 1
s_cmp_lt_u32 s90, 0x400000
s_cbranch_scc1 L_concat_heads__ssm_conv_h3__softmax_full_mha__prompt_kernel_kchk2
L_concat_heads__ssm_conv_h3__softmax_full_mha__prompt_kernel_kok2:
s_add_u32 m0, s82, 32768
s_nop 0
buffer_load_dwordx4 v116, s[76:79], s80 offen lds
buffer_load_dwordx4 v116, s[76:79], s80 offen offset:1024 lds
s_add_u32 m0, s82, 40960
s_nop 0
buffer_load_dwordx4 v116, s[76:79], s81 offen lds
buffer_load_dwordx4 v116, s[76:79], s81 offen offset:1024 lds
s_add_u32 s80, s80, 8192
s_add_u32 s81, s81, 8192
L_concat_heads__ssm_conv_h3__softmax_full_mha__prompt_kernel_kchk3:
s_and_b32 s67, s89, 511
s_cmp_eq_u32 s67, 511
s_cbranch_scc1 L_concat_heads__ssm_conv_h3__softmax_full_mha__prompt_kernel_kok3
global_load_dword v121, v122, s[84:85] sc1
s_waitcnt vmcnt(0)
v_cmp_eq_u32 vcc, s100, v121
s_nop 0
s_mov_b32 s89, vcc_lo
s_add_u32 s90, s90, 1
s_cmp_lt_u32 s90, 0x400000
s_cbranch_scc1 L_concat_heads__ssm_conv_h3__softmax_full_mha__prompt_kernel_kchk3
L_concat_heads__ssm_conv_h3__softmax_full_mha__prompt_kernel_kok3:
s_add_u32 m0, s82, 49152
s_nop 0
buffer_load_dwordx4 v116, s[76:79], s80 offen lds
buffer_load_dwordx4 v116, s[76:79], s80 offen offset:1024 lds
s_add_u32 m0, s82, 57344
s_nop 0
buffer_load_dwordx4 v116, s[76:79], s81 offen lds
buffer_load_dwordx4 v116, s[76:79], s81 offen offset:1024 lds
s_add_u32 s80, s80, 8192
s_add_u32 s81, s81, 8192
s_waitcnt lgkmcnt(6)
v_mfma_f32_32x32x16_bf16 v[4:19], v[44:47], v[76:79], v[4:19]
v_add_u32 v118, 3808, v113
v_min_u32 v118, v118, v117
ds_read_b128 v[68:71], v118
v_mfma_f32_32x32x16_bf16 v[20:35], v[44:47], v[80:83], v[20:35]
ds_read_b128 v[72:75], v113 offset:1504
ds_read2_b32 v[36:37], v114 offset0:88 offset1:89
ds_read2_b32 v[38:39], v114 offset0:90 offset1:91
v_mfma_f32_32x32x16_bf16 v[20:35], v[48:51], v[76:79], v[20:35]
ds_read2_b32 v[40:41], v120 offset0:88 offset1:89
ds_read2_b32 v[42:43], v120 offset0:90 offset1:91
s_waitcnt lgkmcnt(6)
v_mfma_f32_32x32x16_bf16 v[4:19], v[52:55], v[84:87], v[4:19]
v_add_u32 v118, 3840, v113
v_min_u32 v118, v118, v117
ds_read_b128 v[76:79], v118
v_mfma_f32_32x32x16_bf16 v[20:35], v[52:55], v[88:91], v[20:35]
ds_read_b128 v[80:83], v113 offset:1536
ds_read2_b32 v[44:45], v114 offset0:96 offset1:97
ds_read2_b32 v[46:47], v114 offset0:98 offset1:99
v_mfma_f32_32x32x16_bf16 v[20:35], v[56:59], v[84:87], v[20:35]
ds_read2_b32 v[48:49], v120 offset0:96 offset1:97
ds_read2_b32 v[50:51], v120 offset0:98 offset1:99
s_waitcnt lgkmcnt(6)
v_mfma_f32_32x32x16_bf16 v[4:19], v[36:39], v[68:71], v[4:19]
v_add_u32 v118, 3888, v113
v_min_u32 v118, v118, v117
ds_read_b128 v[84:87], v118
v_mfma_f32_32x32x16_bf16 v[20:35], v[36:39], v[72:75], v[20:35]
ds_read_b128 v[88:91], v113 offset:1584
ds_read2_b32 v[52:53], v114 offset0:104 offset1:105
ds_read2_b32 v[54:55], v114 offset0:106 offset1:107
v_mfma_f32_32x32x16_bf16 v[20:35], v[40:43], v[68:71], v[20:35]
ds_read2_b32 v[56:57], v120 offset0:104 offset1:105
ds_read2_b32 v[58:59], v120 offset0:106 offset1:107
s_waitcnt lgkmcnt(6)
v_mfma_f32_32x32x16_bf16 v[4:19], v[44:47], v[76:79], v[4:19]
v_add_u32 v118, 3920, v113
v_min_u32 v118, v118, v117
ds_read_b128 v[68:71], v118
v_mfma_f32_32x32x16_bf16 v[20:35], v[44:47], v[80:83], v[20:35]
ds_read_b128 v[72:75], v113 offset:1616
ds_read2_b32 v[36:37], v114 offset0:112 offset1:113
ds_read2_b32 v[38:39], v114 offset0:114 offset1:115
v_mfma_f32_32x32x16_bf16 v[20:35], v[48:51], v[76:79], v[20:35]
ds_read2_b32 v[40:41], v120 offset0:112 offset1:113
ds_read2_b32 v[42:43], v120 offset0:114 offset1:115
s_waitcnt lgkmcnt(6)
v_mfma_f32_32x32x16_bf16 v[4:19], v[52:55], v[84:87], v[4:19]
v_add_u32 v118, 3952, v113
v_min_u32 v118, v118, v117
ds_read_b128 v[76:79], v118
v_mfma_f32_32x32x16_bf16 v[20:35], v[52:55], v[88:91], v[20:35]
ds_read_b128 v[80:83], v113 offset:1648
ds_read2_b32 v[44:45], v114 offset0:120 offset1:121
ds_read2_b32 v[46:47], v114 offset0:122 offset1:123
v_mfma_f32_32x32x16_bf16 v[20:35], v[56:59], v[84:87], v[20:35]
ds_read2_b32 v[48:49], v120 offset0:120 offset1:121
ds_read2_b32 v[50:51], v120 offset0:122 offset1:123
s_waitcnt lgkmcnt(6)
v_mfma_f32_32x32x16_bf16 v[4:19], v[36:39], v[68:71], v[4:19]
v_add_u32 v118, 3984, v113
v_min_u32 v118, v118, v117
ds_read_b128 v[84:87], v118
v_mfma_f32_32x32x16_bf16 v[20:35], v[36:39], v[72:75], v[20:35]
ds_read_b128 v[88:91], v113 offset:1680
ds_read2_b32 v[52:53], v114 offset0:128 offset1:129
ds_read2_b32 v[54:55], v114 offset0:130 offset1:131
v_mfma_f32_32x32x16_bf16 v[20:35], v[40:43], v[68:71], v[20:35]
ds_read2_b32 v[56:57], v120 offset0:128 offset1:129
ds_read2_b32 v[58:59], v120 offset0:130 offset1:131
s_waitcnt lgkmcnt(6)
v_mfma_f32_32x32x16_bf16 v[4:19], v[44:47], v[76:79], v[4:19]
v_add_u32 v118, 4032, v113
v_min_u32 v118, v118, v117
ds_read_b128 v[68:71], v118
v_mfma_f32_32x32x16_bf16 v[20:35], v[44:47], v[80:83], v[20:35]
ds_read_b128 v[72:75], v113 offset:1728
ds_read2_b32 v[36:37], v114 offset0:136 offset1:137
ds_read2_b32 v[38:39], v114 offset0:138 offset1:139
v_mfma_f32_32x32x16_bf16 v[20:35], v[48:51], v[76:79], v[20:35]
ds_read2_b32 v[40:41], v120 offset0:136 offset1:137
ds_read2_b32 v[42:43], v120 offset0:138 offset1:139
s_waitcnt lgkmcnt(6)
v_mfma_f32_32x32x16_bf16 v[4:19], v[52:55], v[84:87], v[4:19]
v_add_u32 v118, 4064, v113
v_min_u32 v118, v118, v117
ds_read_b128 v[76:79], v118
v_mfma_f32_32x32x16_bf16 v[20:35], v[52:55], v[88:91], v[20:35]
ds_read_b128 v[80:83], v113 offset:1760
ds_read2_b32 v[44:45], v114 offset0:144 offset1:145
ds_read2_b32 v[46:47], v114 offset0:146 offset1:147
v_mfma_f32_32x32x16_bf16 v[20:35], v[56:59], v[84:87], v[20:35]
ds_read2_b32 v[48:49], v120 offset0:144 offset1:145
ds_read2_b32 v[50:51], v120 offset0:146 offset1:147
s_barrier
L_concat_heads__ssm_conv_h3__softmax_full_mha__prompt_kernel_kchk4:
s_and_b32 s67, s89, 2047
s_cmp_eq_u32 s67, 2047
s_cbranch_scc1 L_concat_heads__ssm_conv_h3__softmax_full_mha__prompt_kernel_kok4
global_load_dword v121, v122, s[84:85] sc1
s_waitcnt vmcnt(0)
v_cmp_eq_u32 vcc, s100, v121
s_nop 0
s_mov_b32 s89, vcc_lo
s_add_u32 s90, s90, 1
s_cmp_lt_u32 s90, 0x400000
s_cbranch_scc1 L_concat_heads__ssm_conv_h3__softmax_full_mha__prompt_kernel_kchk4
L_concat_heads__ssm_conv_h3__softmax_full_mha__prompt_kernel_kok4:
s_add_u32 m0, s82, 0
s_nop 0
buffer_load_dwordx4 v116, s[76:79], s80 offen lds
buffer_load_dwordx4 v116, s[76:79], s80 offen offset:1024 lds
s_add_u32 m0, s82, 8192
s_nop 0
buffer_load_dwordx4 v116, s[76:79], s81 offen lds
buffer_load_dwordx4 v116, s[76:79], s81 offen offset:1024 lds
s_add_u32 s80, s80, 8192
s_add_u32 s81, s81, 8192
s_waitcnt lgkmcnt(6)
v_mfma_f32_32x32x16_bf16 v[4:19], v[36:39], v[68:71], v[4:19]
v_add_u32 v118, 4096, v113
v_min_u32 v118, v118, v117
ds_read_b128 v[84:87], v118
v_mfma_f32_32x32x16_bf16 v[20:35], v[36:39], v[72:75], v[20:35]
ds_read_b128 v[88:91], v113 offset:1792
ds_read2_b32 v[52:53], v114 offset0:152 offset1:153
ds_read2_b32 v[54:55], v114 offset0:154 offset1:155
v_mfma_f32_32x32x16_bf16 v[20:35], v[40:43], v[68:71], v[20:35]
ds_read2_b32 v[56:57], v120 offset0:152 offset1:153
ds_read2_b32 v[58:59], v120 offset0:154 offset1:155
s_waitcnt lgkmcnt(6)
v_mfma_f32_32x32x16_bf16 v[4:19], v[44:47], v[76:79], v[4:19]
v_add_u32 v118, 4128, v113
v_min_u32 v118, v118, v117
ds_read_b128 v[68:71], v118
v_mfma_f32_32x32x16_bf16 v[20:35], v[44:47], v[80:83], v[20:35]
ds_read_b128 v[72:75], v113 offset:1824
ds_read2_b32 v[36:37], v114 offset0:160 offset1:161
ds_read2_b32 v[38:39], v114 offset0:162 offset1:163
v_mfma_f32_32x32x16_bf16 v[20:35], v[48:51], v[76:79], v[20:35]
ds_read2_b32 v[40:41], v120 offset0:160 offset1:161
ds_read2_b32 v[42:43], v120 offset0:162 offset1:163
s_waitcnt lgkmcnt(6)
v_mfma_f32_32x32x16_bf16 v[4:19], v[52:55], v[84:87], v[4:19]
v_add_u32 v118, 4176, v113
v_min_u32 v118, v118, v117
ds_read_b128 v[76:79], v118
v_mfma_f32_32x32x16_bf16 v[20:35], v[52:55], v[88:91], v[20:35]
ds_read_b128 v[80:83], v113 offset:1872
ds_read2_b32 v[44:45], v114 offset0:168 offset1:169
ds_read2_b32 v[46:47], v114 offset0:170 offset1:171
v_mfma_f32_32x32x16_bf16 v[20:35], v[56:59], v[84:87], v[20:35]
ds_read2_b32 v[48:49], v120 offset0:168 offset1:169
ds_read2_b32 v[50:51], v120 offset0:170 offset1:171
s_waitcnt lgkmcnt(6)
v_mfma_f32_32x32x16_bf16 v[4:19], v[36:39], v[68:71], v[4:19]
v_add_u32 v118, 4208, v113
v_min_u32 v118, v118, v117
ds_read_b128 v[84:87], v118
v_mfma_f32_32x32x16_bf16 v[20:35], v[36:39], v[72:75], v[20:35]
ds_read_b128 v[88:91], v113 offset:1904
ds_read2_b32 v[52:53], v114 offset0:176 offset1:177
ds_read2_b32 v[54:55], v114 offset0:178 offset1:179
v_mfma_f32_32x32x16_bf16 v[20:35], v[40:43], v[68:71], v[20:35]
ds_read2_b32 v[56:57], v120 offset0:176 offset1:177
ds_read2_b32 v[58:59], v120 offset0:178 offset1:179
s_waitcnt lgkmcnt(6)
v_mfma_f32_32x32x16_bf16 v[4:19], v[44:47], v[76:79], v[4:19]
v_add_u32 v118, 4240, v113
v_min_u32 v118, v118, v117
ds_read_b128 v[68:71], v118
v_mfma_f32_32x32x16_bf16 v[20:35], v[44:47], v[80:83], v[20:35]
ds_read_b128 v[72:75], v113 offset:1936
ds_read2_b32 v[36:37], v114 offset0:184 offset1:185
ds_read2_b32 v[38:39], v114 offset0:186 offset1:187
v_mfma_f32_32x32x16_bf16 v[20:35], v[48:51], v[76:79], v[20:35]
ds_read2_b32 v[40:41], v120 offset0:184 offset1:185
ds_read2_b32 v[42:43], v120 offset0:186 offset1:187
s_waitcnt lgkmcnt(6)
v_mfma_f32_32x32x16_bf16 v[4:19], v[52:55], v[84:87], v[4:19]
v_add_u32 v118, 4272, v113
v_min_u32 v118, v118, v117
ds_read_b128 v[76:79], v118
v_mfma_f32_32x32x16_bf16 v[20:35], v[52:55], v[88:91], v[20:35]
ds_read_b128 v[80:83], v113 offset:1968
ds_read2_b32 v[44:45], v114 offset0:192 offset1:193
ds_read2_b32 v[46:47], v114 offset0:194 offset1:195
v_mfma_f32_32x32x16_bf16 v[20:35], v[56:59], v[84:87], v[20:35]
ds_read2_b32 v[48:49], v120 offset0:192 offset1:193
ds_read2_b32 v[50:51], v120 offset0:194 offset1:195
s_waitcnt lgkmcnt(6)
v_mfma_f32_32x32x16_bf16 v[4:19], v[36:39], v[68:71], v[4:19]
v_add_u32 v118, 4320, v113
v_min_u32 v118, v118, v117
ds_read_b128 v[84:87], v118
v_mfma_f32_32x32x16_bf16 v[20:35], v[36:39], v[72:75], v[20:35]
ds_read_b128 v[88:91], v113 offset:2016
ds_read2_b32 v[52:53], v114 offset0:200 offset1:201
ds_read2_b32 v[54:55], v114 offset0:202 offset1:203
v_mfma_f32_32x32x16_bf16 v[20:35], v[40:43], v[68:71], v[20:35]
ds_read2_b32 v[56:57], v120 offset0:200 offset1:201
ds_read2_b32 v[58:59], v120 offset0:202 offset1:203
s_waitcnt lgkmcnt(6)
v_mfma_f32_32x32x16_bf16 v[4:19], v[44:47], v[76:79], v[4:19]
v_add_u32 v118, 4352, v113
v_min_u32 v118, v118, v117
ds_read_b128 v[68:71], v118
v_mfma_f32_32x32x16_bf16 v[20:35], v[44:47], v[80:83], v[20:35]
ds_read_b128 v[72:75], v113 offset:2048
ds_read2_b32 v[36:37], v114 offset0:208 offset1:209
ds_read2_b32 v[38:39], v114 offset0:210 offset1:211
v_mfma_f32_32x32x16_bf16 v[20:35], v[48:51], v[76:79], v[20:35]
ds_read2_b32 v[40:41], v120 offset0:208 offset1:209
ds_read2_b32 v[42:43], v120 offset0:210 offset1:211
s_waitcnt vmcnt(8)
s_barrier
L_concat_heads__ssm_conv_h3__softmax_full_mha__prompt_kernel_kchk5:
s_and_b32 s67, s89, 8191
s_cmp_eq_u32 s67, 8191
s_cbranch_scc1 L_concat_heads__ssm_conv_h3__softmax_full_mha__prompt_kernel_kok5
global_load_dword v121, v122, s[84:85] sc1
s_waitcnt vmcnt(0)
v_cmp_eq_u32 vcc, s100, v121
s_nop 0
s_mov_b32 s89, vcc_lo
s_add_u32 s90, s90, 1
s_cmp_lt_u32 s90, 0x400000
s_cbranch_scc1 L_concat_heads__ssm_conv_h3__softmax_full_mha__prompt_kernel_kchk5
L_concat_heads__ssm_conv_h3__softmax_full_mha__prompt_kernel_kok5:
s_add_u32 m0, s82, 16384
s_nop 0
buffer_load_dwordx4 v116, s[76:79], s80 offen lds
buffer_load_dwordx4 v116, s[76:79], s80 offen offset:1024 lds
s_add_u32 m0, s82, 24576
s_nop 0
buffer_load_dwordx4 v116, s[76:79], s81 offen lds
buffer_load_dwordx4 v116, s[76:79], s81 offen offset:1024 lds
s_add_u32 s80, s80, 8192
s_add_u32 s81, s81, 8192
s_waitcnt lgkmcnt(6)
v_mfma_f32_32x32x16_bf16 v[4:19], v[52:55], v[84:87], v[4:19]
v_add_u32 v118, 4384, v113
v_min_u32 v118, v118, v117
ds_read_b128 v[76:79], v118
v_mfma_f32_32x32x16_bf16 v[20:35], v[52:55], v[88:91], v[20:35]
ds_read_b128 v[80:83], v113 offset:2080
ds_read2_b32 v[44:45], v114 offset0:216 offset1:217
ds_read2_b32 v[46:47], v114 offset0:218 offset1:219
v_mfma_f32_32x32x16_bf16 v[20:35], v[56:59], v[84:87], v[20:35]
ds_read2_b32 v[48:49], v120 offset0:216 offset1:217
ds_read2_b32 v[50:51], v120 offset0:218 offset1:219
s_waitcnt lgkmcnt(6)
v_mfma_f32_32x32x16_bf16 v[4:19], v[36:39], v[68:71], v[4:19]
v_add_u32 v118, 4416, v113
v_min_u32 v118, v118, v117
ds_read_b128 v[84:87], v118
v_mfma_f32_32x32x16_bf16 v[20:35], v[36:39], v[72:75], v[20:35]
ds_read_b128 v[88:91], v113 offset:2112
ds_read2_b32 v[52:53], v114 offset0:224 offset1:225
ds_read2_b32 v[54:55], v114 offset0:226 offset1:227
v_mfma_f32_32x32x16_bf16 v[20:35], v[40:43], v[68:71], v[20:35]
ds_read2_b32 v[56:57], v120 offset0:224 offset1:225
ds_read2_b32 v[58:59], v120 offset0:226 offset1:227
s_waitcnt lgkmcnt(6)
v_mfma_f32_32x32x16_bf16 v[4:19], v[44:47], v[76:79], v[4:19]
v_add_u32 v118, 4464, v113
v_min_u32 v118, v118, v117
ds_read_b128 v[68:71], v118
v_mfma_f32_32x32x16_bf16 v[20:35], v[44:47], v[80:83], v[20:35]
ds_read_b128 v[72:75], v113 offset:2160
ds_read2_b32 v[36:37], v114 offset0:232 offset1:233
ds_read2_b32 v[38:39], v114 offset0:234 offset1:235
v_mfma_f32_32x32x16_bf16 v[20:35], v[48:51], v[76:79], v[20:35]
ds_read2_b32 v[40:41], v120 offset0:232 offset1:233
ds_read2_b32 v[42:43], v120 offset0:234 offset1:235
s_waitcnt lgkmcnt(6)
v_mfma_f32_32x32x16_bf16 v[4:19], v[52:55], v[84:87], v[4:19]
v_add_u32 v118, 4496, v113
v_min_u32 v118, v118, v117
ds_read_b128 v[76:79], v118
v_mfma_f32_32x32x16_bf16 v[20:35], v[52:55], v[88:91], v[20:35]
ds_read_b128 v[80:83], v113 offset:2192
ds_read2_b32 v[44:45], v114 offset0:240 offset1:241
ds_read2_b32 v[46:47], v114 offset0:242 offset1:243
v_mfma_f32_32x32x16_bf16 v[20:35], v[56:59], v[84:87], v[20:35]
ds_read2_b32 v[48:49], v120 offset0:240 offset1:241
ds_read2_b32 v[50:51], v120 offset0:242 offset1:243
s_waitcnt lgkmcnt(6)
v_mfma_f32_32x32x16_bf16 v[4:19], v[36:39], v[68:71], v[4:19]
v_add_u32 v118, 4528, v113
v_min_u32 v118, v118, v117
ds_read_b128 v[84:87], v118
ds_read_b128 v[88:91], v113 offset:2224
v_mfma_f32_32x32x16_bf16 v[20:35], v[36:39], v[72:75], v[20:35]
v_add_u32 v114, 992, v114
v_add_u32 v120, 992, v120
ds_read2_b32 v[52:53], v114 offset0:0 offset1:1
ds_read2_b32 v[54:55], v114 offset0:2 offset1:3
v_mfma_f32_32x32x16_bf16 v[20:35], v[40:43], v[68:71], v[20:35]
ds_read2_b32 v[56:57], v120 offset0:0 offset1:1
ds_read2_b32 v[58:59], v120 offset0:2 offset1:3
s_waitcnt lgkmcnt(6)
v_mfma_f32_32x32x16_bf16 v[4:19], v[44:47], v[76:79], v[4:19]
v_add_u32 v118, 4560, v113
v_min_u32 v118, v118, v117
ds_read_b128 v[68:71], v118
v_mfma_f32_32x32x16_bf16 v[20:35], v[44:47], v[80:83], v[20:35]
ds_read_b128 v[72:75], v113 offset:2256
ds_read2_b32 v[36:37], v114 offset0:8 offset1:9
ds_read2_b32 v[38:39], v114 offset0:10 offset1:11
v_mfma_f32_32x32x16_bf16 v[20:35], v[48:51], v[76:79], v[20:35]
ds_read2_b32 v[40:41], v120 offset0:8 offset1:9
ds_read2_b32 v[42:43], v120 offset0:10 offset1:11
s_waitcnt lgkmcnt(6)
v_mfma_f32_32x32x16_bf16 v[4:19], v[52:55], v[84:87], v[4:19]
v_mfma_f32_32x32x16_bf16 v[20:35], v[52:55], v[88:91], v[20:35]
v_mfma_f32_32x32x16_bf16 v[20:35], v[56:59], v[84:87], v[20:35]
s_waitcnt lgkmcnt(0)
v_mfma_f32_32x32x16_bf16 v[4:19], v[36:39], v[68:71], v[4:19]
v_mfma_f32_32x32x16_bf16 v[20:35], v[36:39], v[72:75], v[20:35]
v_mfma_f32_32x32x16_bf16 v[20:35], v[40:43], v[68:71], v[20:35]
s_waitcnt vmcnt(8)
s_barrier
L_concat_heads__ssm_conv_h3__softmax_full_mha__prompt_kernel_kchk6:
s_and_b32 s67, s89, 32767
s_cmp_eq_u32 s67, 32767
s_cbranch_scc1 L_concat_heads__ssm_conv_h3__softmax_full_mha__prompt_kernel_kok6
global_load_dword v121, v122, s[84:85] sc1
s_waitcnt vmcnt(0)
v_cmp_eq_u32 vcc, s100, v121
s_nop 0
s_mov_b32 s89, vcc_lo
s_add_u32 s90, s90, 1
s_cmp_lt_u32 s90, 0x400000
s_cbranch_scc1 L_concat_heads__ssm_conv_h3__softmax_full_mha__prompt_kernel_kchk6
L_concat_heads__ssm_conv_h3__softmax_full_mha__prompt_kernel_kok6:
s_add_u32 m0, s82, 32768
s_nop 0
buffer_load_dwordx4 v116, s[76:79], s80 offen lds
buffer_load_dwordx4 v116, s[76:79], s80 offen offset:1024 lds
s_add_u32 m0, s82, 40960
s_nop 0
buffer_load_dwordx4 v116, s[76:79], s81 offen lds
buffer_load_dwordx4 v116, s[76:79], s81 offen offset:1024 lds
s_add_u32 s80, s80, 8192
s_add_u32 s81, s81, 8192
ds_write_b32 v115, v4 offset:0
ds_write_b32 v115, v5 offset:8
ds_write_b32 v115, v6 offset:16
ds_write_b32 v115, v7 offset:24
ds_write_b32 v115, v8 offset:64
ds_write_b32 v115, v9 offset:72
ds_write_b32 v115, v10 offset:80
ds_write_b32 v115, v11 offset:88
ds_write_b32 v115, v12 offset:128
ds_write_b32 v115, v13 offset:136
ds_write_b32 v115, v14 offset:144
ds_write_b32 v115, v15 offset:152
ds_write_b32 v115, v16 offset:192
ds_write_b32 v115, v17 offset:200
ds_write_b32 v115, v18 offset:208
ds_write_b32 v115, v19 offset:216
ds_write_b32 v115, v20 offset:4352
ds_write_b32 v115, v21 offset:4360
ds_write_b32 v115, v22 offset:4368
ds_write_b32 v115, v23 offset:4376
ds_write_b32 v115, v24 offset:4416
ds_write_b32 v115, v25 offset:4424
ds_write_b32 v115, v26 offset:4432
ds_write_b32 v115, v27 offset:4440
ds_write_b32 v115, v28 offset:4480
ds_write_b32 v115, v29 offset:4488
ds_write_b32 v115, v30 offset:4496
ds_write_b32 v115, v31 offset:4504
ds_write_b32 v115, v32 offset:4544
ds_write_b32 v115, v33 offset:4552
ds_write_b32 v115, v34 offset:4560
ds_write_b32 v115, v35 offset:4568
v_lshrrev_b32 v110, 3, v108
v_lshlrev_b32 v110, 4, v110
v_lshl_add_u32 v110, v108, 5, v110
v_add_u32 v110, s71, v110
v_sub_u32 v111, 63, v108
v_lshrrev_b32 v112, 3, v111
v_add_lshl_u32 v111, v111, v112, 4
v_add_u32 v111, s72, v111
s_waitcnt lgkmcnt(0)
ds_read_b128 v[124:127], v110 offset:0
ds_read_b128 v[128:131], v110 offset:16
ds_read_b128 v[156:159], v111 offset:3456
ds_read_b128 v[132:135], v110 offset:2176
ds_read_b128 v[136:139], v110 offset:2192
ds_read_b128 v[160:163], v111 offset:2304
ds_read_b128 v[140:143], v110 offset:4352
ds_read_b128 v[144:147], v110 offset:4368
ds_read_b128 v[164:167], v111 offset:1152
ds_read_b128 v[148:151], v110 offset:6528
ds_read_b128 v[152:155], v110 offset:6544
ds_read_b128 v[168:171], v111 offset:0
s_waitcnt vmcnt(8)
s_barrier
L_concat_heads__ssm_conv_h3__softmax_full_mha__prompt_kernel_kchk7:
s_and_b32 s67, s89, 131071
s_cmp_eq_u32 s67, 131071
s_cbranch_scc1 L_concat_heads__ssm_conv_h3__softmax_full_mha__prompt_kernel_kok7
global_load_dword v121, v122, s[84:85] sc1
s_waitcnt vmcnt(0)
v_cmp_eq_u32 vcc, s100, v121
s_nop 0
s_mov_b32 s89, vcc_lo
s_add_u32 s90, s90, 1
s_cmp_lt_u32 s90, 0x400000
s_cbranch_scc1 L_concat_heads__ssm_conv_h3__softmax_full_mha__prompt_kernel_kchk7
L_concat_heads__ssm_conv_h3__softmax_full_mha__prompt_kernel_kok7:
s_add_u32 m0, s82, 49152
s_nop 0
buffer_load_dwordx4 v116, s[76:79], s80 offen lds
buffer_load_dwordx4 v116, s[76:79], s80 offen offset:1024 lds
s_add_u32 m0, s82, 57344
s_nop 0
buffer_load_dwordx4 v116, s[76:79], s81 offen lds
buffer_load_dwordx4 v116, s[76:79], s81 offen offset:1024 lds
s_add_u32 s80, s80, 8192
s_add_u32 s81, s81, 8192
s_waitcnt lgkmcnt(0)
v_and_b32 v112, 0xffff0000, v159
v_fmac_f32 v124, s64, v112
v_lshlrev_b32 v112, 16, v159
v_fmac_f32 v125, s64, v112
v_and_b32 v112, 0xffff0000, v158
v_fmac_f32 v126, s64, v112
v_lshlrev_b32 v112, 16, v158
v_fmac_f32 v127, s64, v112
v_and_b32 v112, 0xffff0000, v157
v_fmac_f32 v128, s64, v112
v_lshlrev_b32 v112, 16, v157
v_fmac_f32 v129, s64, v112
v_and_b32 v112, 0xffff0000, v156
v_fmac_f32 v130, s64, v112
v_lshlrev_b32 v112, 16, v156
v_fmac_f32 v131, s64, v112
v_cvt_pk_bf16_f32 v124, v124, v125
v_cvt_pk_bf16_f32 v125, v126, v127
v_cvt_pk_bf16_f32 v126, v128, v129
v_cvt_pk_bf16_f32 v127, v130, v131
buffer_store_dwordx4 v[124:127], v109, s[16:19], s70 offen offset:0 sc1
v_and_b32 v112, 0xffff0000, v163
v_fmac_f32 v132, s64, v112
v_lshlrev_b32 v112, 16, v163
v_fmac_f32 v133, s64, v112
v_and_b32 v112, 0xffff0000, v162
v_fmac_f32 v134, s64, v112
v_lshlrev_b32 v112, 16, v162
v_fmac_f32 v135, s64, v112
v_and_b32 v112, 0xffff0000, v161
v_fmac_f32 v136, s64, v112
v_lshlrev_b32 v112, 16, v161
v_fmac_f32 v137, s64, v112
v_and_b32 v112, 0xffff0000, v160
v_fmac_f32 v138, s64, v112
v_lshlrev_b32 v112, 16, v160
v_fmac_f32 v139, s64, v112
v_cvt_pk_bf16_f32 v132, v132, v133
v_cvt_pk_bf16_f32 v133, v134, v135
v_cvt_pk_bf16_f32 v134, v136, v137
v_cvt_pk_bf16_f32 v135, v138, v139
buffer_store_dwordx4 v[132:135], v109, s[16:19], s70 offen offset:1024 sc1
s_waitcnt vmcnt(10)
s_barrier
L_concat_heads__ssm_conv_h3__softmax_full_mha__prompt_kernel_kchk8:
s_and_b32 s67, s89, 524287
s_cmp_eq_u32 s67, 524287
s_cbranch_scc1 L_concat_heads__ssm_conv_h3__softmax_full_mha__prompt_kernel_kok8
global_load_dword v121, v122, s[84:85] sc1
s_waitcnt vmcnt(0)
v_cmp_eq_u32 vcc, s100, v121
s_nop 0
s_mov_b32 s89, vcc_lo
s_add_u32 s90, s90, 1
s_cmp_lt_u32 s90, 0x400000
s_cbranch_scc1 L_concat_heads__ssm_conv_h3__softmax_full_mha__prompt_kernel_kchk8
L_concat_heads__ssm_conv_h3__softmax_full_mha__prompt_kernel_kok8:
s_add_u32 m0, s82, 0
s_nop 0
buffer_load_dwordx4 v116, s[76:79], s80 offen lds
buffer_load_dwordx4 v116, s[76:79], s80 offen offset:1024 lds
s_add_u32 m0, s82, 8192
s_nop 0
buffer_load_dwordx4 v116, s[76:79], s81 offen lds
buffer_load_dwordx4 v116, s[76:79], s81 offen offset:1024 lds
s_add_u32 s80, s80, 8192
s_add_u32 s81, s81, 8192
v_and_b32 v112, 0xffff0000, v167
v_fmac_f32 v140, s64, v112
v_lshlrev_b32 v112, 16, v167
v_fmac_f32 v141, s64, v112
v_and_b32 v112, 0xffff0000, v166
v_fmac_f32 v142, s64, v112
v_lshlrev_b32 v112, 16, v166
v_fmac_f32 v143, s64, v112
v_and_b32 v112, 0xffff0000, v165
v_fmac_f32 v144, s64, v112
v_lshlrev_b32 v112, 16, v165
v_fmac_f32 v145, s64, v112
v_and_b32 v112, 0xffff0000, v164
v_fmac_f32 v146, s64, v112
v_lshlrev_b32 v112, 16, v164
v_fmac_f32 v147, s64, v112
v_cvt_pk_bf16_f32 v140, v140, v141
v_cvt_pk_bf16_f32 v141, v142, v143
v_cvt_pk_bf16_f32 v142, v144, v145
v_cvt_pk_bf16_f32 v143, v146, v147
buffer_store_dwordx4 v[140:143], v109, s[16:19], s70 offen offset:2048 sc1
v_and_b32 v112, 0xffff0000, v171
v_fmac_f32 v148, s64, v112
v_lshlrev_b32 v112, 16, v171
v_fmac_f32 v149, s64, v112
v_and_b32 v112, 0xffff0000, v170
v_fmac_f32 v150, s64, v112
v_lshlrev_b32 v112, 16, v170
v_fmac_f32 v151, s64, v112
v_and_b32 v112, 0xffff0000, v169
v_fmac_f32 v152, s64, v112
v_lshlrev_b32 v112, 16, v169
v_fmac_f32 v153, s64, v112
v_and_b32 v112, 0xffff0000, v168
v_fmac_f32 v154, s64, v112
v_lshlrev_b32 v112, 16, v168
v_fmac_f32 v155, s64, v112
v_cvt_pk_bf16_f32 v148, v148, v149
v_cvt_pk_bf16_f32 v149, v150, v151
v_cvt_pk_bf16_f32 v150, v152, v153
v_cvt_pk_bf16_f32 v151, v154, v155
buffer_store_dwordx4 v[148:151], v109, s[16:19], s70 offen offset:3072 sc1
s_load_dwordx2 s[48:49], s[0:1], 0
s_load_dwordx2 s[50:51], s[0:1], 72
s_load_dwordx2 s[54:55], s[0:1], 88
s_waitcnt vmcnt(12)
s_barrier
L_concat_heads__ssm_conv_h3__softmax_full_mha__prompt_kernel_kchk9:
s_and_b32 s67, s89, 2097151
s_cmp_eq_u32 s67, 2097151
s_cbranch_scc1 L_concat_heads__ssm_conv_h3__softmax_full_mha__prompt_kernel_kok9
global_load_dword v121, v122, s[84:85] sc1
s_waitcnt vmcnt(0)
v_cmp_eq_u32 vcc, s100, v121
s_nop 0
s_mov_b32 s89, vcc_lo
s_add_u32 s90, s90, 1
s_cmp_lt_u32 s90, 0x400000
s_cbranch_scc1 L_concat_heads__ssm_conv_h3__softmax_full_mha__prompt_kernel_kchk9
L_concat_heads__ssm_conv_h3__softmax_full_mha__prompt_kernel_kok9:
s_add_u32 m0, s82, 16384
s_nop 0
buffer_load_dwordx4 v116, s[76:79], s80 offen lds
buffer_load_dwordx4 v116, s[76:79], s80 offen offset:1024 lds
s_add_u32 m0, s82, 24576
s_nop 0
buffer_load_dwordx4 v116, s[76:79], s81 offen lds
buffer_load_dwordx4 v116, s[76:79], s81 offen offset:1024 lds
s_add_u32 s80, s80, 8192
s_add_u32 s81, s81, 8192
s_lshr_b32 s66, s2, 6
s_lshl_b32 s66, s66, 7
s_bfe_u32 s67, s2, 0x30003
s_lshl_b32 s67, s67, 2
s_add_u32 s67, s67, s3
s_lshl_b32 s67, s67, 2
s_add_u32 s66, s66, s67
s_add_u32 s66, s66, s88
s_add_u32 s66, s66, 4096
v_mov_b32 v110, s66
v_mov_b32 v111, s100
s_waitcnt vmcnt(4)
s_mov_b64 exec, 1
global_store_dword v110, v111, s[84:85] sc1
s_mov_b64 exec, -1
s_waitcnt lgkmcnt(0)
v_and_b32 v156, 63, v0
s_lshr_b32 s56, s2, 3
s_and_b32 s57, s2, 7
s_lshl_b32 s57, s57, 2
s_add_u32 s57, s57, s3
s_lshl_b32 s57, s57, 5
s_mul_i32 s60, s3, 10240
s_add_u32 s60, s60, 122880
s_mov_b32 s32, s48
s_and_b32 s33, s49, 0xffff
s_mov_b32 s34, 4194304
s_mov_b32 s35, 0x20000
s_mov_b32 s40, s50
s_and_b32 s41, s51, 0xffff
s_mov_b32 s42, 8388608
s_mov_b32 s43, 0x20000
s_add_u32 s36, s54, 33554432
s_addc_u32 s37, s55, 0
s_and_b32 s37, s37, 0xffff
s_mov_b32 s38, 4194304
s_mov_b32 s39, 0x20000
s_lshl_b32 s59, s57, 1
v_and_b32 v158, 3, v156
v_lshrrev_b32 v159, 2, v156
s_lshl_b32 s58, s56, 17
s_add_u32 s58, s58, s59
v_lshl_add_u32 v157, v158, 4, s58
v_lshl_add_u32 v157, v159, 11, v157
s_lshl_b32 s58, s56, 18
s_add_u32 s58, s58, s59
v_lshl_add_u32 v162, v158, 4, s58
v_lshl_add_u32 v162, v159, 12, v162
v_and_b32 v158, 15, v156
v_lshrrev_b32 v159, 4, v156
v_lshlrev_b32 v163, 8, v158
v_lshl_add_u32 v163, v159, 5, v163
v_add_u32 v163, s60, v163
v_lshlrev_b32 v164, 10, v159
v_lshl_add_u32 v164, v158, 2, v164
v_add_u32 v164, s60, v164
v_lshl_add_u32 v165, v156, 4, s60
v_lshrrev_b32 v159, 3, v156
v_add_u32 v159, s57, v159
v_lshlrev_b32 v161, 12, v159
v_and_b32 v159, 7, v156
v_lshl_add_u32 v161, v159, 4, v161
s_lshl_b32 s58, s56, 7
s_waitcnt vmcnt(13)
s_barrier
L_concat_heads__ssm_conv_h3__softmax_full_mha__prompt_kernel_kchk10:
s_and_b32 s67, s89, 8388607
s_cmp_eq_u32 s67, 8388607
s_cbranch_scc1 L_concat_heads__ssm_conv_h3__softmax_full_mha__prompt_kernel_kok10
global_load_dword v121, v122, s[84:85] sc1
s_waitcnt vmcnt(0)
v_cmp_eq_u32 vcc, s100, v121
s_nop 0
s_mov_b32 s89, vcc_lo
s_add_u32 s90, s90, 1
s_cmp_lt_u32 s90, 0x400000
s_cbranch_scc1 L_concat_heads__ssm_conv_h3__softmax_full_mha__prompt_kernel_kchk10
L_concat_heads__ssm_conv_h3__softmax_full_mha__prompt_kernel_kok10:
s_add_u32 m0, s82, 32768
s_nop 0
buffer_load_dwordx4 v116, s[76:79], s80 offen lds
buffer_load_dwordx4 v116, s[76:79], s80 offen offset:1024 lds
s_add_u32 m0, s82, 40960
s_nop 0
buffer_load_dwordx4 v116, s[76:79], s81 offen lds
buffer_load_dwordx4 v116, s[76:79], s81 offen offset:1024 lds
s_add_u32 s80, s80, 8192
s_add_u32 s81, s81, 8192
s_add_u32 m0, s60, 4096
s_nop 0
buffer_load_dwordx4 v157, s[32:35], 0 offen lds
v_add_u32 v157, 32768, v157
s_add_u32 m0, s60, 5120
s_nop 0
buffer_load_dwordx4 v157, s[32:35], 0 offen lds
v_add_u32 v157, 32768, v157
s_add_u32 m0, s60, 6144
s_nop 0
buffer_load_dwordx4 v157, s[32:35], 0 offen lds
v_add_u32 v157, 32768, v157
s_add_u32 m0, s60, 7168
s_nop 0
buffer_load_dwordx4 v157, s[32:35], 0 offen lds
v_add_u32 v157, 32768, v157
s_lshl_b32 s66, s3, 7
s_add_u32 s66, s66, s88
s_add_u32 s66, s66, 4096
v_and_b32 v119, 31, v108
v_lshl_add_u32 v119, v119, 2, s66
s_lshl_b32 s69, s2, 2
s_add_u32 s69, s69, s3
s_lshl_b32 s69, s69, 11
buffer_load_dwordx4 v[92:95], v109, s[24:27], s69 offen offset:0
buffer_load_dwordx4 v[96:99], v109, s[24:27], s69 offen offset:1024
s_waitcnt vmcnt(17)
s_barrier
L_concat_heads__ssm_conv_h3__softmax_full_mha__prompt_kernel_kchk11:
s_and_b32 s67, s89, 33554431
s_cmp_eq_u32 s67, 33554431
s_cbranch_scc1 L_concat_heads__ssm_conv_h3__softmax_full_mha__prompt_kernel_kok11
global_load_dword v121, v122, s[84:85] sc1
s_waitcnt vmcnt(0)
v_cmp_eq_u32 vcc, s100, v121
s_nop 0
s_mov_b32 s89, vcc_lo
s_add_u32 s90, s90, 1
s_cmp_lt_u32 s90, 0x400000
s_cbranch_scc1 L_concat_heads__ssm_conv_h3__softmax_full_mha__prompt_kernel_kchk11
L_concat_heads__ssm_conv_h3__softmax_full_mha__prompt_kernel_kok11:
s_add_u32 m0, s82, 49152
s_nop 0
buffer_load_dwordx4 v116, s[76:79], s80 offen lds
buffer_load_dwordx4 v116, s[76:79], s80 offen offset:1024 lds
s_add_u32 m0, s82, 57344
s_nop 0
buffer_load_dwordx4 v116, s[76:79], s81 offen lds
buffer_load_dwordx4 v116, s[76:79], s81 offen offset:1024 lds
s_add_u32 s80, s80, 8192
s_add_u32 s81, s81, 8192
s_waitcnt vmcnt(15)
s_barrier
L_concat_heads__ssm_conv_h3__softmax_full_mha__prompt_kernel_kchk12:
s_and_b32 s67, s89, 134217727
s_cmp_eq_u32 s67, 134217727
s_cbranch_scc1 L_concat_heads__ssm_conv_h3__softmax_full_mha__prompt_kernel_kok12
global_load_dword v121, v122, s[84:85] sc1
s_waitcnt vmcnt(0)
v_cmp_eq_u32 vcc, s100, v121
s_nop 0
s_mov_b32 s89, vcc_lo
s_add_u32 s90, s90, 1
s_cmp_lt_u32 s90, 0x400000
s_cbranch_scc1 L_concat_heads__ssm_conv_h3__softmax_full_mha__prompt_kernel_kchk12
L_concat_heads__ssm_conv_h3__softmax_full_mha__prompt_kernel_kok12:
s_add_u32 m0, s82, 0
s_nop 0
buffer_load_dwordx4 v116, s[76:79], s80 offen lds
buffer_load_dwordx4 v116, s[76:79], s80 offen offset:1024 lds
s_add_u32 m0, s82, 8192
s_nop 0
buffer_load_dwordx4 v116, s[76:79], s81 offen lds
buffer_load_dwordx4 v116, s[76:79], s81 offen offset:1024 lds
s_add_u32 s80, s80, 8192
s_add_u32 s81, s81, 8192
s_mov_b32 s69, 0
L_pollz2:
global_load_dword v111, v119, s[84:85] sc1
s_waitcnt vmcnt(0)
v_cmp_ne_u32 vcc, s100, v111
s_nop 0
s_cbranch_vccz L_readyz2
s_sleep 8
s_add_u32 s69, s69, 1
s_cmp_lt_u32 s69, 0x200000
s_cbranch_scc1 L_pollz2
L_readyz2:
s_add_u32 m0, s60, 0
s_nop 0
buffer_load_dwordx4 v161, s[36:39], s58 offen sc1 lds
s_add_u32 s58, s58, 32768
s_add_u32 m0, s60, 1024
s_nop 0
buffer_load_dwordx4 v161, s[36:39], s58 offen sc1 lds
s_add_u32 s58, s58, 32768
s_add_u32 m0, s60, 2048
s_nop 0
buffer_load_dwordx4 v161, s[36:39], s58 offen sc1 lds
s_add_u32 s58, s58, 32768
s_add_u32 m0, s60, 3072
s_nop 0
buffer_load_dwordx4 v161, s[36:39], s58 offen sc1 lds
s_add_u32 s58, s58, 32768
s_waitcnt vmcnt(18)
s_barrier
L_concat_heads__ssm_conv_h3__softmax_full_mha__prompt_kernel_kchk13:
s_and_b32 s67, s89, 536870911
s_cmp_eq_u32 s67, 536870911
s_cbranch_scc1 L_concat_heads__ssm_conv_h3__softmax_full_mha__prompt_kernel_kok13
global_load_dword v121, v122, s[84:85] sc1
s_waitcnt vmcnt(0)
v_cmp_eq_u32 vcc, s100, v121
s_nop 0
s_mov_b32 s89, vcc_lo
s_add_u32 s90, s90, 1
s_cmp_lt_u32 s90, 0x400000
s_cbranch_scc1 L_concat_heads__ssm_conv_h3__softmax_full_mha__prompt_kernel_kchk13
L_concat_heads__ssm_conv_h3__softmax_full_mha__prompt_kernel_kok13:
s_add_u32 m0, s82, 16384
s_nop 0
buffer_load_dwordx4 v116, s[76:79], s80 offen lds
buffer_load_dwordx4 v116, s[76:79], s80 offen offset:1024 lds
s_add_u32 m0, s82, 24576
s_nop 0
buffer_load_dwordx4 v116, s[76:79], s81 offen lds
buffer_load_dwordx4 v116, s[76:79], s81 offen offset:1024 lds
s_add_u32 s80, s80, 8192
s_add_u32 s81, s81, 8192
s_waitcnt vmcnt(4)
ds_read_b128 v[140:143], v163 offset:0
ds_read_b128 v[144:147], v163 offset:16
ds_read_b128 v[148:151], v163 offset:128
ds_read_b128 v[152:155], v163 offset:144
ds_read_b32 v124, v164 offset:4096
ds_read_b32 v125, v164 offset:4160
ds_read_b32 v126, v164 offset:4224
ds_read_b32 v127, v164 offset:4288
ds_read_b32 v128, v164 offset:4352
ds_read_b32 v129, v164 offset:4416
ds_read_b32 v130, v164 offset:4480
ds_read_b32 v131, v164 offset:4544
ds_read_b32 v132, v164 offset:4608
ds_read_b32 v133, v164 offset:4672
ds_read_b32 v134, v164 offset:4736
ds_read_b32 v135, v164 offset:4800
ds_read_b32 v136, v164 offset:4864
ds_read_b32 v137, v164 offset:4928
ds_read_b32 v138, v164 offset:4992
ds_read_b32 v139, v164 offset:5056
s_waitcnt lgkmcnt(0)
v_lshlrev_b32 v159, 16, v140
v_lshlrev_b32 v158, 16, v124
v_mul_f32 v159, v159, v158
v_lshlrev_b32 v160, 16, v148
v_and_b32 v158, 0xffff0000, v124
v_mul_f32 v160, v160, v158
v_cvt_pk_bf16_f32 v124, v159, v160
v_and_b32 v159, 0xffff0000, v140
v_lshlrev_b32 v158, 16, v125
v_mul_f32 v159, v159, v158
v_and_b32 v160, 0xffff0000, v148
v_and_b32 v158, 0xffff0000, v125
v_mul_f32 v160, v160, v158
v_cvt_pk_bf16_f32 v125, v159, v160
v_lshlrev_b32 v159, 16, v141
v_lshlrev_b32 v158, 16, v126
v_mul_f32 v159, v159, v158
v_lshlrev_b32 v160, 16, v149
v_and_b32 v158, 0xffff0000, v126
v_mul_f32 v160, v160, v158
v_cvt_pk_bf16_f32 v126, v159, v160
v_and_b32 v159, 0xffff0000, v141
v_lshlrev_b32 v158, 16, v127
v_mul_f32 v159, v159, v158
v_and_b32 v160, 0xffff0000, v149
v_and_b32 v158, 0xffff0000, v127
v_mul_f32 v160, v160, v158
v_cvt_pk_bf16_f32 v127, v159, v160
v_lshlrev_b32 v159, 16, v142
v_lshlrev_b32 v158, 16, v128
v_mul_f32 v159, v159, v158
v_lshlrev_b32 v160, 16, v150
v_and_b32 v158, 0xffff0000, v128
s_waitcnt vmcnt(12)
s_barrier
L_concat_heads__ssm_conv_h3__softmax_full_mha__prompt_kernel_kchk14:
s_and_b32 s67, s89, 2147483647
s_cmp_eq_u32 s67, 2147483647
s_cbranch_scc1 L_concat_heads__ssm_conv_h3__softmax_full_mha__prompt_kernel_kok14
global_load_dword v121, v122, s[84:85] sc1
s_waitcnt vmcnt(0)
v_cmp_eq_u32 vcc, s100, v121
s_nop 0
s_mov_b32 s89, vcc_lo
s_add_u32 s90, s90, 1
s_cmp_lt_u32 s90, 0x400000
s_cbranch_scc1 L_concat_heads__ssm_conv_h3__softmax_full_mha__prompt_kernel_kchk14
L_concat_heads__ssm_conv_h3__softmax_full_mha__prompt_kernel_kok14:
s_add_u32 m0, s82, 32768
s_nop 0
buffer_load_dwordx4 v116, s[76:79], s80 offen lds
buffer_load_dwordx4 v116, s[76:79], s80 offen offset:1024 lds
s_add_u32 m0, s82, 40960
s_nop 0
buffer_load_dwordx4 v116, s[76:79], s81 offen lds
buffer_load_dwordx4 v116, s[76:79], s81 offen offset:1024 lds
s_add_u32 s80, s80, 8192
s_add_u32 s81, s81, 8192
v_mul_f32 v160, v160, v158
v_cvt_pk_bf16_f32 v128, v159, v160
v_and_b32 v159, 0xffff0000, v142
v_lshlrev_b32 v158, 16, v129
v_mul_f32 v159, v159, v158
v_and_b32 v160, 0xffff0000, v150
v_and_b32 v158, 0xffff0000, v129
v_mul_f32 v160, v160, v158
v_cvt_pk_bf16_f32 v129, v159, v160
v_lshlrev_b32 v159, 16, v143
v_lshlrev_b32 v158, 16, v130
v_mul_f32 v159, v159, v158
v_lshlrev_b32 v160, 16, v151
v_and_b32 v158, 0xffff0000, v130
v_mul_f32 v160, v160, v158
v_cvt_pk_bf16_f32 v130, v159, v160
v_and_b32 v159, 0xffff0000, v143
v_lshlrev_b32 v158, 16, v131
v_mul_f32 v159, v159, v158
v_and_b32 v160, 0xffff0000, v151
v_and_b32 v158, 0xffff0000, v131
v_mul_f32 v160, v160, v158
v_cvt_pk_bf16_f32 v131, v159, v160
v_lshlrev_b32 v159, 16, v144
v_lshlrev_b32 v158, 16, v132
v_mul_f32 v159, v159, v158
v_lshlrev_b32 v160, 16, v152
v_and_b32 v158, 0xffff0000, v132
v_mul_f32 v160, v160, v158
v_cvt_pk_bf16_f32 v132, v159, v160
v_and_b32 v159, 0xffff0000, v144
v_lshlrev_b32 v158, 16, v133
v_mul_f32 v159, v159, v158
v_and_b32 v160, 0xffff0000, v152
v_and_b32 v158, 0xffff0000, v133
v_mul_f32 v160, v160, v158
v_cvt_pk_bf16_f32 v133, v159, v160
v_lshlrev_b32 v159, 16, v145
v_lshlrev_b32 v158, 16, v134
v_mul_f32 v159, v159, v158
v_lshlrev_b32 v160, 16, v153
v_and_b32 v158, 0xffff0000, v134
v_mul_f32 v160, v160, v158
v_cvt_pk_bf16_f32 v134, v159, v160
v_and_b32 v159, 0xffff0000, v145
v_lshlrev_b32 v158, 16, v135
v_mul_f32 v159, v159, v158
v_and_b32 v160, 0xffff0000, v153
v_and_b32 v158, 0xffff0000, v135
v_mul_f32 v160, v160, v158
v_cvt_pk_bf16_f32 v135, v159, v160
v_lshlrev_b32 v159, 16, v146
v_lshlrev_b32 v158, 16, v136
v_mul_f32 v159, v159, v158
s_waitcnt vmcnt(12)
s_barrier
L_concat_heads__ssm_conv_h3__softmax_full_mha__prompt_kernel_kchk15:
s_and_b32 s67, s89, 4294967295
s_cmp_eq_u32 s67, 4294967295
s_cbranch_scc1 L_concat_heads__ssm_conv_h3__softmax_full_mha__prompt_kernel_kok15
global_load_dword v121, v122, s[84:85] sc1
s_waitcnt vmcnt(0)
v_cmp_eq_u32 vcc, s100, v121
s_nop 0
s_mov_b32 s89, vcc_lo
s_add_u32 s90, s90, 1
s_cmp_lt_u32 s90, 0x400000
s_cbranch_scc1 L_concat_heads__ssm_conv_h3__softmax_full_mha__prompt_kernel_kchk15
L_concat_heads__ssm_conv_h3__softmax_full_mha__prompt_kernel_kok15:
s_cmp_eq_u32 s3, 3
s_cselect_b32 s67, 2048, 0
s_sub_u32 s80, s80, s67
s_sub_u32 s81, s81, s67
s_add_u32 m0, s82, 49152
s_nop 0
buffer_load_dwordx4 v116, s[76:79], s80 offen lds
buffer_load_dwordx4 v116, s[76:79], s80 offen offset:1024 lds
s_add_u32 m0, s82, 57344
s_nop 0
buffer_load_dwordx4 v116, s[76:79], s81 offen lds
buffer_load_dwordx4 v116, s[76:79], s81 offen offset:1024 lds
s_add_u32 s80, s80, 8192
s_add_u32 s81, s81, 8192
v_lshlrev_b32 v160, 16, v154
v_and_b32 v158, 0xffff0000, v136
v_mul_f32 v160, v160, v158
v_cvt_pk_bf16_f32 v136, v159, v160
v_and_b32 v159, 0xffff0000, v146
v_lshlrev_b32 v158, 16, v137
v_mul_f32 v159, v159, v158
v_and_b32 v160, 0xffff0000, v154
v_and_b32 v158, 0xffff0000, v137
v_mul_f32 v160, v160, v158
v_cvt_pk_bf16_f32 v137, v159, v160
v_lshlrev_b32 v159, 16, v147
v_lshlrev_b32 v158, 16, v138
v_mul_f32 v159, v159, v158
v_lshlrev_b32 v160, 16, v155
v_and_b32 v158, 0xffff0000, v138
v_mul_f32 v160, v160, v158
v_cvt_pk_bf16_f32 v138, v159, v160
v_and_b32 v159, 0xffff0000, v147
v_lshlrev_b32 v158, 16, v139
v_mul_f32 v159, v159, v158
v_and_b32 v160, 0xffff0000, v155
v_and_b32 v158, 0xffff0000, v139
v_mul_f32 v160, v160, v158
v_cvt_pk_bf16_f32 v139, v159, v160
ds_write_b32 v164, v124 offset:4096
ds_write_b32 v164, v125 offset:4160
ds_write_b32 v164, v126 offset:4224
ds_write_b32 v164, v127 offset:4288
ds_write_b32 v164, v128 offset:4352
ds_write_b32 v164, v129 offset:4416
ds_write_b32 v164, v130 offset:4480
ds_write_b32 v164, v131 offset:4544
ds_write_b32 v164, v132 offset:4608
ds_write_b32 v164, v133 offset:4672
ds_write_b32 v164, v134 offset:4736
ds_write_b32 v164, v135 offset:4800
ds_write_b32 v164, v136 offset:4864
ds_write_b32 v164, v137 offset:4928
ds_write_b32 v164, v138 offset:4992
ds_write_b32 v164, v139 offset:5056
s_waitcnt lgkmcnt(0)
ds_read_b128 v[140:143], v165 offset:4096
ds_read_b128 v[144:147], v165 offset:5120
ds_read_b128 v[148:151], v165 offset:6144
ds_read_b128 v[152:155], v165 offset:7168
s_waitcnt lgkmcnt(0)
buffer_store_dwordx4 v[140:143], v162, s[40:43], 0 offen
v_add_u32 v162, 65536, v162
buffer_store_dwordx4 v[144:147], v162, s[40:43], 0 offen
v_add_u32 v162, 65536, v162
buffer_store_dwordx4 v[148:151], v162, s[40:43], 0 offen
v_add_u32 v162, 65536, v162
buffer_store_dwordx4 v[152:155], v162, s[40:43], 0 offen
s_waitcnt lgkmcnt(0)
s_waitcnt vmcnt(12)
s_barrier
s_lshr_b32 s69, s2, 4
s_lshl_b32 s69, s69, 7
v_lshrrev_b32 v112, 3, v108
s_lshl_b32 s71, s3, 4
v_add_u32 v112, s71, v112
v_lshlrev_b32 v112, 11, v112
v_bfe_u32 v114, v108, 4, 1
v_lshlrev_b32 v114, 2, v114
v_and_b32 v113, 7, v108
v_xor_b32 v113, v113, v114
v_lshl_add_u32 v112, v113, 4, v112
v_add_u32 v110, s69, v112
v_add_u32 v111, 16384, v110
s_mov_b32 s69, 0
s_mov_b32 s70, 0
s_mov_b32 s73, 0
s_mov_b64 s[74:75], 0
s_add_u32 m0, s82, 65536
s_nop 0
buffer_load_dwordx4 v110, s[24:27], s69 offen lds
s_add_u32 m0, s82, 66560
s_nop 0
buffer_load_dwordx4 v111, s[24:27], s69 offen lds
s_add_u32 s69, s69, 131072
s_add_u32 m0, s82, 73728
s_nop 0
buffer_load_dwordx4 v110, s[24:27], s69 offen lds
s_add_u32 m0, s82, 74752
s_nop 0
buffer_load_dwordx4 v111, s[24:27], s69 offen lds
s_add_u32 s69, s69, 131072
s_add_u32 m0, s82, 81920
s_nop 0
buffer_load_dwordx4 v110, s[24:27], s69 offen lds
s_add_u32 m0, s82, 82944
s_nop 0
buffer_load_dwordx4 v111, s[24:27], s69 offen lds
s_add_u32 s69, s69, 131072
s_add_u32 m0, s82, 90112
s_nop 0
buffer_load_dwordx4 v110, s[24:27], s69 offen lds
s_add_u32 m0, s82, 91136
s_nop 0
buffer_load_dwordx4 v111, s[24:27], s69 offen lds
s_add_u32 s69, s69, 131072
s_waitcnt vmcnt(16)
s_barrier
s_add_u32 m0, s82, 98304
s_nop 0
buffer_load_dwordx4 v110, s[24:27], s69 offen lds
s_add_u32 m0, s82, 99328
s_nop 0
buffer_load_dwordx4 v111, s[24:27], s69 offen lds
s_add_u32 s69, s69, 131072
s_add_u32 m0, s82, 106496
s_nop 0
buffer_load_dwordx4 v110, s[24:27], s69 offen lds
s_add_u32 m0, s82, 107520
s_nop 0
buffer_load_dwordx4 v111, s[24:27], s69 offen lds
s_add_u32 s69, s69, 131072
s_add_u32 m0, s82, 114688
s_nop 0
buffer_load_dwordx4 v110, s[24:27], s69 offen lds
s_add_u32 m0, s82, 115712
s_nop 0
buffer_load_dwordx4 v111, s[24:27], s69 offen lds
s_add_u32 s69, s69, 131072
s_add_u32 m0, s82, 122880
s_nop 0
buffer_load_dwordx4 v110, s[24:27], s69 offen lds
s_add_u32 m0, s82, 123904
s_nop 0
buffer_load_dwordx4 v111, s[24:27], s69 offen lds
s_add_u32 s69, s69, 131072
s_waitcnt vmcnt(20)
s_barrier
s_add_u32 m0, s82, 131072
s_nop 0
buffer_load_dwordx4 v110, s[24:27], s69 offen lds
s_add_u32 m0, s82, 132096
s_nop 0
buffer_load_dwordx4 v111, s[24:27], s69 offen lds
s_add_u32 s69, s69, 131072
s_add_u32 m0, s82, 139264
s_nop 0
buffer_load_dwordx4 v110, s[24:27], s69 offen lds
s_add_u32 m0, s82, 140288
s_nop 0
buffer_load_dwordx4 v111, s[24:27], s69 offen lds
s_add_u32 s69, s69, 131072
s_waitcnt vmcnt(0)
s_barrier
L_concat_heads__ssm_conv_h3__softmax_full_mha__prompt_kernel_last:
s_endpgm
.section .rodata,"a"
.p2align 6
.amdhsa_kernel concat_heads__ssm_conv_h3__softmax_full_mha__prompt_kernel
  .amdhsa_next_free_vgpr 234
  .amdhsa_next_free_sgpr 102
  .amdhsa_accum_offset 236
  .amdhsa_group_segment_fixed_size 0
  .amdhsa_kernarg_size 96
  .amdhsa_user_sgpr_count 2
  .amdhsa_user_sgpr_kernarg_segment_ptr 1
  .amdhsa_system_sgpr_workgroup_id_x 1
.end_amdhsa_kernel
```
